```python
import torch

def _softmax(x, axis=-1):
    return torch.softmax(x, dim=axis)
def _gelu(x):
    return torch.nn.functional.gelu(x, approximate="tanh")
def _silu(x):
    return torch.nn.functional.silu(x)
def _sigmoid(x):
    return torch.sigmoid(x)
def _layernorm(x, axis=-1, eps=1e-5):
    m = x.mean(dim=axis, keepdim=True)
    v = x.var(dim=axis, keepdim=True, unbiased=False)
    return (x - m) / torch.sqrt(v + eps)
def _scatter_add(tgt, idx, src, axis=0):
    return tgt.clone().index_add_(axis, idx, src)
def _segment_sum(src, seg, n):
    out = torch.zeros((n,) + src.shape[1:], dtype=src.dtype)
    return out.index_add_(0, seg, src)
def _pad(x, pw):
    flat = tuple(v for pair in reversed(pw) for v in pair)
    return torch.nn.functional.pad(x, flat)

kernel_name = 'standalone__mha_block_cached__near_ridge'

def setup_inputs():

    _w = (lambda a: (lambda t: t.to(torch.bfloat16) if t.is_floating_point() else t)(torch.as_tensor(a)))
    B, Sq, D = 16, 160, 640
    H, Sk, Dh = 32, 512, 128
    return {
        "x": _w((lambda *s: torch.randn(*s, dtype=torch.bfloat16) * 0.8)(B, Sq, D)),
        "k_cache": _w((lambda *s: torch.randn(*s, dtype=torch.bfloat16) * 0.8)(B, H, Sk, Dh)),
        "v_cache": _w((lambda *s: torch.randn(*s, dtype=torch.bfloat16) * 0.05)(B, H, Sk, Dh)),
        "wq": _w((lambda *s: torch.randn(*s, dtype=torch.bfloat16) * 0.8)(D, H * Dh) * (D ** -0.5)),
        "wo": _w((lambda *s: torch.randn(*s, dtype=torch.bfloat16) * 0.05)(H * Dh, D) * ((H * Dh) ** -0.5)),
    }

def reference(x, k_cache, v_cache, wq, wo):
    B, Sq, D = x.shape
    H, Dh = 32, 128
    q = (lambda x, *d: x.permute(*d))((x @ wq).reshape(B, Sq, H, Dh), 0, 2, 1, 3)
    scores = torch.einsum("bhqd,bhkd->bhqk", q, k_cache) * (Dh ** -0.5)
    p = _softmax(scores, axis=-1)
    o = torch.einsum("bhqk,bhkd->bhqd", p, v_cache)
    return (lambda x, *d: x.permute(*d))(o, 0, 2, 1, 3).reshape(B, Sq, H * Dh) @ wo
```

```asm
; @launch grid=(256,1,1) block=(256,1,1) lds=163840
.amdgcn_target "amdgcn-amd-amdhsa--gfx950"
.text
.globl standalone__mha_block_cached__near_ridge_kernel
.p2align 8
.type standalone__mha_block_cached__near_ridge_kernel,@function
standalone__mha_block_cached__near_ridge_kernel:
    s_cmp_ge_u32 s2, 256
    s_cbranch_scc1 K_END
    s_load_dwordx16 s[4:19], s[0:1], 0
    s_getpc_b64 s[24:25]
IPF_BASE:
    s_lshr_b32 s26, s2, 3
    s_lshl_b32 s26, s26, 12
    v_lshl_add_u32 v96, v0, 4, s26
    v_min_u32 v96, K_END-IPF_BASE-16, v96
    v_mov_b32 v97, s25
    v_add_co_u32 v96, vcc, s24, v96
    v_addc_co_u32 v97, vcc, 0, v97, vcc
    s_cmp_ge_u32 s26, K_END-IPF_BASE
    s_cbranch_scc1 IPF_SKIP
    global_load_dwordx4 v[100:103], v[96:97], off
IPF_SKIP:
    v_lshrrev_b32 v1, 6, v0
    v_and_b32 v2, 63, v0
    v_readfirstlane_b32 s40, v1
    v_and_b32 v3, 15, v2
    v_lshrrev_b32 v1, 4, v2
    s_add_u32 s43, s2, 0
    s_and_b32 s43, s43, 7
    s_lshr_b32 s44, s2, 3
    s_lshr_b32 s41, s43, 2
    s_lshl_b32 s41, s41, 3
    s_and_b32 s45, s44, 7
    s_add_u32 s41, s41, s45
    s_and_b32 s42, s43, 3
    s_lshl_b32 s42, s42, 2
    s_lshr_b32 s45, s44, 3
    s_add_u32 s42, s42, s45
    s_lshr_b32 s46, s40, 1
    s_and_b32 s47, s40, 1
    s_lshr_b32 s49, s44, 3
    s_add_u32 s56, s44, s49
    s_and_b32 s56, s56, 1
    s_mul_i32 s56, s56, 5
    v_lshrrev_b32 v20, 1, v3
    v_and_b32 v21, 1, v2
    v_lshlrev_b32 v21, 4, v21
    v_xor_b32 v22, v20, v1
    v_lshl_add_u32 v22, v22, 5, v21
    v_lshl_add_u32 v50, v1, 13, v22
    s_lshl_b32 s48, s47, 17
    s_lshl_b32 s49, s46, 8
    s_add_u32 s48, s48, s49
    v_add_u32 v50, s48, v50
    v_add_u32 v51, 31744, v50
    v_xor_b32 v52, 0x80, v50
    v_add_u32 v53, 95232, v52
    v_add_u32 v52, 63488, v52
    s_lshl_b32 s50, s42, 9
    s_lshl_b32 s48, s56, 19
    s_add_u32 s50, s50, s48
    s_lshl_b32 s52, s40, 12
    v_lshrrev_b32 v25, 3, v2
    v_mul_u32_u24 v25, 1280, v25
    v_and_b32 v26, 7, v2
    v_xor_b32 v26, v26, v1
    s_lshl_b32 s48, s47, 2
    v_xor_b32 v26, s48, v26
    s_mul_i32 s48, s40, 51200
    v_add_u32 v25, s48, v25
    v_lshl_add_u32 v54, v26, 4, v25
    v_xor_b32 v26, 4, v26
    v_lshl_add_u32 v55, v26, 4, v25
    v_add_u32 v56, 18432, v54
    v_add_u32 v57, 30720, v55
    v_add_u32 v58, 39936, v54
    v_add_u32 v55, 9216, v55
    s_mul_i32 s51, s41, 204800
    s_add_u32 s55, s51, 1280
    s_lshl_b32 s48, s56, 7
    s_add_u32 s51, s51, s48
    s_mul_i32 s57, s40, 5120
    s_add_u32 s53, s57, 118784
    s_add_u32 s90, s57, 98304
    s_lshl_b32 s58, s53, 1
    s_add_u32 s58, s58, 20480
    s_waitcnt lgkmcnt(0)
    s_mov_b32 s24, s10
    s_and_b32 s25, s11, 0xffff
    s_mov_b32 s26, 5242880
    s_mov_b32 s27, 0x20000
    s_mov_b32 s20, s4
    s_and_b32 s21, s5, 0xffff
    s_mov_b32 s22, 3276800
    s_mov_b32 s23, 0x20000
    s_add_u32 s28, s18, 34623488
    s_addc_u32 s29, s19, 0
    s_load_dword s30, s[28:29], 0
    s_add_u32 m0, s52, 32768
    s_nop 0
    buffer_load_dwordx4 v50, s[24:27], s50 offen offset:0 lds
    buffer_load_dwordx4 v51, s[24:27], s50 offen offset:1024 lds
    buffer_load_dwordx4 v52, s[24:27], s50 offen offset:2048 lds
    buffer_load_dwordx4 v53, s[24:27], s50 offen offset:3072 lds
    s_add_u32 s50, s50, 262144
    s_add_u32 m0, s57, 118784
    s_nop 0
    buffer_load_dwordx4 v54, s[20:23], s51 offen offset:0 lds
    buffer_load_dwordx4 v55, s[20:23], s51 offen offset:1024 lds
    buffer_load_dwordx4 v56, s[20:23], s51 offen offset:2048 lds
    s_add_u32 m0, s57, 121856
    s_nop 0
    buffer_load_dwordx4 v57, s[20:23], s51 offen offset:0 lds
    buffer_load_dwordx4 v58, s[20:23], s51 offen offset:1024 lds
    s_add_u32 s51, s51, 128
    s_cmp_ge_u32 s51, s55
    s_cselect_b32 s54, 1280, 0
    s_sub_u32 s51, s51, s54
    s_mov_b32 s36, s18
    s_and_b32 s37, s19, 0xffff
    s_mov_b32 s38, 34627584
    s_mov_b32 s39, 0x20000
    s_mov_b32 s32, s12
    s_and_b32 s33, s13, 0xffff
    s_mov_b32 s34, 5242880
    s_mov_b32 s35, 0x20000
    s_lshl_b32 s48, s41, 4
    s_add_u32 s48, s48, s42
    s_lshl_b32 s48, s48, 18
    s_add_u32 s80, s6, s48
    s_addc_u32 s81, s7, 0
    s_and_b32 s81, s81, 0xffff
    s_mov_b32 s82, 262144
    s_mov_b32 s83, 0x20000
    s_add_u32 s84, s8, s48
    s_addc_u32 s85, s9, 0
    s_and_b32 s85, s85, 0xffff
    s_mov_b32 s86, 262144
    s_mov_b32 s87, 0x20000
    v_xor_b32 v33, v3, v1
    v_lshlrev_b32 v33, 4, v33
    v_lshl_add_u32 v16, v1, 8, v33
    s_lshl_b32 s48, s47, 7
    v_xor_b32 v16, s48, v16
    v_xor_b32 v17, 64, v16
    v_lshl_add_u32 v18, v1, 8, v22
    v_xor_b32 v19, 0x80, v18
    s_lshl_b32 s74, s40, 11
    s_lshl_b32 s100, s44, 1
    s_lshr_b32 s48, s44, 3
    s_add_u32 s100, s100, s48
    s_and_b32 s100, s100, 15
    s_lshl_b32 s100, s100, 13
    s_add_u32 s101, s100, 8192
    s_and_b32 s101, s101, 0x1ffff
    s_add_u32 s100, s100, s74
    s_add_u32 s101, s101, s74
    s_mov_b32 s79, 0x1ffff
    v_lshrrev_b32 v33, 2, v3
    v_and_b32 v34, 3, v3
    v_lshlrev_b32 v34, 3, v34
    v_and_b32 v35, 1, v1
    v_lshl_or_b32 v35, v35, 2, v33
    v_lshl_add_u32 v35, v35, 5, v34
    v_lshl_add_u32 v36, v1, 3, v33
    v_lshl_add_u32 v36, v36, 8, v35
    s_lshl_b32 s48, s46, 13
    s_add_u32 s48, s48, 32768
    v_add_u32 v40, s48, v36
    v_xor_b32 v41, 32, v40
    v_xor_b32 v42, 64, v40
    v_xor_b32 v43, 96, v40
    v_xor_b32 v44, 128, v40
    v_xor_b32 v45, 160, v40
    v_xor_b32 v46, 192, v40
    v_xor_b32 v47, 224, v40
    v_lshl_add_u32 v36, v1, 2, v33
    v_lshl_add_u32 v37, v36, 8, v35
    s_lshl_b32 s48, s46, 13
    s_add_u32 s49, s48, 65536
    v_add_u32 v8, s49, v37
    v_xor_b32 v9, 32, v8
    v_xor_b32 v10, 64, v8
    v_xor_b32 v11, 96, v8
    v_xor_b32 v12, 128, v8
    v_xor_b32 v13, 160, v8
    v_xor_b32 v14, 192, v8
    v_xor_b32 v15, 224, v8
    v_mul_u32_u24 v38, 320, v36
    v_add_u32 v38, v38, v34
    v_and_b32 v33, 1, v1
    v_lshlrev_b32 v33, 1, v33
    v_lshrrev_b32 v34, 1, v1
    v_or_b32 v33, v33, v34
    v_xor_b32 v33, v33, v3
    v_lshlrev_b32 v33, 4, v33
    v_lshl_add_u32 v33, v3, 8, v33
    v_add_u32 v4, s48, v33
    v_xor_b32 v5, 64, v4
    v_xor_b32 v6, 128, v4
    v_xor_b32 v7, 192, v4
    v_xor_b32 v33, v20, v1
    v_lshlrev_b32 v33, 4, v33
    v_lshl_add_u32 v33, v3, 7, v33
    s_mul_i32 s48, s47, 10240
    s_add_u32 s48, s48, 118784
    v_add_u32 v48, s48, v33
    v_xor_b32 v49, 64, v48
    v_lshlrev_b32 v90, 4, v2
    v_add_u32 v91, 4096, v90
    v_mov_b32 v92, 0
    s_lshr_b32 s88, s42, 2
    s_and_b32 s89, s42, 3
    s_lshl_b32 s91, s41, 2
    s_add_u32 s91, s91, s88
    s_lshl_b32 s91, s91, 7
    s_add_u32 s91, s91, 34603008
    s_lshl_b32 s48, s89, 2
    s_add_u32 s78, s91, s48
    s_mul_i32 s48, s46, 10
    v_add_u32 v33, 0, v2
    v_mul_u32_u24 v34, 3277, v33
    v_lshrrev_b32 v34, 16, v34
    v_mul_u32_u24 v35, 20, v34
    v_sub_u32 v33, v33, v35
    v_lshrrev_b32 v35, 1, v34
    v_and_b32 v35, 2, v35
    v_xor_b32 v33, v33, v35
    v_add_u32 v33, s48, v33
    v_subrev_u32 v35, 20, v33
    v_min_u32 v33, v33, v35
    v_mul_u32_u24 v34, 1280, v34
    v_lshl_add_u32 v64, v33, 4, v34
    v_add_u32 v33, 64, v2
    v_mul_u32_u24 v34, 3277, v33
    v_lshrrev_b32 v34, 16, v34
    v_mul_u32_u24 v35, 20, v34
    v_sub_u32 v33, v33, v35
    v_lshrrev_b32 v35, 1, v34
    v_and_b32 v35, 2, v35
    v_xor_b32 v33, v33, v35
    v_add_u32 v33, s48, v33
    v_subrev_u32 v35, 20, v33
    v_min_u32 v33, v33, v35
    v_mul_u32_u24 v34, 1280, v34
    v_lshl_add_u32 v65, v33, 4, v34
    v_subrev_u32 v65, 1024, v65
    v_add_u32 v33, 128, v2
    v_mul_u32_u24 v34, 3277, v33
    v_lshrrev_b32 v34, 16, v34
    v_mul_u32_u24 v35, 20, v34
    v_sub_u32 v33, v33, v35
    v_lshrrev_b32 v35, 1, v34
    v_and_b32 v35, 2, v35
    v_xor_b32 v33, v33, v35
    v_add_u32 v33, s48, v33
    v_subrev_u32 v35, 20, v33
    v_min_u32 v33, v33, v35
    v_mul_u32_u24 v34, 1280, v34
    v_lshl_add_u32 v66, v33, 4, v34
    v_subrev_u32 v66, 2048, v66
    v_add_u32 v33, 192, v2
    v_mul_u32_u24 v34, 3277, v33
    v_lshrrev_b32 v34, 16, v34
    v_mul_u32_u24 v35, 20, v34
    v_sub_u32 v33, v33, v35
    v_lshrrev_b32 v35, 1, v34
    v_and_b32 v35, 2, v35
    v_xor_b32 v33, v33, v35
    v_add_u32 v33, s48, v33
    v_subrev_u32 v35, 20, v33
    v_min_u32 v33, v33, v35
    v_mul_u32_u24 v34, 1280, v34
    v_lshl_add_u32 v67, v33, 4, v34
    v_subrev_u32 v67, 3072, v67
    v_add_u32 v33, 256, v2
    v_mul_u32_u24 v34, 3277, v33
    v_lshrrev_b32 v34, 16, v34
    v_mul_u32_u24 v35, 20, v34
    v_sub_u32 v33, v33, v35
    v_lshrrev_b32 v35, 1, v34
    v_and_b32 v35, 2, v35
    v_xor_b32 v33, v33, v35
    v_add_u32 v33, s48, v33
    v_subrev_u32 v35, 20, v33
    v_min_u32 v33, v33, v35
    v_mul_u32_u24 v34, 1280, v34
    v_lshl_add_u32 v68, v33, 4, v34
    s_lshl_b32 s48, s88, 3
    s_add_u32 s48, s48, s46
    s_mul_i32 s48, s48, 163840
    s_mul_i32 s49, s47, 20480
    s_add_u32 s48, s48, s49
    s_mul_i32 s49, s89, 320
    s_add_u32 s48, s48, s49
    s_lshl_b32 s93, s88, 5
    s_add_u32 s93, s93, s44
    s_lshl_b32 s93, s93, 2
    s_add_u32 s93, s93, s40
    s_mul_i32 s93, s93, 10240
    s_mul_i32 s49, s89, 327680
    s_add_u32 s60, s48, s49
    s_cmp_lt_u32 s89, 1
    s_cselect_b32 s49, 1, 0
    s_mul_i32 s49, s49, 327680
    s_add_u32 s61, s48, s49
    s_cmp_lt_u32 s89, 2
    s_cselect_b32 s49, 2, 1
    s_mul_i32 s49, s49, 327680
    s_add_u32 s64, s48, s49
    s_cmp_lt_u32 s89, 3
    s_cselect_b32 s49, 3, 2
    s_mul_i32 s49, s49, 327680
    s_add_u32 s65, s48, s49
    s_mul_i32 s62, s46, 0x18000
    s_xor_b32 s63, s62, 0x8000
    s_lshl_b32 s92, s46, 14
    s_add_u32 s92, s92, 0x20000
    v_and_b32 v33, 1, v1
    v_lshlrev_b32 v33, 5, v33
    v_add_u32 v34, v38, v33
    v_sub_u32 v35, v38, v33
    v_add_u32 v0, s92, v34
    v_add_u32 v1, s92, v35
    v_add_u32 v89, s62, v34
    v_add_u32 v94, s62, v35
    v_add_u32 v3, s63, v34
    v_add_u32 v2, s63, v35
    s_mul_i32 s48, s47, 5120
    s_add_u32 s62, s62, s48
    s_add_u32 s63, s63, s48
    s_add_u32 s92, s92, s48
    s_mov_b32 s8, s14
    s_and_b32 s9, s15, 0xffff
    s_mov_b32 s10, 3276800
    s_mov_b32 s11, 0x20000
    s_mov_b64 vcc, 0
    v_mov_b32 v84, 0
    v_mov_b32 v85, 0
    v_mov_b32 v86, 0
    s_add_u32 m0, s52, 49152
    s_nop 0
    buffer_load_dwordx4 v50, s[24:27], s50 offen offset:0 lds
    buffer_load_dwordx4 v51, s[24:27], s50 offen offset:1024 lds
    buffer_load_dwordx4 v52, s[24:27], s50 offen offset:2048 lds
    buffer_load_dwordx4 v53, s[24:27], s50 offen offset:3072 lds
    s_add_u32 s50, s50, 262144
    s_cmp_ge_u32 s50, 5242880
    s_cselect_b32 s54, 5242880, 0
    s_sub_u32 s50, s50, s54
    s_add_u32 m0, s57, 139264
    s_nop 0
    buffer_load_dwordx4 v54, s[20:23], s51 offen offset:0 lds
    buffer_load_dwordx4 v55, s[20:23], s51 offen offset:1024 lds
    buffer_load_dwordx4 v56, s[20:23], s51 offen offset:2048 lds
    s_add_u32 m0, s57, 142336
    s_nop 0
    buffer_load_dwordx4 v57, s[20:23], s51 offen offset:0 lds
    buffer_load_dwordx4 v58, s[20:23], s51 offen offset:1024 lds
    s_add_u32 s51, s51, 128
    s_cmp_ge_u32 s51, s55
    s_cselect_b32 s54, 1280, 0
    s_sub_u32 s51, s51, s54
    s_add_u32 m0, s52, 65536
    s_nop 0
    buffer_load_dwordx4 v50, s[24:27], s50 offen offset:0 lds
    buffer_load_dwordx4 v51, s[24:27], s50 offen offset:1024 lds
    buffer_load_dwordx4 v52, s[24:27], s50 offen offset:2048 lds
    buffer_load_dwordx4 v53, s[24:27], s50 offen offset:3072 lds
    s_add_u32 s50, s50, 262144
    s_mov_b32 s76, 0
    s_waitcnt lgkmcnt(0)
    s_mul_i32 s30, s30, 0x9E3779B1
    s_add_u32 s30, s30, 0x7F4A7C15
    s_mov_b32 s31, 1
    v_mov_b32 v93, s30
    s_waitcnt vmcnt(13)
    s_barrier
    ds_read_b128 a[64:67], v48 offset:0
    ds_read_b128 a[68:71], v48 offset:2048
    ds_read_b128 a[72:75], v48 offset:4096
    ds_read_b128 a[76:79], v48 offset:6144
    ds_read_b128 a[228:231], v48 offset:8192
    ds_read_b64_tr_b16 a[0:1], v40 offset:0
    ds_read_b64_tr_b16 a[2:3], v40 offset:1024
    ds_read_b64_tr_b16 a[4:5], v41 offset:0
    ds_read_b64_tr_b16 a[6:7], v41 offset:1024
    ds_read_b64_tr_b16 a[8:9], v42 offset:0
    ds_read_b64_tr_b16 a[10:11], v42 offset:1024
    ds_read_b64_tr_b16 a[12:13], v43 offset:0
    ds_read_b64_tr_b16 a[14:15], v43 offset:1024
    ds_read_b64_tr_b16 a[16:17], v44 offset:0
    ds_read_b64_tr_b16 a[18:19], v44 offset:1024
    ds_read_b64_tr_b16 a[20:21], v45 offset:0
    ds_read_b64_tr_b16 a[22:23], v45 offset:1024
    ds_read_b64_tr_b16 a[24:25], v46 offset:0
    ds_read_b64_tr_b16 a[26:27], v46 offset:1024
    ds_read_b64_tr_b16 a[28:29], v47 offset:0
    ds_read_b64_tr_b16 a[30:31], v47 offset:1024
    ds_read_b128 a[232:235], v49 offset:0
    ds_read_b128 a[236:239], v49 offset:2048
    ds_read_b128 a[240:243], v49 offset:4096
    ds_read_b128 a[244:247], v49 offset:6144
    ds_read_b128 a[248:251], v49 offset:8192
    s_waitcnt lgkmcnt(1)
    v_mfma_f32_16x16x32_bf16 v[96:99], a[0:3], a[64:67], 0
    v_mfma_f32_16x16x32_bf16 v[100:103], a[4:7], a[64:67], 0
    v_mfma_f32_16x16x32_bf16 v[104:107], a[8:11], a[64:67], 0
    v_mfma_f32_16x16x32_bf16 v[108:111], a[12:15], a[64:67], 0
    v_mfma_f32_16x16x32_bf16 v[112:115], a[16:19], a[64:67], 0
    v_mfma_f32_16x16x32_bf16 v[116:119], a[20:23], a[64:67], 0
    s_waitcnt vmcnt(9) lgkmcnt(0)
    v_mfma_f32_16x16x32_bf16 v[120:123], a[24:27], a[64:67], 0
    s_barrier
    v_mfma_f32_16x16x32_bf16 v[124:127], a[28:31], a[64:67], 0
    ds_read_b64_tr_b16 a[32:33], v40 offset:16384
    ds_read_b64_tr_b16 a[34:35], v40 offset:17408
    v_mfma_f32_16x16x32_bf16 v[128:131], a[0:3], a[68:71], 0
    s_add_u32 m0, s52, 81920
    ds_read_b64_tr_b16 a[36:37], v41 offset:16384
    ds_read_b64_tr_b16 a[38:39], v41 offset:17408
    v_mfma_f32_16x16x32_bf16 v[132:135], a[4:7], a[68:71], 0
    buffer_load_dwordx4 v50, s[24:27], s50 offen offset:0 lds
    v_mfma_f32_16x16x32_bf16 v[136:139], a[8:11], a[68:71], 0
    ds_read_b64_tr_b16 a[40:41], v42 offset:16384
    ds_read_b64_tr_b16 a[42:43], v42 offset:17408
    v_mfma_f32_16x16x32_bf16 v[140:143], a[12:15], a[68:71], 0
    buffer_load_dwordx4 v51, s[24:27], s50 offen offset:1024 lds
    v_mfma_f32_16x16x32_bf16 v[144:147], a[16:19], a[68:71], 0
    ds_read_b64_tr_b16 a[44:45], v43 offset:16384
    ds_read_b64_tr_b16 a[46:47], v43 offset:17408
    v_mfma_f32_16x16x32_bf16 v[148:151], a[20:23], a[68:71], 0
    buffer_load_dwordx4 v52, s[24:27], s50 offen offset:2048 lds
    v_mfma_f32_16x16x32_bf16 v[152:155], a[24:27], a[68:71], 0
    ds_read_b64_tr_b16 a[48:49], v44 offset:16384
    ds_read_b64_tr_b16 a[50:51], v44 offset:17408
    v_mfma_f32_16x16x32_bf16 v[156:159], a[28:31], a[68:71], 0
    buffer_load_dwordx4 v53, s[24:27], s50 offen offset:3072 lds
    v_mfma_f32_16x16x32_bf16 v[160:163], a[0:3], a[72:75], 0
    s_add_u32 s50, s50, 262144
    s_cmp_ge_u32 s50, 5242880
    s_cselect_b32 s54, 5242880, 0
    s_sub_u32 s50, s50, s54
    s_add_u32 m0, s57, 118784
    v_mfma_f32_16x16x32_bf16 v[164:167], a[4:7], a[72:75], 0
    buffer_load_dwordx4 v54, s[20:23], s51 offen offset:0 lds
    v_mfma_f32_16x16x32_bf16 v[168:171], a[8:11], a[72:75], 0
    ds_read_b64_tr_b16 a[52:53], v45 offset:16384
    ds_read_b64_tr_b16 a[54:55], v45 offset:17408
    v_mfma_f32_16x16x32_bf16 v[172:175], a[12:15], a[72:75], 0
    buffer_load_dwordx4 v55, s[20:23], s51 offen offset:1024 lds
    v_mfma_f32_16x16x32_bf16 v[176:179], a[16:19], a[72:75], 0
    ds_read_b64_tr_b16 a[56:57], v46 offset:16384
    ds_read_b64_tr_b16 a[58:59], v46 offset:17408
    v_mfma_f32_16x16x32_bf16 v[180:183], a[20:23], a[72:75], 0
    buffer_load_dwordx4 v56, s[20:23], s51 offen offset:2048 lds
    v_mfma_f32_16x16x32_bf16 v[184:187], a[24:27], a[72:75], 0
    s_add_u32 m0, s57, 121856
    ds_read_b64_tr_b16 a[60:61], v47 offset:16384
    ds_read_b64_tr_b16 a[62:63], v47 offset:17408
    v_mfma_f32_16x16x32_bf16 v[188:191], a[28:31], a[72:75], 0
    v_mfma_f32_16x16x32_bf16 v[192:195], a[0:3], a[76:79], 0
    buffer_load_dwordx4 v57, s[20:23], s51 offen offset:0 lds
    v_mfma_f32_16x16x32_bf16 v[196:199], a[4:7], a[76:79], 0
    v_mfma_f32_16x16x32_bf16 v[200:203], a[8:11], a[76:79], 0
    buffer_load_dwordx4 v58, s[20:23], s51 offen offset:1024 lds
    v_mfma_f32_16x16x32_bf16 v[204:207], a[12:15], a[76:79], 0
    s_add_u32 s51, s51, 128
    s_cmp_ge_u32 s51, s55
    s_cselect_b32 s54, 1280, 0
    s_sub_u32 s51, s51, s54
    s_add_u32 m0, s52, 32768
    v_mfma_f32_16x16x32_bf16 v[208:211], a[16:19], a[76:79], 0
    buffer_load_dwordx4 v50, s[24:27], s50 offen offset:0 lds
    v_mfma_f32_16x16x32_bf16 v[212:215], a[20:23], a[76:79], 0
    v_mfma_f32_16x16x32_bf16 v[216:219], a[24:27], a[76:79], 0
    buffer_load_dwordx4 v51, s[24:27], s50 offen offset:1024 lds
    v_mfma_f32_16x16x32_bf16 v[220:223], a[28:31], a[76:79], 0
    v_mfma_f32_16x16x32_bf16 v[224:227], a[0:3], a[228:231], 0
    buffer_load_dwordx4 v52, s[24:27], s50 offen offset:2048 lds
    v_mfma_f32_16x16x32_bf16 v[228:231], a[4:7], a[228:231], 0
    v_mfma_f32_16x16x32_bf16 v[232:235], a[8:11], a[228:231], 0
    buffer_load_dwordx4 v53, s[24:27], s50 offen offset:3072 lds
    v_mfma_f32_16x16x32_bf16 v[236:239], a[12:15], a[228:231], 0
    s_add_u32 s50, s50, 262144
    v_mfma_f32_16x16x32_bf16 v[240:243], a[16:19], a[228:231], 0
    v_mfma_f32_16x16x32_bf16 v[244:247], a[20:23], a[228:231], 0
    v_mfma_f32_16x16x32_bf16 v[248:251], a[24:27], a[228:231], 0
    v_mfma_f32_16x16x32_bf16 v[252:255], a[28:31], a[228:231], 0
    s_waitcnt lgkmcnt(0)
    v_mfma_f32_16x16x32_bf16 v[96:99], a[32:35], a[232:235], v[96:99]
    s_waitcnt vmcnt(13) lgkmcnt(0)
    v_mfma_f32_16x16x32_bf16 v[100:103], a[36:39], a[232:235], v[100:103]
    s_barrier
    v_mfma_f32_16x16x32_bf16 v[104:107], a[40:43], a[232:235], v[104:107]
    ds_read_b128 a[64:67], v48 offset:20480
    ds_read_b128 a[68:71], v48 offset:22528
    v_mfma_f32_16x16x32_bf16 v[108:111], a[44:47], a[232:235], v[108:111]
    s_add_u32 m0, s52, 49152
    ds_read_b128 a[72:75], v48 offset:24576
    ds_read_b128 a[76:79], v48 offset:26624
    v_mfma_f32_16x16x32_bf16 v[112:115], a[48:51], a[232:235], v[112:115]
    buffer_load_dwordx4 v50, s[24:27], s50 offen offset:0 lds
    v_mfma_f32_16x16x32_bf16 v[116:119], a[52:55], a[232:235], v[116:119]
    ds_read_b128 a[228:231], v48 offset:28672
    ds_read_b64_tr_b16 a[0:1], v40 offset:32768
    v_mfma_f32_16x16x32_bf16 v[120:123], a[56:59], a[232:235], v[120:123]
    ds_read_b64_tr_b16 a[2:3], v40 offset:33792
    ds_read_b64_tr_b16 a[4:5], v41 offset:32768
    v_mfma_f32_16x16x32_bf16 v[124:127], a[60:63], a[232:235], v[124:127]
    ds_read_b64_tr_b16 a[6:7], v41 offset:33792
    ds_read_b64_tr_b16 a[8:9], v42 offset:32768
    v_mfma_f32_16x16x32_bf16 v[128:131], a[32:35], a[236:239], v[128:131]
    buffer_load_dwordx4 v51, s[24:27], s50 offen offset:1024 lds
    v_mfma_f32_16x16x32_bf16 v[132:135], a[36:39], a[236:239], v[132:135]
    ds_read_b128 a[232:235], v49 offset:20480
    ds_read_b64_tr_b16 a[10:11], v42 offset:33792
    v_mfma_f32_16x16x32_bf16 v[136:139], a[40:43], a[236:239], v[136:139]
    ds_read_b64_tr_b16 a[12:13], v43 offset:32768
    ds_read_b64_tr_b16 a[14:15], v43 offset:33792
    v_mfma_f32_16x16x32_bf16 v[140:143], a[44:47], a[236:239], v[140:143]
    ds_read_b64_tr_b16 a[16:17], v44 offset:32768
    ds_read_b64_tr_b16 a[18:19], v44 offset:33792
    v_mfma_f32_16x16x32_bf16 v[144:147], a[48:51], a[236:239], v[144:147]
    buffer_load_dwordx4 v52, s[24:27], s50 offen offset:2048 lds
    v_mfma_f32_16x16x32_bf16 v[148:151], a[52:55], a[236:239], v[148:151]
    ds_read_b64_tr_b16 a[20:21], v45 offset:32768
    ds_read_b64_tr_b16 a[22:23], v45 offset:33792
    v_mfma_f32_16x16x32_bf16 v[152:155], a[56:59], a[236:239], v[152:155]
    ds_read_b64_tr_b16 a[24:25], v46 offset:32768
    ds_read_b64_tr_b16 a[26:27], v46 offset:33792
    v_mfma_f32_16x16x32_bf16 v[156:159], a[60:63], a[236:239], v[156:159]
    ds_read_b64_tr_b16 a[28:29], v47 offset:32768
    ds_read_b64_tr_b16 a[30:31], v47 offset:33792
    v_mfma_f32_16x16x32_bf16 v[160:163], a[32:35], a[240:243], v[160:163]
    buffer_load_dwordx4 v53, s[24:27], s50 offen offset:3072 lds
    v_mfma_f32_16x16x32_bf16 v[164:167], a[36:39], a[240:243], v[164:167]
    s_add_u32 s50, s50, 262144
    s_cmp_ge_u32 s50, 5242880
    s_cselect_b32 s54, 5242880, 0
    ds_read_b128 a[236:239], v49 offset:22528
    v_mfma_f32_16x16x32_bf16 v[168:171], a[40:43], a[240:243], v[168:171]
    s_sub_u32 s50, s50, s54
    s_add_u32 s75, s100, 0
    v_mfma_f32_16x16x32_bf16 v[172:175], a[44:47], a[240:243], v[172:175]
    s_and_b32 s75, s75, s79
    s_add_u32 m0, s74, 0
    v_mfma_f32_16x16x32_bf16 v[176:179], a[48:51], a[240:243], v[176:179]
    buffer_load_dwordx4 v16, s[80:83], s75 offen offset:0 nt lds
    v_mfma_f32_16x16x32_bf16 v[180:183], a[52:55], a[240:243], v[180:183]
    v_mfma_f32_16x16x32_bf16 v[184:187], a[56:59], a[240:243], v[184:187]
    v_mfma_f32_16x16x32_bf16 v[188:191], a[60:63], a[240:243], v[188:191]
    v_mfma_f32_16x16x32_bf16 v[192:195], a[32:35], a[244:247], v[192:195]
    buffer_load_dwordx4 v17, s[80:83], s75 offen offset:1024 nt lds
    v_mfma_f32_16x16x32_bf16 v[196:199], a[36:39], a[244:247], v[196:199]
    s_add_u32 s75, s101, 0
    s_and_b32 s75, s75, s79
    ds_read_b128 a[240:243], v49 offset:24576
    v_mfma_f32_16x16x32_bf16 v[200:203], a[40:43], a[244:247], v[200:203]
    s_add_u32 s75, s75, 131072
    v_mfma_f32_16x16x32_bf16 v[204:207], a[44:47], a[244:247], v[204:207]
    s_add_u32 m0, s74, 8192
    v_mfma_f32_16x16x32_bf16 v[208:211], a[48:51], a[244:247], v[208:211]
    buffer_load_dwordx4 v16, s[80:83], s75 offen offset:0 nt lds
    v_mfma_f32_16x16x32_bf16 v[212:215], a[52:55], a[244:247], v[212:215]
    v_mfma_f32_16x16x32_bf16 v[216:219], a[56:59], a[244:247], v[216:219]
    v_mfma_f32_16x16x32_bf16 v[220:223], a[60:63], a[244:247], v[220:223]
    v_mfma_f32_16x16x32_bf16 v[224:227], a[32:35], a[248:251], v[224:227]
    buffer_load_dwordx4 v17, s[80:83], s75 offen offset:1024 nt lds
    v_mfma_f32_16x16x32_bf16 v[228:231], a[36:39], a[248:251], v[228:231]
    ds_read_b128 a[244:247], v49 offset:26624
    v_mfma_f32_16x16x32_bf16 v[232:235], a[40:43], a[248:251], v[232:235]
    v_mfma_f32_16x16x32_bf16 v[236:239], a[44:47], a[248:251], v[236:239]
    v_mfma_f32_16x16x32_bf16 v[240:243], a[48:51], a[248:251], v[240:243]
    v_mfma_f32_16x16x32_bf16 v[244:247], a[52:55], a[248:251], v[244:247]
    v_mfma_f32_16x16x32_bf16 v[248:251], a[56:59], a[248:251], v[248:251]
    v_mfma_f32_16x16x32_bf16 v[252:255], a[60:63], a[248:251], v[252:255]
    ds_read_b128 a[248:251], v49 offset:28672
    s_waitcnt lgkmcnt(1)
    v_mfma_f32_16x16x32_bf16 v[96:99], a[0:3], a[64:67], v[96:99]
    v_mfma_f32_16x16x32_bf16 v[100:103], a[4:7], a[64:67], v[100:103]
    v_mfma_f32_16x16x32_bf16 v[104:107], a[8:11], a[64:67], v[104:107]
    v_mfma_f32_16x16x32_bf16 v[108:111], a[12:15], a[64:67], v[108:111]
    v_mfma_f32_16x16x32_bf16 v[112:115], a[16:19], a[64:67], v[112:115]
    v_mfma_f32_16x16x32_bf16 v[116:119], a[20:23], a[64:67], v[116:119]
    s_waitcnt vmcnt(17) lgkmcnt(0)
    v_mfma_f32_16x16x32_bf16 v[120:123], a[24:27], a[64:67], v[120:123]
    s_barrier
    v_mfma_f32_16x16x32_bf16 v[124:127], a[28:31], a[64:67], v[124:127]
    ds_read_b64_tr_b16 a[32:33], v40 offset:49152
    ds_read_b64_tr_b16 a[34:35], v40 offset:50176
    v_mfma_f32_16x16x32_bf16 v[128:131], a[0:3], a[68:71], v[128:131]
    s_add_u32 m0, s57, 139264
    ds_read_b64_tr_b16 a[36:37], v41 offset:49152
    ds_read_b64_tr_b16 a[38:39], v41 offset:50176
    v_mfma_f32_16x16x32_bf16 v[132:135], a[4:7], a[68:71], v[132:135]
    buffer_load_dwordx4 v54, s[20:23], s51 offen offset:0 lds
    v_mfma_f32_16x16x32_bf16 v[136:139], a[8:11], a[68:71], v[136:139]
    ds_read_b64_tr_b16 a[40:41], v42 offset:49152
    ds_read_b64_tr_b16 a[42:43], v42 offset:50176
    v_mfma_f32_16x16x32_bf16 v[140:143], a[12:15], a[68:71], v[140:143]
    ds_read_b64_tr_b16 a[44:45], v43 offset:49152
    ds_read_b64_tr_b16 a[46:47], v43 offset:50176
    v_mfma_f32_16x16x32_bf16 v[144:147], a[16:19], a[68:71], v[144:147]
    buffer_load_dwordx4 v55, s[20:23], s51 offen offset:1024 lds
    v_mfma_f32_16x16x32_bf16 v[148:151], a[20:23], a[68:71], v[148:151]
    ds_read_b64_tr_b16 a[48:49], v44 offset:49152
    ds_read_b64_tr_b16 a[50:51], v44 offset:50176
    v_mfma_f32_16x16x32_bf16 v[152:155], a[24:27], a[68:71], v[152:155]
    ds_read_b64_tr_b16 a[52:53], v45 offset:49152
    ds_read_b64_tr_b16 a[54:55], v45 offset:50176
    v_mfma_f32_16x16x32_bf16 v[156:159], a[28:31], a[68:71], v[156:159]
    buffer_load_dwordx4 v56, s[20:23], s51 offen offset:2048 lds
    v_mfma_f32_16x16x32_bf16 v[160:163], a[0:3], a[72:75], v[160:163]
    s_add_u32 m0, s57, 142336
    ds_read_b64_tr_b16 a[56:57], v46 offset:49152
    ds_read_b64_tr_b16 a[58:59], v46 offset:50176
    v_mfma_f32_16x16x32_bf16 v[164:167], a[4:7], a[72:75], v[164:167]
    ds_read_b64_tr_b16 a[60:61], v47 offset:49152
    ds_read_b64_tr_b16 a[62:63], v47 offset:50176
    v_mfma_f32_16x16x32_bf16 v[168:171], a[8:11], a[72:75], v[168:171]
    buffer_load_dwordx4 v57, s[20:23], s51 offen offset:0 lds
    v_mfma_f32_16x16x32_bf16 v[172:175], a[12:15], a[72:75], v[172:175]
    v_mfma_f32_16x16x32_bf16 v[176:179], a[16:19], a[72:75], v[176:179]
    v_mfma_f32_16x16x32_bf16 v[180:183], a[20:23], a[72:75], v[180:183]
    buffer_load_dwordx4 v58, s[20:23], s51 offen offset:1024 lds
    v_mfma_f32_16x16x32_bf16 v[184:187], a[24:27], a[72:75], v[184:187]
    s_add_u32 s51, s51, 128
    s_cmp_ge_u32 s51, s55
    s_cselect_b32 s54, 1280, 0
    v_mfma_f32_16x16x32_bf16 v[188:191], a[28:31], a[72:75], v[188:191]
    s_sub_u32 s51, s51, s54
    s_add_u32 m0, s52, 65536
    v_mfma_f32_16x16x32_bf16 v[192:195], a[0:3], a[76:79], v[192:195]
    buffer_load_dwordx4 v50, s[24:27], s50 offen offset:0 lds
    v_mfma_f32_16x16x32_bf16 v[196:199], a[4:7], a[76:79], v[196:199]
    v_mfma_f32_16x16x32_bf16 v[200:203], a[8:11], a[76:79], v[200:203]
    v_mfma_f32_16x16x32_bf16 v[204:207], a[12:15], a[76:79], v[204:207]
    buffer_load_dwordx4 v51, s[24:27], s50 offen offset:1024 lds
    v_mfma_f32_16x16x32_bf16 v[208:211], a[16:19], a[76:79], v[208:211]
    v_mfma_f32_16x16x32_bf16 v[212:215], a[20:23], a[76:79], v[212:215]
    v_mfma_f32_16x16x32_bf16 v[216:219], a[24:27], a[76:79], v[216:219]
    buffer_load_dwordx4 v52, s[24:27], s50 offen offset:2048 lds
    v_mfma_f32_16x16x32_bf16 v[220:223], a[28:31], a[76:79], v[220:223]
    v_mfma_f32_16x16x32_bf16 v[224:227], a[0:3], a[228:231], v[224:227]
    v_mfma_f32_16x16x32_bf16 v[228:231], a[4:7], a[228:231], v[228:231]
    buffer_load_dwordx4 v53, s[24:27], s50 offen offset:3072 lds
    v_mfma_f32_16x16x32_bf16 v[232:235], a[8:11], a[228:231], v[232:235]
    s_add_u32 s50, s50, 262144
    v_mfma_f32_16x16x32_bf16 v[236:239], a[12:15], a[228:231], v[236:239]
    v_mfma_f32_16x16x32_bf16 v[240:243], a[16:19], a[228:231], v[240:243]
    v_mfma_f32_16x16x32_bf16 v[244:247], a[20:23], a[228:231], v[244:247]
    v_mfma_f32_16x16x32_bf16 v[248:251], a[24:27], a[228:231], v[248:251]
    v_mfma_f32_16x16x32_bf16 v[252:255], a[28:31], a[228:231], v[252:255]
    s_waitcnt lgkmcnt(0)
    v_mfma_f32_16x16x32_bf16 v[96:99], a[32:35], a[232:235], v[96:99]
    s_waitcnt vmcnt(17) lgkmcnt(0)
    v_mfma_f32_16x16x32_bf16 v[100:103], a[36:39], a[232:235], v[100:103]
    s_barrier
    v_mfma_f32_16x16x32_bf16 v[104:107], a[40:43], a[232:235], v[104:107]
    ds_read_b128 a[64:67], v48 offset:0
    ds_read_b128 a[68:71], v48 offset:2048
    v_mfma_f32_16x16x32_bf16 v[108:111], a[44:47], a[232:235], v[108:111]
    s_add_u32 m0, s52, 81920
    ds_read_b128 a[72:75], v48 offset:4096
    ds_read_b128 a[76:79], v48 offset:6144
    v_mfma_f32_16x16x32_bf16 v[112:115], a[48:51], a[232:235], v[112:115]
    buffer_load_dwordx4 v50, s[24:27], s50 offen offset:0 lds
    v_mfma_f32_16x16x32_bf16 v[116:119], a[52:55], a[232:235], v[116:119]
    ds_read_b128 a[228:231], v48 offset:8192
    ds_read_b64_tr_b16 a[0:1], v40 offset:0
    v_mfma_f32_16x16x32_bf16 v[120:123], a[56:59], a[232:235], v[120:123]
    ds_read_b64_tr_b16 a[2:3], v40 offset:1024
    ds_read_b64_tr_b16 a[4:5], v41 offset:0
    v_mfma_f32_16x16x32_bf16 v[124:127], a[60:63], a[232:235], v[124:127]
    ds_read_b64_tr_b16 a[6:7], v41 offset:1024
    ds_read_b64_tr_b16 a[8:9], v42 offset:0
    v_mfma_f32_16x16x32_bf16 v[128:131], a[32:35], a[236:239], v[128:131]
    ds_read_b128 a[232:235], v49 offset:0
    ds_read_b64_tr_b16 a[10:11], v42 offset:1024
    v_mfma_f32_16x16x32_bf16 v[132:135], a[36:39], a[236:239], v[132:135]
    ds_read_b64_tr_b16 a[12:13], v43 offset:0
    ds_read_b64_tr_b16 a[14:15], v43 offset:1024
    v_mfma_f32_16x16x32_bf16 v[136:139], a[40:43], a[236:239], v[136:139]
    ds_read_b64_tr_b16 a[16:17], v44 offset:0
    ds_read_b64_tr_b16 a[18:19], v44 offset:1024
    v_mfma_f32_16x16x32_bf16 v[140:143], a[44:47], a[236:239], v[140:143]
    ds_read_b64_tr_b16 a[20:21], v45 offset:0
    ds_read_b64_tr_b16 a[22:23], v45 offset:1024
    v_mfma_f32_16x16x32_bf16 v[144:147], a[48:51], a[236:239], v[144:147]
    buffer_load_dwordx4 v51, s[24:27], s50 offen offset:1024 lds
    v_mfma_f32_16x16x32_bf16 v[148:151], a[52:55], a[236:239], v[148:151]
    ds_read_b64_tr_b16 a[24:25], v46 offset:0
    ds_read_b64_tr_b16 a[26:27], v46 offset:1024
    v_mfma_f32_16x16x32_bf16 v[152:155], a[56:59], a[236:239], v[152:155]
    ds_read_b64_tr_b16 a[28:29], v47 offset:0
    ds_read_b64_tr_b16 a[30:31], v47 offset:1024
    v_mfma_f32_16x16x32_bf16 v[156:159], a[60:63], a[236:239], v[156:159]
    v_mfma_f32_16x16x32_bf16 v[160:163], a[32:35], a[240:243], v[160:163]
    ds_read_b128 a[236:239], v49 offset:2048
    v_mfma_f32_16x16x32_bf16 v[164:167], a[36:39], a[240:243], v[164:167]
    v_mfma_f32_16x16x32_bf16 v[168:171], a[40:43], a[240:243], v[168:171]
    v_mfma_f32_16x16x32_bf16 v[172:175], a[44:47], a[240:243], v[172:175]
    v_mfma_f32_16x16x32_bf16 v[176:179], a[48:51], a[240:243], v[176:179]
    buffer_load_dwordx4 v52, s[24:27], s50 offen offset:2048 lds
    v_mfma_f32_16x16x32_bf16 v[180:183], a[52:55], a[240:243], v[180:183]
    v_mfma_f32_16x16x32_bf16 v[184:187], a[56:59], a[240:243], v[184:187]
    v_mfma_f32_16x16x32_bf16 v[188:191], a[60:63], a[240:243], v[188:191]
    v_mfma_f32_16x16x32_bf16 v[192:195], a[32:35], a[244:247], v[192:195]
    ds_read_b128 a[240:243], v49 offset:4096
    v_mfma_f32_16x16x32_bf16 v[196:199], a[36:39], a[244:247], v[196:199]
    v_mfma_f32_16x16x32_bf16 v[200:203], a[40:43], a[244:247], v[200:203]
    v_mfma_f32_16x16x32_bf16 v[204:207], a[44:47], a[244:247], v[204:207]
    v_mfma_f32_16x16x32_bf16 v[208:211], a[48:51], a[244:247], v[208:211]
    buffer_load_dwordx4 v53, s[24:27], s50 offen offset:3072 lds
    v_mfma_f32_16x16x32_bf16 v[212:215], a[52:55], a[244:247], v[212:215]
    s_add_u32 s50, s50, 262144
    v_mfma_f32_16x16x32_bf16 v[216:219], a[56:59], a[244:247], v[216:219]
    v_mfma_f32_16x16x32_bf16 v[220:223], a[60:63], a[244:247], v[220:223]
    s_cmp_ge_u32 s50, 5242880
    v_mfma_f32_16x16x32_bf16 v[224:227], a[32:35], a[248:251], v[224:227]
    ds_read_b128 a[244:247], v49 offset:6144
    v_mfma_f32_16x16x32_bf16 v[228:231], a[36:39], a[248:251], v[228:231]
    v_mfma_f32_16x16x32_bf16 v[232:235], a[40:43], a[248:251], v[232:235]
    s_cselect_b32 s54, 5242880, 0
    v_mfma_f32_16x16x32_bf16 v[236:239], a[44:47], a[248:251], v[236:239]
    v_mfma_f32_16x16x32_bf16 v[240:243], a[48:51], a[248:251], v[240:243]
    v_mfma_f32_16x16x32_bf16 v[244:247], a[52:55], a[248:251], v[244:247]
    s_sub_u32 s50, s50, s54
    v_mfma_f32_16x16x32_bf16 v[248:251], a[56:59], a[248:251], v[248:251]
    v_mfma_f32_16x16x32_bf16 v[252:255], a[60:63], a[248:251], v[252:255]
    ds_read_b128 a[248:251], v49 offset:8192
    s_waitcnt lgkmcnt(1)
    v_mfma_f32_16x16x32_bf16 v[96:99], a[0:3], a[64:67], v[96:99]
    v_mfma_f32_16x16x32_bf16 v[100:103], a[4:7], a[64:67], v[100:103]
    v_mfma_f32_16x16x32_bf16 v[104:107], a[8:11], a[64:67], v[104:107]
    v_mfma_f32_16x16x32_bf16 v[108:111], a[12:15], a[64:67], v[108:111]
    v_mfma_f32_16x16x32_bf16 v[112:115], a[16:19], a[64:67], v[112:115]
    v_mfma_f32_16x16x32_bf16 v[116:119], a[20:23], a[64:67], v[116:119]
    s_waitcnt vmcnt(17) lgkmcnt(0)
    v_mfma_f32_16x16x32_bf16 v[120:123], a[24:27], a[64:67], v[120:123]
    s_barrier
    v_mfma_f32_16x16x32_bf16 v[124:127], a[28:31], a[64:67], v[124:127]
    ds_read_b64_tr_b16 a[32:33], v40 offset:16384
    ds_read_b64_tr_b16 a[34:35], v40 offset:17408
    v_mfma_f32_16x16x32_bf16 v[128:131], a[0:3], a[68:71], v[128:131]
    s_add_u32 m0, s57, 118784
    ds_read_b64_tr_b16 a[36:37], v41 offset:16384
    ds_read_b64_tr_b16 a[38:39], v41 offset:17408
    v_mfma_f32_16x16x32_bf16 v[132:135], a[4:7], a[68:71], v[132:135]
    buffer_load_dwordx4 v54, s[20:23], s51 offen offset:0 lds
    v_mfma_f32_16x16x32_bf16 v[136:139], a[8:11], a[68:71], v[136:139]
    ds_read_b64_tr_b16 a[40:41], v42 offset:16384
    ds_read_b64_tr_b16 a[42:43], v42 offset:17408
    v_mfma_f32_16x16x32_bf16 v[140:143], a[12:15], a[68:71], v[140:143]
    ds_read_b64_tr_b16 a[44:45], v43 offset:16384
    ds_read_b64_tr_b16 a[46:47], v43 offset:17408
    v_mfma_f32_16x16x32_bf16 v[144:147], a[16:19], a[68:71], v[144:147]
    buffer_load_dwordx4 v55, s[20:23], s51 offen offset:1024 lds
    v_mfma_f32_16x16x32_bf16 v[148:151], a[20:23], a[68:71], v[148:151]
    ds_read_b64_tr_b16 a[48:49], v44 offset:16384
    ds_read_b64_tr_b16 a[50:51], v44 offset:17408
    v_mfma_f32_16x16x32_bf16 v[152:155], a[24:27], a[68:71], v[152:155]
    ds_read_b64_tr_b16 a[52:53], v45 offset:16384
    ds_read_b64_tr_b16 a[54:55], v45 offset:17408
    v_mfma_f32_16x16x32_bf16 v[156:159], a[28:31], a[68:71], v[156:159]
    buffer_load_dwordx4 v56, s[20:23], s51 offen offset:2048 lds
    v_mfma_f32_16x16x32_bf16 v[160:163], a[0:3], a[72:75], v[160:163]
    s_add_u32 m0, s57, 121856
    ds_read_b64_tr_b16 a[56:57], v46 offset:16384
    ds_read_b64_tr_b16 a[58:59], v46 offset:17408
    v_mfma_f32_16x16x32_bf16 v[164:167], a[4:7], a[72:75], v[164:167]
    ds_read_b64_tr_b16 a[60:61], v47 offset:16384
    ds_read_b64_tr_b16 a[62:63], v47 offset:17408
    v_mfma_f32_16x16x32_bf16 v[168:171], a[8:11], a[72:75], v[168:171]
    buffer_load_dwordx4 v57, s[20:23], s51 offen offset:0 lds
    v_mfma_f32_16x16x32_bf16 v[172:175], a[12:15], a[72:75], v[172:175]
    v_mfma_f32_16x16x32_bf16 v[176:179], a[16:19], a[72:75], v[176:179]
    v_mfma_f32_16x16x32_bf16 v[180:183], a[20:23], a[72:75], v[180:183]
    buffer_load_dwordx4 v58, s[20:23], s51 offen offset:1024 lds
    v_mfma_f32_16x16x32_bf16 v[184:187], a[24:27], a[72:75], v[184:187]
    s_add_u32 s51, s51, 128
    s_cmp_ge_u32 s51, s55
    s_cselect_b32 s54, 1280, 0
    v_mfma_f32_16x16x32_bf16 v[188:191], a[28:31], a[72:75], v[188:191]
    s_sub_u32 s51, s51, s54
    s_add_u32 m0, s52, 32768
    v_mfma_f32_16x16x32_bf16 v[192:195], a[0:3], a[76:79], v[192:195]
    buffer_load_dwordx4 v50, s[24:27], s50 offen offset:0 lds
    v_mfma_f32_16x16x32_bf16 v[196:199], a[4:7], a[76:79], v[196:199]
    v_mfma_f32_16x16x32_bf16 v[200:203], a[8:11], a[76:79], v[200:203]
    v_mfma_f32_16x16x32_bf16 v[204:207], a[12:15], a[76:79], v[204:207]
    buffer_load_dwordx4 v51, s[24:27], s50 offen offset:1024 lds
    v_mfma_f32_16x16x32_bf16 v[208:211], a[16:19], a[76:79], v[208:211]
    v_mfma_f32_16x16x32_bf16 v[212:215], a[20:23], a[76:79], v[212:215]
    v_mfma_f32_16x16x32_bf16 v[216:219], a[24:27], a[76:79], v[216:219]
    buffer_load_dwordx4 v52, s[24:27], s50 offen offset:2048 lds
    v_mfma_f32_16x16x32_bf16 v[220:223], a[28:31], a[76:79], v[220:223]
    v_mfma_f32_16x16x32_bf16 v[224:227], a[0:3], a[228:231], v[224:227]
    v_mfma_f32_16x16x32_bf16 v[228:231], a[4:7], a[228:231], v[228:231]
    buffer_load_dwordx4 v53, s[24:27], s50 offen offset:3072 lds
    v_mfma_f32_16x16x32_bf16 v[232:235], a[8:11], a[228:231], v[232:235]
    s_add_u32 s50, s50, 262144
    v_mfma_f32_16x16x32_bf16 v[236:239], a[12:15], a[228:231], v[236:239]
    v_mfma_f32_16x16x32_bf16 v[240:243], a[16:19], a[228:231], v[240:243]
    v_mfma_f32_16x16x32_bf16 v[244:247], a[20:23], a[228:231], v[244:247]
    v_mfma_f32_16x16x32_bf16 v[248:251], a[24:27], a[228:231], v[248:251]
    v_mfma_f32_16x16x32_bf16 v[252:255], a[28:31], a[228:231], v[252:255]
    s_waitcnt lgkmcnt(0)
    v_mfma_f32_16x16x32_bf16 v[96:99], a[32:35], a[232:235], v[96:99]
    s_waitcnt vmcnt(13) lgkmcnt(0)
    v_mfma_f32_16x16x32_bf16 v[100:103], a[36:39], a[232:235], v[100:103]
    s_barrier
    v_mfma_f32_16x16x32_bf16 v[104:107], a[40:43], a[232:235], v[104:107]
    ds_read_b128 a[64:67], v48 offset:20480
    ds_read_b128 a[68:71], v48 offset:22528
    v_mfma_f32_16x16x32_bf16 v[108:111], a[44:47], a[232:235], v[108:111]
    s_add_u32 m0, s52, 49152
    ds_read_b128 a[72:75], v48 offset:24576
    ds_read_b128 a[76:79], v48 offset:26624
    v_mfma_f32_16x16x32_bf16 v[112:115], a[48:51], a[232:235], v[112:115]
    buffer_load_dwordx4 v50, s[24:27], s50 offen offset:0 lds
    v_mfma_f32_16x16x32_bf16 v[116:119], a[52:55], a[232:235], v[116:119]
    ds_read_b128 a[228:231], v48 offset:28672
    ds_read_b64_tr_b16 a[0:1], v40 offset:32768
    v_mfma_f32_16x16x32_bf16 v[120:123], a[56:59], a[232:235], v[120:123]
    ds_read_b64_tr_b16 a[2:3], v40 offset:33792
    ds_read_b64_tr_b16 a[4:5], v41 offset:32768
    v_mfma_f32_16x16x32_bf16 v[124:127], a[60:63], a[232:235], v[124:127]
    ds_read_b64_tr_b16 a[6:7], v41 offset:33792
    ds_read_b64_tr_b16 a[8:9], v42 offset:32768
    v_mfma_f32_16x16x32_bf16 v[128:131], a[32:35], a[236:239], v[128:131]
    buffer_load_dwordx4 v51, s[24:27], s50 offen offset:1024 lds
    v_mfma_f32_16x16x32_bf16 v[132:135], a[36:39], a[236:239], v[132:135]
    ds_read_b128 a[232:235], v49 offset:20480
    ds_read_b64_tr_b16 a[10:11], v42 offset:33792
    v_mfma_f32_16x16x32_bf16 v[136:139], a[40:43], a[236:239], v[136:139]
    ds_read_b64_tr_b16 a[12:13], v43 offset:32768
    ds_read_b64_tr_b16 a[14:15], v43 offset:33792
    v_mfma_f32_16x16x32_bf16 v[140:143], a[44:47], a[236:239], v[140:143]
    ds_read_b64_tr_b16 a[16:17], v44 offset:32768
    ds_read_b64_tr_b16 a[18:19], v44 offset:33792
    v_mfma_f32_16x16x32_bf16 v[144:147], a[48:51], a[236:239], v[144:147]
    buffer_load_dwordx4 v52, s[24:27], s50 offen offset:2048 lds
    v_mfma_f32_16x16x32_bf16 v[148:151], a[52:55], a[236:239], v[148:151]
    ds_read_b64_tr_b16 a[20:21], v45 offset:32768
    ds_read_b64_tr_b16 a[22:23], v45 offset:33792
    v_mfma_f32_16x16x32_bf16 v[152:155], a[56:59], a[236:239], v[152:155]
    ds_read_b64_tr_b16 a[24:25], v46 offset:32768
    ds_read_b64_tr_b16 a[26:27], v46 offset:33792
    v_mfma_f32_16x16x32_bf16 v[156:159], a[60:63], a[236:239], v[156:159]
    ds_read_b64_tr_b16 a[28:29], v47 offset:32768
    ds_read_b64_tr_b16 a[30:31], v47 offset:33792
    v_mfma_f32_16x16x32_bf16 v[160:163], a[32:35], a[240:243], v[160:163]
    buffer_load_dwordx4 v53, s[24:27], s50 offen offset:3072 lds
    v_mfma_f32_16x16x32_bf16 v[164:167], a[36:39], a[240:243], v[164:167]
    s_add_u32 s50, s50, 262144
    s_cmp_ge_u32 s50, 5242880
    s_cselect_b32 s54, 5242880, 0
    ds_read_b128 a[236:239], v49 offset:22528
    v_mfma_f32_16x16x32_bf16 v[168:171], a[40:43], a[240:243], v[168:171]
    s_sub_u32 s50, s50, s54
    s_add_u32 s75, s100, 8192
    ds_read_b128 a[80:83], v4 offset:0
    v_mfma_f32_16x16x32_bf16 v[172:175], a[44:47], a[240:243], v[172:175]
    s_and_b32 s75, s75, s79
    s_add_u32 m0, s74, 16384
    ds_read_b128 a[84:87], v5 offset:0
    v_mfma_f32_16x16x32_bf16 v[176:179], a[48:51], a[240:243], v[176:179]
    buffer_load_dwordx4 v16, s[80:83], s75 offen offset:0 nt lds
    v_mfma_f32_16x16x32_bf16 v[180:183], a[52:55], a[240:243], v[180:183]
    ds_read_b128 a[88:91], v6 offset:0
    ds_read_b128 a[92:95], v7 offset:0
    v_mfma_f32_16x16x32_bf16 v[184:187], a[56:59], a[240:243], v[184:187]
    ds_read_b128 a[96:99], v4 offset:4096
    ds_read_b128 a[100:103], v5 offset:4096
    v_mfma_f32_16x16x32_bf16 v[188:191], a[60:63], a[240:243], v[188:191]
    ds_read_b128 a[104:107], v6 offset:4096
    ds_read_b128 a[108:111], v7 offset:4096
    v_mfma_f32_16x16x32_bf16 v[192:195], a[32:35], a[244:247], v[192:195]
    buffer_load_dwordx4 v17, s[80:83], s75 offen offset:1024 nt lds
    v_mfma_f32_16x16x32_bf16 v[196:199], a[36:39], a[244:247], v[196:199]
    s_add_u32 s75, s101, 8192
    s_and_b32 s75, s75, s79
    ds_read_b128 a[240:243], v49 offset:24576
    v_mfma_f32_16x16x32_bf16 v[200:203], a[40:43], a[244:247], v[200:203]
    s_add_u32 s75, s75, 131072
    v_mfma_f32_16x16x32_bf16 v[204:207], a[44:47], a[244:247], v[204:207]
    s_add_u32 m0, s74, 24576
    v_mfma_f32_16x16x32_bf16 v[208:211], a[48:51], a[244:247], v[208:211]
    buffer_load_dwordx4 v16, s[80:83], s75 offen offset:0 nt lds
    v_mfma_f32_16x16x32_bf16 v[212:215], a[52:55], a[244:247], v[212:215]
    v_mfma_f32_16x16x32_bf16 v[216:219], a[56:59], a[244:247], v[216:219]
    v_mfma_f32_16x16x32_bf16 v[220:223], a[60:63], a[244:247], v[220:223]
    v_mfma_f32_16x16x32_bf16 v[224:227], a[32:35], a[248:251], v[224:227]
    buffer_load_dwordx4 v17, s[80:83], s75 offen offset:1024 nt lds
    v_mfma_f32_16x16x32_bf16 v[228:231], a[36:39], a[248:251], v[228:231]
    ds_read_b128 a[244:247], v49 offset:26624
    v_mfma_f32_16x16x32_bf16 v[232:235], a[40:43], a[248:251], v[232:235]
    v_mfma_f32_16x16x32_bf16 v[236:239], a[44:47], a[248:251], v[236:239]
    v_mfma_f32_16x16x32_bf16 v[240:243], a[48:51], a[248:251], v[240:243]
    v_mfma_f32_16x16x32_bf16 v[244:247], a[52:55], a[248:251], v[244:247]
    v_mfma_f32_16x16x32_bf16 v[248:251], a[56:59], a[248:251], v[248:251]
    v_mfma_f32_16x16x32_bf16 v[252:255], a[60:63], a[248:251], v[252:255]
    ds_read_b128 a[248:251], v49 offset:28672
    s_waitcnt lgkmcnt(1)
    v_mfma_f32_16x16x32_bf16 v[96:99], a[0:3], a[64:67], v[96:99]
    v_mfma_f32_16x16x32_bf16 v[100:103], a[4:7], a[64:67], v[100:103]
    v_mfma_f32_16x16x32_bf16 v[104:107], a[8:11], a[64:67], v[104:107]
    v_mfma_f32_16x16x32_bf16 v[108:111], a[12:15], a[64:67], v[108:111]
    v_mfma_f32_16x16x32_bf16 v[112:115], a[16:19], a[64:67], v[112:115]
    v_mfma_f32_16x16x32_bf16 v[116:119], a[20:23], a[64:67], v[116:119]
    s_waitcnt vmcnt(17) lgkmcnt(0)
    v_mfma_f32_16x16x32_bf16 v[120:123], a[24:27], a[64:67], v[120:123]
    s_barrier
    v_mfma_f32_16x16x32_bf16 v[124:127], a[28:31], a[64:67], v[124:127]
    ds_read_b64_tr_b16 a[32:33], v40 offset:49152
    ds_read_b64_tr_b16 a[34:35], v40 offset:50176
    v_mfma_f32_16x16x32_bf16 v[128:131], a[0:3], a[68:71], v[128:131]
    s_add_u32 m0, s57, 139264
    ds_read_b64_tr_b16 a[36:37], v41 offset:49152
    ds_read_b64_tr_b16 a[38:39], v41 offset:50176
    v_mfma_f32_16x16x32_bf16 v[132:135], a[4:7], a[68:71], v[132:135]
    buffer_load_dwordx4 v54, s[20:23], s51 offen offset:0 lds
    v_mfma_f32_16x16x32_bf16 v[136:139], a[8:11], a[68:71], v[136:139]
    ds_read_b64_tr_b16 a[40:41], v42 offset:49152
    ds_read_b64_tr_b16 a[42:43], v42 offset:50176
    v_mfma_f32_16x16x32_bf16 v[140:143], a[12:15], a[68:71], v[140:143]
    ds_read_b64_tr_b16 a[44:45], v43 offset:49152
    ds_read_b64_tr_b16 a[46:47], v43 offset:50176
    v_mfma_f32_16x16x32_bf16 v[144:147], a[16:19], a[68:71], v[144:147]
    buffer_load_dwordx4 v55, s[20:23], s51 offen offset:1024 lds
    v_mfma_f32_16x16x32_bf16 v[148:151], a[20:23], a[68:71], v[148:151]
    ds_read_b64_tr_b16 a[48:49], v44 offset:49152
    ds_read_b64_tr_b16 a[50:51], v44 offset:50176
    v_mfma_f32_16x16x32_bf16 v[152:155], a[24:27], a[68:71], v[152:155]
    ds_read_b64_tr_b16 a[52:53], v45 offset:49152
    ds_read_b64_tr_b16 a[54:55], v45 offset:50176
    v_mfma_f32_16x16x32_bf16 v[156:159], a[28:31], a[68:71], v[156:159]
    buffer_load_dwordx4 v56, s[20:23], s51 offen offset:2048 lds
    v_mfma_f32_16x16x32_bf16 v[160:163], a[0:3], a[72:75], v[160:163]
    s_add_u32 m0, s57, 142336
    ds_read_b64_tr_b16 a[56:57], v46 offset:49152
    ds_read_b64_tr_b16 a[58:59], v46 offset:50176
    v_mfma_f32_16x16x32_bf16 v[164:167], a[4:7], a[72:75], v[164:167]
    ds_read_b64_tr_b16 a[60:61], v47 offset:49152
    ds_read_b64_tr_b16 a[62:63], v47 offset:50176
    v_mfma_f32_16x16x32_bf16 v[168:171], a[8:11], a[72:75], v[168:171]
    buffer_load_dwordx4 v57, s[20:23], s51 offen offset:0 lds
    v_mfma_f32_16x16x32_bf16 v[172:175], a[12:15], a[72:75], v[172:175]
    v_mfma_f32_16x16x32_bf16 v[176:179], a[16:19], a[72:75], v[176:179]
    v_mfma_f32_16x16x32_bf16 v[180:183], a[20:23], a[72:75], v[180:183]
    buffer_load_dwordx4 v58, s[20:23], s51 offen offset:1024 lds
    v_mfma_f32_16x16x32_bf16 v[184:187], a[24:27], a[72:75], v[184:187]
    s_add_u32 s51, s51, 128
    s_cmp_ge_u32 s51, s55
    s_cselect_b32 s54, 1280, 0
    v_mfma_f32_16x16x32_bf16 v[188:191], a[28:31], a[72:75], v[188:191]
    s_sub_u32 s51, s51, s54
    s_add_u32 m0, s52, 65536
    v_mfma_f32_16x16x32_bf16 v[192:195], a[0:3], a[76:79], v[192:195]
    buffer_load_dwordx4 v50, s[24:27], s50 offen offset:0 lds
    v_mfma_f32_16x16x32_bf16 v[196:199], a[4:7], a[76:79], v[196:199]
    v_mfma_f32_16x16x32_bf16 v[200:203], a[8:11], a[76:79], v[200:203]
    v_mfma_f32_16x16x32_bf16 v[204:207], a[12:15], a[76:79], v[204:207]
    buffer_load_dwordx4 v51, s[24:27], s50 offen offset:1024 lds
    v_mfma_f32_16x16x32_bf16 v[208:211], a[16:19], a[76:79], v[208:211]
    v_mfma_f32_16x16x32_bf16 v[212:215], a[20:23], a[76:79], v[212:215]
    v_mfma_f32_16x16x32_bf16 v[216:219], a[24:27], a[76:79], v[216:219]
    buffer_load_dwordx4 v52, s[24:27], s50 offen offset:2048 lds
    v_mfma_f32_16x16x32_bf16 v[220:223], a[28:31], a[76:79], v[220:223]
    v_mfma_f32_16x16x32_bf16 v[224:227], a[0:3], a[228:231], v[224:227]
    v_mfma_f32_16x16x32_bf16 v[228:231], a[4:7], a[228:231], v[228:231]
    buffer_load_dwordx4 v53, s[24:27], s50 offen offset:3072 lds
    v_mfma_f32_16x16x32_bf16 v[232:235], a[8:11], a[228:231], v[232:235]
    s_add_u32 s50, s50, 262144
    v_mfma_f32_16x16x32_bf16 v[236:239], a[12:15], a[228:231], v[236:239]
    v_mfma_f32_16x16x32_bf16 v[240:243], a[16:19], a[228:231], v[240:243]
    v_mfma_f32_16x16x32_bf16 v[244:247], a[20:23], a[228:231], v[244:247]
    v_mfma_f32_16x16x32_bf16 v[248:251], a[24:27], a[228:231], v[248:251]
    v_mfma_f32_16x16x32_bf16 v[252:255], a[28:31], a[228:231], v[252:255]
    s_waitcnt lgkmcnt(0)
    v_mfma_f32_16x16x32_bf16 v[96:99], a[32:35], a[232:235], v[96:99]
    s_waitcnt vmcnt(17) lgkmcnt(0)
    v_mfma_f32_16x16x32_bf16 v[100:103], a[36:39], a[232:235], v[100:103]
    s_barrier
    v_mfma_f32_16x16x32_bf16 v[104:107], a[40:43], a[232:235], v[104:107]
    ds_read_b128 a[64:67], v48 offset:0
    ds_read_b128 a[68:71], v48 offset:2048
    v_mfma_f32_16x16x32_bf16 v[108:111], a[44:47], a[232:235], v[108:111]
    s_add_u32 m0, s52, 81920
    ds_read_b128 a[72:75], v48 offset:4096
    ds_read_b128 a[76:79], v48 offset:6144
    v_mfma_f32_16x16x32_bf16 v[112:115], a[48:51], a[232:235], v[112:115]
    buffer_load_dwordx4 v50, s[24:27], s50 offen offset:0 lds
    v_mfma_f32_16x16x32_bf16 v[116:119], a[52:55], a[232:235], v[116:119]
    ds_read_b128 a[228:231], v48 offset:8192
    ds_read_b64_tr_b16 a[0:1], v40 offset:0
    v_mfma_f32_16x16x32_bf16 v[120:123], a[56:59], a[232:235], v[120:123]
    ds_read_b64_tr_b16 a[2:3], v40 offset:1024
    ds_read_b64_tr_b16 a[4:5], v41 offset:0
    v_mfma_f32_16x16x32_bf16 v[124:127], a[60:63], a[232:235], v[124:127]
    ds_read_b64_tr_b16 a[6:7], v41 offset:1024
    ds_read_b64_tr_b16 a[8:9], v42 offset:0
    v_mfma_f32_16x16x32_bf16 v[128:131], a[32:35], a[236:239], v[128:131]
    buffer_load_dwordx4 v51, s[24:27], s50 offen offset:1024 lds
    v_mfma_f32_16x16x32_bf16 v[132:135], a[36:39], a[236:239], v[132:135]
    ds_read_b128 a[232:235], v49 offset:0
    ds_read_b64_tr_b16 a[10:11], v42 offset:1024
    v_mfma_f32_16x16x32_bf16 v[136:139], a[40:43], a[236:239], v[136:139]
    ds_read_b64_tr_b16 a[12:13], v43 offset:0
    ds_read_b64_tr_b16 a[14:15], v43 offset:1024
    v_mfma_f32_16x16x32_bf16 v[140:143], a[44:47], a[236:239], v[140:143]
    ds_read_b64_tr_b16 a[16:17], v44 offset:0
    ds_read_b64_tr_b16 a[18:19], v44 offset:1024
    v_mfma_f32_16x16x32_bf16 v[144:147], a[48:51], a[236:239], v[144:147]
    buffer_load_dwordx4 v52, s[24:27], s50 offen offset:2048 lds
    v_mfma_f32_16x16x32_bf16 v[148:151], a[52:55], a[236:239], v[148:151]
    ds_read_b64_tr_b16 a[20:21], v45 offset:0
    ds_read_b64_tr_b16 a[22:23], v45 offset:1024
    v_mfma_f32_16x16x32_bf16 v[152:155], a[56:59], a[236:239], v[152:155]
    ds_read_b64_tr_b16 a[24:25], v46 offset:0
    ds_read_b64_tr_b16 a[26:27], v46 offset:1024
    v_mfma_f32_16x16x32_bf16 v[156:159], a[60:63], a[236:239], v[156:159]
    ds_read_b64_tr_b16 a[28:29], v47 offset:0
    ds_read_b64_tr_b16 a[30:31], v47 offset:1024
    v_mfma_f32_16x16x32_bf16 v[160:163], a[32:35], a[240:243], v[160:163]
    buffer_load_dwordx4 v53, s[24:27], s50 offen offset:3072 lds
    v_mfma_f32_16x16x32_bf16 v[164:167], a[36:39], a[240:243], v[164:167]
    s_add_u32 s50, s50, 262144
    s_cmp_ge_u32 s50, 5242880
    s_cselect_b32 s54, 5242880, 0
    ds_read_b128 a[236:239], v49 offset:2048
    v_mfma_f32_16x16x32_bf16 v[168:171], a[40:43], a[240:243], v[168:171]
    s_sub_u32 s50, s50, s54
    s_add_u32 s75, s100, 0
    v_mfma_f32_16x16x32_bf16 v[172:175], a[44:47], a[240:243], v[172:175]
    s_and_b32 s75, s75, s79
    s_add_u32 m0, s74, 98304
    v_mfma_f32_16x16x32_bf16 v[176:179], a[48:51], a[240:243], v[176:179]
    buffer_load_dwordx4 v18, s[84:87], s75 offen offset:0 nt lds
    v_mfma_f32_16x16x32_bf16 v[180:183], a[52:55], a[240:243], v[180:183]
    v_mfma_f32_16x16x32_bf16 v[184:187], a[56:59], a[240:243], v[184:187]
    v_mfma_f32_16x16x32_bf16 v[188:191], a[60:63], a[240:243], v[188:191]
    v_mfma_f32_16x16x32_bf16 v[192:195], a[32:35], a[244:247], v[192:195]
    buffer_load_dwordx4 v19, s[84:87], s75 offen offset:1024 nt lds
    v_mfma_f32_16x16x32_bf16 v[196:199], a[36:39], a[244:247], v[196:199]
    s_add_u32 s75, s101, 0
    s_and_b32 s75, s75, s79
    ds_read_b128 a[240:243], v49 offset:4096
    v_mfma_f32_16x16x32_bf16 v[200:203], a[40:43], a[244:247], v[200:203]
    s_add_u32 s75, s75, 131072
    v_mfma_f32_16x16x32_bf16 v[204:207], a[44:47], a[244:247], v[204:207]
    s_add_u32 m0, s74, 106496
    v_mfma_f32_16x16x32_bf16 v[208:211], a[48:51], a[244:247], v[208:211]
    buffer_load_dwordx4 v18, s[84:87], s75 offen offset:0 nt lds
    v_mfma_f32_16x16x32_bf16 v[212:215], a[52:55], a[244:247], v[212:215]
    v_mfma_f32_16x16x32_bf16 v[216:219], a[56:59], a[244:247], v[216:219]
    v_mfma_f32_16x16x32_bf16 v[220:223], a[60:63], a[244:247], v[220:223]
    v_mfma_f32_16x16x32_bf16 v[224:227], a[32:35], a[248:251], v[224:227]
    buffer_load_dwordx4 v19, s[84:87], s75 offen offset:1024 nt lds
    v_mfma_f32_16x16x32_bf16 v[228:231], a[36:39], a[248:251], v[228:231]
    ds_read_b128 a[244:247], v49 offset:6144
    v_mfma_f32_16x16x32_bf16 v[232:235], a[40:43], a[248:251], v[232:235]
    v_mfma_f32_16x16x32_bf16 v[236:239], a[44:47], a[248:251], v[236:239]
    v_mfma_f32_16x16x32_bf16 v[240:243], a[48:51], a[248:251], v[240:243]
    v_mfma_f32_16x16x32_bf16 v[244:247], a[52:55], a[248:251], v[244:247]
    v_mfma_f32_16x16x32_bf16 v[248:251], a[56:59], a[248:251], v[248:251]
    v_mfma_f32_16x16x32_bf16 v[252:255], a[60:63], a[248:251], v[252:255]
    ds_read_b128 a[248:251], v49 offset:8192
    s_waitcnt lgkmcnt(1)
    v_mfma_f32_16x16x32_bf16 v[96:99], a[0:3], a[64:67], v[96:99]
    v_mfma_f32_16x16x32_bf16 v[100:103], a[4:7], a[64:67], v[100:103]
    v_mfma_f32_16x16x32_bf16 v[104:107], a[8:11], a[64:67], v[104:107]
    v_mfma_f32_16x16x32_bf16 v[108:111], a[12:15], a[64:67], v[108:111]
    v_mfma_f32_16x16x32_bf16 v[112:115], a[16:19], a[64:67], v[112:115]
    v_mfma_f32_16x16x32_bf16 v[116:119], a[20:23], a[64:67], v[116:119]
    s_waitcnt vmcnt(21) lgkmcnt(0)
    v_mfma_f32_16x16x32_bf16 v[120:123], a[24:27], a[64:67], v[120:123]
    s_barrier
    v_mfma_f32_16x16x32_bf16 v[124:127], a[28:31], a[64:67], v[124:127]
    ds_read_b64_tr_b16 a[32:33], v40 offset:16384
    ds_read_b64_tr_b16 a[34:35], v40 offset:17408
    v_mfma_f32_16x16x32_bf16 v[128:131], a[0:3], a[68:71], v[128:131]
    s_add_u32 m0, s57, 118784
    ds_read_b64_tr_b16 a[36:37], v41 offset:16384
    ds_read_b64_tr_b16 a[38:39], v41 offset:17408
    v_mfma_f32_16x16x32_bf16 v[132:135], a[4:7], a[68:71], v[132:135]
    buffer_load_dwordx4 v54, s[20:23], s51 offen offset:0 lds
    v_mfma_f32_16x16x32_bf16 v[136:139], a[8:11], a[68:71], v[136:139]
    ds_read_b64_tr_b16 a[40:41], v42 offset:16384
    ds_read_b64_tr_b16 a[42:43], v42 offset:17408
    v_mfma_f32_16x16x32_bf16 v[140:143], a[12:15], a[68:71], v[140:143]
    ds_read_b64_tr_b16 a[44:45], v43 offset:16384
    ds_read_b64_tr_b16 a[46:47], v43 offset:17408
    v_mfma_f32_16x16x32_bf16 v[144:147], a[16:19], a[68:71], v[144:147]
    buffer_load_dwordx4 v55, s[20:23], s51 offen offset:1024 lds
    v_mfma_f32_16x16x32_bf16 v[148:151], a[20:23], a[68:71], v[148:151]
    ds_read_b64_tr_b16 a[48:49], v44 offset:16384
    ds_read_b64_tr_b16 a[50:51], v44 offset:17408
    v_mfma_f32_16x16x32_bf16 v[152:155], a[24:27], a[68:71], v[152:155]
    ds_read_b64_tr_b16 a[52:53], v45 offset:16384
    ds_read_b64_tr_b16 a[54:55], v45 offset:17408
    v_mfma_f32_16x16x32_bf16 v[156:159], a[28:31], a[68:71], v[156:159]
    buffer_load_dwordx4 v56, s[20:23], s51 offen offset:2048 lds
    v_mfma_f32_16x16x32_bf16 v[160:163], a[0:3], a[72:75], v[160:163]
    s_add_u32 m0, s57, 121856
    ds_read_b64_tr_b16 a[56:57], v46 offset:16384
    ds_read_b64_tr_b16 a[58:59], v46 offset:17408
    v_mfma_f32_16x16x32_bf16 v[164:167], a[4:7], a[72:75], v[164:167]
    ds_read_b64_tr_b16 a[60:61], v47 offset:16384
    ds_read_b64_tr_b16 a[62:63], v47 offset:17408
    v_mfma_f32_16x16x32_bf16 v[168:171], a[8:11], a[72:75], v[168:171]
    buffer_load_dwordx4 v57, s[20:23], s51 offen offset:0 lds
    v_mfma_f32_16x16x32_bf16 v[172:175], a[12:15], a[72:75], v[172:175]
    v_mfma_f32_16x16x32_bf16 v[176:179], a[16:19], a[72:75], v[176:179]
    v_mfma_f32_16x16x32_bf16 v[180:183], a[20:23], a[72:75], v[180:183]
    buffer_load_dwordx4 v58, s[20:23], s51 offen offset:1024 lds
    v_mfma_f32_16x16x32_bf16 v[184:187], a[24:27], a[72:75], v[184:187]
    s_add_u32 s51, s51, 128
    s_cmp_ge_u32 s51, s55
    s_cselect_b32 s54, 1280, 0
    v_mfma_f32_16x16x32_bf16 v[188:191], a[28:31], a[72:75], v[188:191]
    s_sub_u32 s51, s51, s54
    s_add_u32 m0, s52, 32768
    v_mfma_f32_16x16x32_bf16 v[192:195], a[0:3], a[76:79], v[192:195]
    buffer_load_dwordx4 v50, s[24:27], s50 offen offset:0 lds
    v_mfma_f32_16x16x32_bf16 v[196:199], a[4:7], a[76:79], v[196:199]
    v_mfma_f32_16x16x32_bf16 v[200:203], a[8:11], a[76:79], v[200:203]
    v_mfma_f32_16x16x32_bf16 v[204:207], a[12:15], a[76:79], v[204:207]
    buffer_load_dwordx4 v51, s[24:27], s50 offen offset:1024 lds
    v_mfma_f32_16x16x32_bf16 v[208:211], a[16:19], a[76:79], v[208:211]
    v_mfma_f32_16x16x32_bf16 v[212:215], a[20:23], a[76:79], v[212:215]
    v_mfma_f32_16x16x32_bf16 v[216:219], a[24:27], a[76:79], v[216:219]
    buffer_load_dwordx4 v52, s[24:27], s50 offen offset:2048 lds
    v_mfma_f32_16x16x32_bf16 v[220:223], a[28:31], a[76:79], v[220:223]
    v_mfma_f32_16x16x32_bf16 v[224:227], a[0:3], a[228:231], v[224:227]
    v_mfma_f32_16x16x32_bf16 v[228:231], a[4:7], a[228:231], v[228:231]
    buffer_load_dwordx4 v53, s[24:27], s50 offen offset:3072 lds
    v_mfma_f32_16x16x32_bf16 v[232:235], a[8:11], a[228:231], v[232:235]
    s_add_u32 s50, s50, 262144
    v_mfma_f32_16x16x32_bf16 v[236:239], a[12:15], a[228:231], v[236:239]
    v_mfma_f32_16x16x32_bf16 v[240:243], a[16:19], a[228:231], v[240:243]
    v_mfma_f32_16x16x32_bf16 v[244:247], a[20:23], a[228:231], v[244:247]
    v_mfma_f32_16x16x32_bf16 v[248:251], a[24:27], a[228:231], v[248:251]
    v_mfma_f32_16x16x32_bf16 v[252:255], a[28:31], a[228:231], v[252:255]
    s_waitcnt lgkmcnt(0)
    v_mfma_f32_16x16x32_bf16 v[96:99], a[32:35], a[232:235], v[96:99]
    s_waitcnt vmcnt(17) lgkmcnt(0)
    v_mfma_f32_16x16x32_bf16 v[100:103], a[36:39], a[232:235], v[100:103]
    s_barrier
    v_mfma_f32_16x16x32_bf16 v[104:107], a[40:43], a[232:235], v[104:107]
    ds_read_b128 a[64:67], v48 offset:20480
    ds_read_b128 a[68:71], v48 offset:22528
    v_mfma_f32_16x16x32_bf16 v[108:111], a[44:47], a[232:235], v[108:111]
    s_add_u32 m0, s52, 49152
    ds_read_b128 a[72:75], v48 offset:24576
    ds_read_b128 a[76:79], v48 offset:26624
    v_mfma_f32_16x16x32_bf16 v[112:115], a[48:51], a[232:235], v[112:115]
    buffer_load_dwordx4 v50, s[24:27], s50 offen offset:0 lds
    v_mfma_f32_16x16x32_bf16 v[116:119], a[52:55], a[232:235], v[116:119]
    ds_read_b128 a[228:231], v48 offset:28672
    ds_read_b64_tr_b16 a[0:1], v40 offset:32768
    v_mfma_f32_16x16x32_bf16 v[120:123], a[56:59], a[232:235], v[120:123]
    ds_read_b64_tr_b16 a[2:3], v40 offset:33792
    ds_read_b64_tr_b16 a[4:5], v41 offset:32768
    v_mfma_f32_16x16x32_bf16 v[124:127], a[60:63], a[232:235], v[124:127]
    ds_read_b64_tr_b16 a[6:7], v41 offset:33792
    ds_read_b64_tr_b16 a[8:9], v42 offset:32768
    v_mfma_f32_16x16x32_bf16 v[128:131], a[32:35], a[236:239], v[128:131]
    buffer_load_dwordx4 v51, s[24:27], s50 offen offset:1024 lds
    v_mfma_f32_16x16x32_bf16 v[132:135], a[36:39], a[236:239], v[132:135]
    ds_read_b128 a[232:235], v49 offset:20480
    ds_read_b64_tr_b16 a[10:11], v42 offset:33792
    v_mfma_f32_16x16x32_bf16 v[136:139], a[40:43], a[236:239], v[136:139]
    ds_read_b64_tr_b16 a[12:13], v43 offset:32768
    ds_read_b64_tr_b16 a[14:15], v43 offset:33792
    v_mfma_f32_16x16x32_bf16 v[140:143], a[44:47], a[236:239], v[140:143]
    ds_read_b64_tr_b16 a[16:17], v44 offset:32768
    ds_read_b64_tr_b16 a[18:19], v44 offset:33792
    v_mfma_f32_16x16x32_bf16 v[144:147], a[48:51], a[236:239], v[144:147]
    buffer_load_dwordx4 v52, s[24:27], s50 offen offset:2048 lds
    v_mfma_f32_16x16x32_bf16 v[148:151], a[52:55], a[236:239], v[148:151]
    ds_read_b64_tr_b16 a[20:21], v45 offset:32768
    ds_read_b64_tr_b16 a[22:23], v45 offset:33792
    v_mfma_f32_16x16x32_bf16 v[152:155], a[56:59], a[236:239], v[152:155]
    ds_read_b64_tr_b16 a[24:25], v46 offset:32768
    ds_read_b64_tr_b16 a[26:27], v46 offset:33792
    v_mfma_f32_16x16x32_bf16 v[156:159], a[60:63], a[236:239], v[156:159]
    ds_read_b64_tr_b16 a[28:29], v47 offset:32768
    ds_read_b64_tr_b16 a[30:31], v47 offset:33792
    v_mfma_f32_16x16x32_bf16 v[160:163], a[32:35], a[240:243], v[160:163]
    buffer_load_dwordx4 v53, s[24:27], s50 offen offset:3072 lds
    v_mfma_f32_16x16x32_bf16 v[164:167], a[36:39], a[240:243], v[164:167]
    s_add_u32 s50, s50, 262144
    s_cmp_ge_u32 s50, 5242880
    s_cselect_b32 s54, 5242880, 0
    ds_read_b128 a[236:239], v49 offset:22528
    v_mfma_f32_16x16x32_bf16 v[168:171], a[40:43], a[240:243], v[168:171]
    s_sub_u32 s50, s50, s54
    s_add_u32 s75, s100, 16384
    ds_read_b128 a[112:115], v4 offset:16384
    v_mfma_f32_16x16x32_bf16 v[172:175], a[44:47], a[240:243], v[172:175]
    s_and_b32 s75, s75, s79
    s_add_u32 m0, s74, 0
    ds_read_b128 a[116:119], v5 offset:16384
    v_mfma_f32_16x16x32_bf16 v[176:179], a[48:51], a[240:243], v[176:179]
    buffer_load_dwordx4 v16, s[80:83], s75 offen offset:0 nt lds
    v_mfma_f32_16x16x32_bf16 v[180:183], a[52:55], a[240:243], v[180:183]
    ds_read_b128 a[120:123], v6 offset:16384
    ds_read_b128 a[124:127], v7 offset:16384
    v_mfma_f32_16x16x32_bf16 v[184:187], a[56:59], a[240:243], v[184:187]
    ds_read_b128 a[128:131], v4 offset:20480
    ds_read_b128 a[132:135], v5 offset:20480
    v_mfma_f32_16x16x32_bf16 v[188:191], a[60:63], a[240:243], v[188:191]
    ds_read_b128 a[136:139], v6 offset:20480
    ds_read_b128 a[140:143], v7 offset:20480
    v_mfma_f32_16x16x32_bf16 v[192:195], a[32:35], a[244:247], v[192:195]
    buffer_load_dwordx4 v17, s[80:83], s75 offen offset:1024 nt lds
    v_mfma_f32_16x16x32_bf16 v[196:199], a[36:39], a[244:247], v[196:199]
    s_add_u32 s75, s101, 16384
    s_and_b32 s75, s75, s79
    ds_read_b128 a[240:243], v49 offset:24576
    v_mfma_f32_16x16x32_bf16 v[200:203], a[40:43], a[244:247], v[200:203]
    s_add_u32 s75, s75, 131072
    v_mfma_f32_16x16x32_bf16 v[204:207], a[44:47], a[244:247], v[204:207]
    s_add_u32 m0, s74, 8192
    v_mfma_f32_16x16x32_bf16 v[208:211], a[48:51], a[244:247], v[208:211]
    buffer_load_dwordx4 v16, s[80:83], s75 offen offset:0 nt lds
    v_mfma_f32_16x16x32_bf16 v[212:215], a[52:55], a[244:247], v[212:215]
    v_mfma_f32_16x16x32_bf16 v[216:219], a[56:59], a[244:247], v[216:219]
    v_mfma_f32_16x16x32_bf16 v[220:223], a[60:63], a[244:247], v[220:223]
    v_mfma_f32_16x16x32_bf16 v[224:227], a[32:35], a[248:251], v[224:227]
    buffer_load_dwordx4 v17, s[80:83], s75 offen offset:1024 nt lds
    v_mfma_f32_16x16x32_bf16 v[228:231], a[36:39], a[248:251], v[228:231]
    ds_read_b128 a[244:247], v49 offset:26624
    v_mfma_f32_16x16x32_bf16 v[232:235], a[40:43], a[248:251], v[232:235]
    v_mfma_f32_16x16x32_bf16 v[236:239], a[44:47], a[248:251], v[236:239]
    v_mfma_f32_16x16x32_bf16 v[240:243], a[48:51], a[248:251], v[240:243]
    v_mfma_f32_16x16x32_bf16 v[244:247], a[52:55], a[248:251], v[244:247]
    v_mfma_f32_16x16x32_bf16 v[248:251], a[56:59], a[248:251], v[248:251]
    v_mfma_f32_16x16x32_bf16 v[252:255], a[60:63], a[248:251], v[252:255]
    ds_read_b128 a[248:251], v49 offset:28672
    s_waitcnt lgkmcnt(1)
    v_mfma_f32_16x16x32_bf16 v[96:99], a[0:3], a[64:67], v[96:99]
    v_mfma_f32_16x16x32_bf16 v[100:103], a[4:7], a[64:67], v[100:103]
    v_mfma_f32_16x16x32_bf16 v[104:107], a[8:11], a[64:67], v[104:107]
    v_mfma_f32_16x16x32_bf16 v[108:111], a[12:15], a[64:67], v[108:111]
    v_mfma_f32_16x16x32_bf16 v[112:115], a[16:19], a[64:67], v[112:115]
    v_mfma_f32_16x16x32_bf16 v[116:119], a[20:23], a[64:67], v[116:119]
    s_waitcnt vmcnt(17) lgkmcnt(0)
    v_mfma_f32_16x16x32_bf16 v[120:123], a[24:27], a[64:67], v[120:123]
    s_barrier
    v_mfma_f32_16x16x32_bf16 v[124:127], a[28:31], a[64:67], v[124:127]
    ds_read_b64_tr_b16 a[32:33], v40 offset:49152
    ds_read_b64_tr_b16 a[34:35], v40 offset:50176
    v_mfma_f32_16x16x32_bf16 v[128:131], a[0:3], a[68:71], v[128:131]
    s_add_u32 m0, s57, 139264
    ds_read_b64_tr_b16 a[36:37], v41 offset:49152
    ds_read_b64_tr_b16 a[38:39], v41 offset:50176
    v_mfma_f32_16x16x32_bf16 v[132:135], a[4:7], a[68:71], v[132:135]
    buffer_load_dwordx4 v54, s[20:23], s51 offen offset:0 lds
    v_mfma_f32_16x16x32_bf16 v[136:139], a[8:11], a[68:71], v[136:139]
    ds_read_b64_tr_b16 a[40:41], v42 offset:49152
    ds_read_b64_tr_b16 a[42:43], v42 offset:50176
    v_mfma_f32_16x16x32_bf16 v[140:143], a[12:15], a[68:71], v[140:143]
    ds_read_b64_tr_b16 a[44:45], v43 offset:49152
    ds_read_b64_tr_b16 a[46:47], v43 offset:50176
    v_mfma_f32_16x16x32_bf16 v[144:147], a[16:19], a[68:71], v[144:147]
    buffer_load_dwordx4 v55, s[20:23], s51 offen offset:1024 lds
    v_mfma_f32_16x16x32_bf16 v[148:151], a[20:23], a[68:71], v[148:151]
    ds_read_b64_tr_b16 a[48:49], v44 offset:49152
    ds_read_b64_tr_b16 a[50:51], v44 offset:50176
    v_mfma_f32_16x16x32_bf16 v[152:155], a[24:27], a[68:71], v[152:155]
    ds_read_b64_tr_b16 a[52:53], v45 offset:49152
    ds_read_b64_tr_b16 a[54:55], v45 offset:50176
    v_mfma_f32_16x16x32_bf16 v[156:159], a[28:31], a[68:71], v[156:159]
    buffer_load_dwordx4 v56, s[20:23], s51 offen offset:2048 lds
    v_mfma_f32_16x16x32_bf16 v[160:163], a[0:3], a[72:75], v[160:163]
    s_add_u32 m0, s57, 142336
    ds_read_b64_tr_b16 a[56:57], v46 offset:49152
    ds_read_b64_tr_b16 a[58:59], v46 offset:50176
    v_mfma_f32_16x16x32_bf16 v[164:167], a[4:7], a[72:75], v[164:167]
    ds_read_b64_tr_b16 a[60:61], v47 offset:49152
    ds_read_b64_tr_b16 a[62:63], v47 offset:50176
    v_mfma_f32_16x16x32_bf16 v[168:171], a[8:11], a[72:75], v[168:171]
    buffer_load_dwordx4 v57, s[20:23], s51 offen offset:0 lds
    v_mfma_f32_16x16x32_bf16 v[172:175], a[12:15], a[72:75], v[172:175]
    ds_read_b64_tr_b16 a[144:145], v8 offset:32768
    ds_read_b64_tr_b16 a[146:147], v8 offset:36864
    v_mfma_f32_16x16x32_bf16 v[176:179], a[16:19], a[72:75], v[176:179]
    ds_read_b64_tr_b16 a[148:149], v9 offset:32768
    ds_read_b64_tr_b16 a[150:151], v9 offset:36864
    v_mfma_f32_16x16x32_bf16 v[180:183], a[20:23], a[72:75], v[180:183]
    buffer_load_dwordx4 v58, s[20:23], s51 offen offset:1024 lds
    v_mfma_f32_16x16x32_bf16 v[184:187], a[24:27], a[72:75], v[184:187]
    s_add_u32 s51, s51, 128
    s_cmp_ge_u32 s51, s55
    s_cselect_b32 s54, 1280, 0
    v_mfma_f32_16x16x32_bf16 v[188:191], a[28:31], a[72:75], v[188:191]
    s_sub_u32 s51, s51, s54
    s_add_u32 m0, s52, 65536
    ds_read_b64_tr_b16 a[152:153], v10 offset:32768
    v_mfma_f32_16x16x32_bf16 v[192:195], a[0:3], a[76:79], v[192:195]
    buffer_load_dwordx4 v50, s[24:27], s50 offen offset:0 lds
    v_mfma_f32_16x16x32_bf16 v[196:199], a[4:7], a[76:79], v[196:199]
    ds_read_b64_tr_b16 a[154:155], v10 offset:36864
    ds_read_b64_tr_b16 a[156:157], v11 offset:32768
    v_mfma_f32_16x16x32_bf16 v[200:203], a[8:11], a[76:79], v[200:203]
    ds_read_b64_tr_b16 a[158:159], v11 offset:36864
    ds_read_b64_tr_b16 a[160:161], v12 offset:32768
    v_mfma_f32_16x16x32_bf16 v[204:207], a[12:15], a[76:79], v[204:207]
    buffer_load_dwordx4 v51, s[24:27], s50 offen offset:1024 lds
    v_mfma_f32_16x16x32_bf16 v[208:211], a[16:19], a[76:79], v[208:211]
    ds_read_b64_tr_b16 a[162:163], v12 offset:36864
    ds_read_b64_tr_b16 a[164:165], v13 offset:32768
    v_mfma_f32_16x16x32_bf16 v[212:215], a[20:23], a[76:79], v[212:215]
    ds_read_b64_tr_b16 a[166:167], v13 offset:36864
    ds_read_b64_tr_b16 a[168:169], v14 offset:32768
    v_mfma_f32_16x16x32_bf16 v[216:219], a[24:27], a[76:79], v[216:219]
    buffer_load_dwordx4 v52, s[24:27], s50 offen offset:2048 lds
    v_mfma_f32_16x16x32_bf16 v[220:223], a[28:31], a[76:79], v[220:223]
    ds_read_b64_tr_b16 a[170:171], v14 offset:36864
    ds_read_b64_tr_b16 a[172:173], v15 offset:32768
    v_mfma_f32_16x16x32_bf16 v[224:227], a[0:3], a[228:231], v[224:227]
    ds_read_b64_tr_b16 a[174:175], v15 offset:36864
    v_mfma_f32_16x16x32_bf16 v[228:231], a[4:7], a[228:231], v[228:231]
    buffer_load_dwordx4 v53, s[24:27], s50 offen offset:3072 lds
    v_mfma_f32_16x16x32_bf16 v[232:235], a[8:11], a[228:231], v[232:235]
    s_add_u32 s50, s50, 262144
    v_mfma_f32_16x16x32_bf16 v[236:239], a[12:15], a[228:231], v[236:239]
    v_mfma_f32_16x16x32_bf16 v[240:243], a[16:19], a[228:231], v[240:243]
    v_mfma_f32_16x16x32_bf16 v[244:247], a[20:23], a[228:231], v[244:247]
    v_mfma_f32_16x16x32_bf16 v[248:251], a[24:27], a[228:231], v[248:251]
    v_mfma_f32_16x16x32_bf16 v[252:255], a[28:31], a[228:231], v[252:255]
    s_waitcnt lgkmcnt(0)
    v_mfma_f32_16x16x32_bf16 v[96:99], a[32:35], a[232:235], v[96:99]
    s_waitcnt vmcnt(17) lgkmcnt(0)
    v_mfma_f32_16x16x32_bf16 v[100:103], a[36:39], a[232:235], v[100:103]
    s_barrier
    v_mfma_f32_16x16x32_bf16 v[104:107], a[40:43], a[232:235], v[104:107]
    ds_read_b128 a[64:67], v48 offset:0
    ds_read_b128 a[68:71], v48 offset:2048
    v_mfma_f32_16x16x32_bf16 v[108:111], a[44:47], a[232:235], v[108:111]
    s_add_u32 m0, s52, 81920
    ds_read_b128 a[72:75], v48 offset:4096
    ds_read_b128 a[76:79], v48 offset:6144
    v_mfma_f32_16x16x32_bf16 v[112:115], a[48:51], a[232:235], v[112:115]
    buffer_load_dwordx4 v50, s[24:27], s50 offen offset:0 lds
    v_mfma_f32_16x16x32_bf16 v[116:119], a[52:55], a[232:235], v[116:119]
    ds_read_b128 a[228:231], v48 offset:8192
    ds_read_b64_tr_b16 a[0:1], v40 offset:0
    v_mfma_f32_16x16x32_bf16 v[120:123], a[56:59], a[232:235], v[120:123]
    ds_read_b64_tr_b16 a[2:3], v40 offset:1024
    ds_read_b64_tr_b16 a[4:5], v41 offset:0
    v_mfma_f32_16x16x32_bf16 v[124:127], a[60:63], a[232:235], v[124:127]
    ds_read_b64_tr_b16 a[6:7], v41 offset:1024
    ds_read_b64_tr_b16 a[8:9], v42 offset:0
    v_mfma_f32_16x16x32_bf16 v[128:131], a[32:35], a[236:239], v[128:131]
    buffer_load_dwordx4 v51, s[24:27], s50 offen offset:1024 lds
    v_mfma_f32_16x16x32_bf16 v[132:135], a[36:39], a[236:239], v[132:135]
    ds_read_b128 a[232:235], v49 offset:0
    ds_read_b64_tr_b16 a[10:11], v42 offset:1024
    v_mfma_f32_16x16x32_bf16 v[136:139], a[40:43], a[236:239], v[136:139]
    ds_read_b64_tr_b16 a[12:13], v43 offset:0
    ds_read_b64_tr_b16 a[14:15], v43 offset:1024
    v_mfma_f32_16x16x32_bf16 v[140:143], a[44:47], a[236:239], v[140:143]
    ds_read_b64_tr_b16 a[16:17], v44 offset:0
    ds_read_b64_tr_b16 a[18:19], v44 offset:1024
    v_mfma_f32_16x16x32_bf16 v[144:147], a[48:51], a[236:239], v[144:147]
    buffer_load_dwordx4 v52, s[24:27], s50 offen offset:2048 lds
    v_mfma_f32_16x16x32_bf16 v[148:151], a[52:55], a[236:239], v[148:151]
    ds_read_b64_tr_b16 a[20:21], v45 offset:0
    ds_read_b64_tr_b16 a[22:23], v45 offset:1024
    v_mfma_f32_16x16x32_bf16 v[152:155], a[56:59], a[236:239], v[152:155]
    ds_read_b64_tr_b16 a[24:25], v46 offset:0
    ds_read_b64_tr_b16 a[26:27], v46 offset:1024
    v_mfma_f32_16x16x32_bf16 v[156:159], a[60:63], a[236:239], v[156:159]
    ds_read_b64_tr_b16 a[28:29], v47 offset:0
    ds_read_b64_tr_b16 a[30:31], v47 offset:1024
    v_mfma_f32_16x16x32_bf16 v[160:163], a[32:35], a[240:243], v[160:163]
    buffer_load_dwordx4 v53, s[24:27], s50 offen offset:3072 lds
    v_mfma_f32_16x16x32_bf16 v[164:167], a[36:39], a[240:243], v[164:167]
    s_add_u32 s50, s50, 262144
    s_cmp_ge_u32 s50, 5242880
    s_cselect_b32 s54, 5242880, 0
    ds_read_b128 a[236:239], v49 offset:2048
    v_mfma_f32_16x16x32_bf16 v[168:171], a[40:43], a[240:243], v[168:171]
    s_sub_u32 s50, s50, s54
    s_add_u32 s75, s100, 8192
    v_mfma_f32_16x16x32_bf16 v[172:175], a[44:47], a[240:243], v[172:175]
    s_and_b32 s75, s75, s79
    s_add_u32 m0, s74, 98304
    v_mfma_f32_16x16x32_bf16 v[176:179], a[48:51], a[240:243], v[176:179]
    buffer_load_dwordx4 v18, s[84:87], s75 offen offset:0 nt lds
    v_mfma_f32_16x16x32_bf16 v[180:183], a[52:55], a[240:243], v[180:183]
    v_mfma_f32_16x16x32_bf16 v[184:187], a[56:59], a[240:243], v[184:187]
    v_mfma_f32_16x16x32_bf16 v[188:191], a[60:63], a[240:243], v[188:191]
    v_mfma_f32_16x16x32_bf16 v[192:195], a[32:35], a[244:247], v[192:195]
    buffer_load_dwordx4 v19, s[84:87], s75 offen offset:1024 nt lds
    v_mfma_f32_16x16x32_bf16 v[196:199], a[36:39], a[244:247], v[196:199]
    s_add_u32 s75, s101, 8192
    s_and_b32 s75, s75, s79
    ds_read_b128 a[240:243], v49 offset:4096
    v_mfma_f32_16x16x32_bf16 v[200:203], a[40:43], a[244:247], v[200:203]
    s_add_u32 s75, s75, 131072
    v_mfma_f32_16x16x32_bf16 v[204:207], a[44:47], a[244:247], v[204:207]
    s_add_u32 m0, s74, 106496
    v_mfma_f32_16x16x32_bf16 v[208:211], a[48:51], a[244:247], v[208:211]
    buffer_load_dwordx4 v18, s[84:87], s75 offen offset:0 nt lds
    v_mfma_f32_16x16x32_bf16 v[212:215], a[52:55], a[244:247], v[212:215]
    v_mfma_f32_16x16x32_bf16 v[216:219], a[56:59], a[244:247], v[216:219]
    v_mfma_f32_16x16x32_bf16 v[220:223], a[60:63], a[244:247], v[220:223]
    v_mfma_f32_16x16x32_bf16 v[224:227], a[32:35], a[248:251], v[224:227]
    buffer_load_dwordx4 v19, s[84:87], s75 offen offset:1024 nt lds
    v_mfma_f32_16x16x32_bf16 v[228:231], a[36:39], a[248:251], v[228:231]
    ds_read_b128 a[244:247], v49 offset:6144
    v_mfma_f32_16x16x32_bf16 v[232:235], a[40:43], a[248:251], v[232:235]
    v_mfma_f32_16x16x32_bf16 v[236:239], a[44:47], a[248:251], v[236:239]
    v_mfma_f32_16x16x32_bf16 v[240:243], a[48:51], a[248:251], v[240:243]
    v_mfma_f32_16x16x32_bf16 v[244:247], a[52:55], a[248:251], v[244:247]
    v_mfma_f32_16x16x32_bf16 v[248:251], a[56:59], a[248:251], v[248:251]
    v_mfma_f32_16x16x32_bf16 v[252:255], a[60:63], a[248:251], v[252:255]
    ds_read_b128 a[248:251], v49 offset:8192
    s_waitcnt lgkmcnt(1)
    v_mfma_f32_16x16x32_bf16 v[96:99], a[0:3], a[64:67], v[96:99]
    v_mfma_f32_16x16x32_bf16 v[100:103], a[4:7], a[64:67], v[100:103]
    v_mfma_f32_16x16x32_bf16 v[104:107], a[8:11], a[64:67], v[104:107]
    v_mfma_f32_16x16x32_bf16 v[108:111], a[12:15], a[64:67], v[108:111]
    v_mfma_f32_16x16x32_bf16 v[112:115], a[16:19], a[64:67], v[112:115]
    v_mfma_f32_16x16x32_bf16 v[116:119], a[20:23], a[64:67], v[116:119]
    s_waitcnt vmcnt(21) lgkmcnt(0)
    v_mfma_f32_16x16x32_bf16 v[120:123], a[24:27], a[64:67], v[120:123]
    s_barrier
    v_mfma_f32_16x16x32_bf16 v[124:127], a[28:31], a[64:67], v[124:127]
    ds_read_b64_tr_b16 a[32:33], v40 offset:16384
    ds_read_b64_tr_b16 a[34:35], v40 offset:17408
    v_mfma_f32_16x16x32_bf16 v[128:131], a[0:3], a[68:71], v[128:131]
    s_add_u32 m0, s57, 118784
    ds_read_b64_tr_b16 a[36:37], v41 offset:16384
    ds_read_b64_tr_b16 a[38:39], v41 offset:17408
    v_mfma_f32_16x16x32_bf16 v[132:135], a[4:7], a[68:71], v[132:135]
    buffer_load_dwordx4 v54, s[20:23], s51 offen offset:0 lds
    v_mfma_f32_16x16x32_bf16 v[136:139], a[8:11], a[68:71], v[136:139]
    ds_read_b64_tr_b16 a[40:41], v42 offset:16384
    ds_read_b64_tr_b16 a[42:43], v42 offset:17408
    v_mfma_f32_16x16x32_bf16 v[140:143], a[12:15], a[68:71], v[140:143]
    ds_read_b64_tr_b16 a[44:45], v43 offset:16384
    ds_read_b64_tr_b16 a[46:47], v43 offset:17408
    v_mfma_f32_16x16x32_bf16 v[144:147], a[16:19], a[68:71], v[144:147]
    buffer_load_dwordx4 v55, s[20:23], s51 offen offset:1024 lds
    v_mfma_f32_16x16x32_bf16 v[148:151], a[20:23], a[68:71], v[148:151]
    ds_read_b64_tr_b16 a[48:49], v44 offset:16384
    ds_read_b64_tr_b16 a[50:51], v44 offset:17408
    v_mfma_f32_16x16x32_bf16 v[152:155], a[24:27], a[68:71], v[152:155]
    ds_read_b64_tr_b16 a[52:53], v45 offset:16384
    ds_read_b64_tr_b16 a[54:55], v45 offset:17408
    v_mfma_f32_16x16x32_bf16 v[156:159], a[28:31], a[68:71], v[156:159]
    buffer_load_dwordx4 v56, s[20:23], s51 offen offset:2048 lds
    v_mfma_f32_16x16x32_bf16 v[160:163], a[0:3], a[72:75], v[160:163]
    s_add_u32 m0, s57, 121856
    ds_read_b64_tr_b16 a[56:57], v46 offset:16384
    ds_read_b64_tr_b16 a[58:59], v46 offset:17408
    v_mfma_f32_16x16x32_bf16 v[164:167], a[4:7], a[72:75], v[164:167]
    ds_read_b64_tr_b16 a[60:61], v47 offset:16384
    ds_read_b64_tr_b16 a[62:63], v47 offset:17408
    v_mfma_f32_16x16x32_bf16 v[168:171], a[8:11], a[72:75], v[168:171]
    buffer_load_dwordx4 v57, s[20:23], s51 offen offset:0 lds
    v_mfma_f32_16x16x32_bf16 v[172:175], a[12:15], a[72:75], v[172:175]
    v_mfma_f32_16x16x32_bf16 v[176:179], a[16:19], a[72:75], v[176:179]
    v_mfma_f32_16x16x32_bf16 v[180:183], a[20:23], a[72:75], v[180:183]
    buffer_load_dwordx4 v58, s[20:23], s51 offen offset:1024 lds
    v_mfma_f32_16x16x32_bf16 v[184:187], a[24:27], a[72:75], v[184:187]
    s_add_u32 s51, s51, 128
    s_cmp_ge_u32 s51, s55
    s_cselect_b32 s54, 1280, 0
    v_mfma_f32_16x16x32_bf16 v[188:191], a[28:31], a[72:75], v[188:191]
    s_sub_u32 s51, s51, s54
    s_add_u32 m0, s52, 32768
    v_mfma_f32_16x16x32_bf16 v[192:195], a[0:3], a[76:79], v[192:195]
    buffer_load_dwordx4 v50, s[24:27], s50 offen offset:0 lds
    v_mfma_f32_16x16x32_bf16 v[196:199], a[4:7], a[76:79], v[196:199]
    v_mfma_f32_16x16x32_bf16 v[200:203], a[8:11], a[76:79], v[200:203]
    v_mfma_f32_16x16x32_bf16 v[204:207], a[12:15], a[76:79], v[204:207]
    buffer_load_dwordx4 v51, s[24:27], s50 offen offset:1024 lds
    v_mfma_f32_16x16x32_bf16 v[208:211], a[16:19], a[76:79], v[208:211]
    v_mfma_f32_16x16x32_bf16 v[212:215], a[20:23], a[76:79], v[212:215]
    v_mfma_f32_16x16x32_bf16 v[216:219], a[24:27], a[76:79], v[216:219]
    buffer_load_dwordx4 v52, s[24:27], s50 offen offset:2048 lds
    v_mfma_f32_16x16x32_bf16 v[220:223], a[28:31], a[76:79], v[220:223]
    v_mfma_f32_16x16x32_bf16 v[224:227], a[0:3], a[228:231], v[224:227]
    v_mfma_f32_16x16x32_bf16 v[228:231], a[4:7], a[228:231], v[228:231]
    buffer_load_dwordx4 v53, s[24:27], s50 offen offset:3072 lds
    v_mfma_f32_16x16x32_bf16 v[232:235], a[8:11], a[228:231], v[232:235]
    s_add_u32 s50, s50, 262144
    v_mfma_f32_16x16x32_bf16 v[236:239], a[12:15], a[228:231], v[236:239]
    v_mfma_f32_16x16x32_bf16 v[240:243], a[16:19], a[228:231], v[240:243]
    v_mfma_f32_16x16x32_bf16 v[244:247], a[20:23], a[228:231], v[244:247]
    v_mfma_f32_16x16x32_bf16 v[248:251], a[24:27], a[228:231], v[248:251]
    v_mfma_f32_16x16x32_bf16 v[252:255], a[28:31], a[228:231], v[252:255]
    s_waitcnt lgkmcnt(0)
    v_mfma_f32_16x16x32_bf16 v[96:99], a[32:35], a[232:235], v[96:99]
    s_waitcnt vmcnt(17) lgkmcnt(0)
    v_mfma_f32_16x16x32_bf16 v[100:103], a[36:39], a[232:235], v[100:103]
    s_barrier
    v_mfma_f32_16x16x32_bf16 v[104:107], a[40:43], a[232:235], v[104:107]
    ds_read_b128 a[64:67], v48 offset:20480
    ds_read_b128 a[68:71], v48 offset:22528
    v_mfma_f32_16x16x32_bf16 v[108:111], a[44:47], a[232:235], v[108:111]
    s_add_u32 m0, s52, 49152
    ds_read_b128 a[72:75], v48 offset:24576
    ds_read_b128 a[76:79], v48 offset:26624
    v_mfma_f32_16x16x32_bf16 v[112:115], a[48:51], a[232:235], v[112:115]
    buffer_load_dwordx4 v50, s[24:27], s50 offen offset:0 lds
    v_mfma_f32_16x16x32_bf16 v[116:119], a[52:55], a[232:235], v[116:119]
    ds_read_b128 a[228:231], v48 offset:28672
    ds_read_b64_tr_b16 a[0:1], v40 offset:32768
    v_mfma_f32_16x16x32_bf16 v[120:123], a[56:59], a[232:235], v[120:123]
    ds_read_b64_tr_b16 a[2:3], v40 offset:33792
    ds_read_b64_tr_b16 a[4:5], v41 offset:32768
    v_mfma_f32_16x16x32_bf16 v[124:127], a[60:63], a[232:235], v[124:127]
    ds_read_b64_tr_b16 a[6:7], v41 offset:33792
    ds_read_b64_tr_b16 a[8:9], v42 offset:32768
    v_mfma_f32_16x16x32_bf16 v[128:131], a[32:35], a[236:239], v[128:131]
    buffer_load_dwordx4 v51, s[24:27], s50 offen offset:1024 lds
    v_mfma_f32_16x16x32_bf16 v[132:135], a[36:39], a[236:239], v[132:135]
    ds_read_b128 a[232:235], v49 offset:20480
    ds_read_b64_tr_b16 a[10:11], v42 offset:33792
    v_mfma_f32_16x16x32_bf16 v[136:139], a[40:43], a[236:239], v[136:139]
    ds_read_b64_tr_b16 a[12:13], v43 offset:32768
    ds_read_b64_tr_b16 a[14:15], v43 offset:33792
    v_mfma_f32_16x16x32_bf16 v[140:143], a[44:47], a[236:239], v[140:143]
    ds_read_b64_tr_b16 a[16:17], v44 offset:32768
    ds_read_b64_tr_b16 a[18:19], v44 offset:33792
    v_mfma_f32_16x16x32_bf16 v[144:147], a[48:51], a[236:239], v[144:147]
    buffer_load_dwordx4 v52, s[24:27], s50 offen offset:2048 lds
    v_mfma_f32_16x16x32_bf16 v[148:151], a[52:55], a[236:239], v[148:151]
    ds_read_b64_tr_b16 a[20:21], v45 offset:32768
    ds_read_b64_tr_b16 a[22:23], v45 offset:33792
    v_mfma_f32_16x16x32_bf16 v[152:155], a[56:59], a[236:239], v[152:155]
    ds_read_b64_tr_b16 a[24:25], v46 offset:32768
    ds_read_b64_tr_b16 a[26:27], v46 offset:33792
    v_mfma_f32_16x16x32_bf16 v[156:159], a[60:63], a[236:239], v[156:159]
    ds_read_b64_tr_b16 a[28:29], v47 offset:32768
    ds_read_b64_tr_b16 a[30:31], v47 offset:33792
    v_mfma_f32_16x16x32_bf16 v[160:163], a[32:35], a[240:243], v[160:163]
    buffer_load_dwordx4 v53, s[24:27], s50 offen offset:3072 lds
    v_mfma_f32_16x16x32_bf16 v[164:167], a[36:39], a[240:243], v[164:167]
    s_add_u32 s50, s50, 262144
    s_cmp_ge_u32 s50, 5242880
    s_cselect_b32 s54, 5242880, 0
    ds_read_b128 a[236:239], v49 offset:22528
    v_mfma_f32_16x16x32_bf16 v[168:171], a[40:43], a[240:243], v[168:171]
    s_sub_u32 s50, s50, s54
    s_add_u32 s75, s100, 24576
    v_mfma_f32_16x16x32_bf16 v[172:175], a[44:47], a[240:243], v[172:175]
    s_and_b32 s75, s75, s79
    s_add_u32 m0, s74, 16384
    v_mfma_f32_16x16x32_bf16 v[176:179], a[48:51], a[240:243], v[176:179]
    buffer_load_dwordx4 v16, s[80:83], s75 offen offset:0 nt lds
    v_mfma_f32_16x16x32_bf16 v[180:183], a[52:55], a[240:243], v[180:183]
    v_mfma_f32_16x16x32_bf16 v[184:187], a[56:59], a[240:243], v[184:187]
    v_mfma_f32_16x16x32_bf16 v[188:191], a[60:63], a[240:243], v[188:191]
    v_mfma_f32_16x16x32_bf16 v[192:195], a[32:35], a[244:247], v[192:195]
    buffer_load_dwordx4 v17, s[80:83], s75 offen offset:1024 nt lds
    v_mfma_f32_16x16x32_bf16 v[196:199], a[36:39], a[244:247], v[196:199]
    s_add_u32 s75, s101, 24576
    s_and_b32 s75, s75, s79
    ds_read_b128 a[240:243], v49 offset:24576
    v_mfma_f32_16x16x32_bf16 v[200:203], a[40:43], a[244:247], v[200:203]
    s_add_u32 s75, s75, 131072
    v_mfma_f32_16x16x32_bf16 v[204:207], a[44:47], a[244:247], v[204:207]
    s_add_u32 m0, s74, 24576
    v_mfma_f32_16x16x32_bf16 v[208:211], a[48:51], a[244:247], v[208:211]
    buffer_load_dwordx4 v16, s[80:83], s75 offen offset:0 nt lds
    v_mfma_f32_16x16x32_bf16 v[212:215], a[52:55], a[244:247], v[212:215]
    v_mfma_f32_16x16x32_bf16 v[216:219], a[56:59], a[244:247], v[216:219]
    v_mfma_f32_16x16x32_bf16 v[220:223], a[60:63], a[244:247], v[220:223]
    v_mfma_f32_16x16x32_bf16 v[224:227], a[32:35], a[248:251], v[224:227]
    buffer_load_dwordx4 v17, s[80:83], s75 offen offset:1024 nt lds
    v_mfma_f32_16x16x32_bf16 v[228:231], a[36:39], a[248:251], v[228:231]
    ds_read_b128 a[244:247], v49 offset:26624
    v_mfma_f32_16x16x32_bf16 v[232:235], a[40:43], a[248:251], v[232:235]
    v_mfma_f32_16x16x32_bf16 v[236:239], a[44:47], a[248:251], v[236:239]
    v_mfma_f32_16x16x32_bf16 v[240:243], a[48:51], a[248:251], v[240:243]
    v_mfma_f32_16x16x32_bf16 v[244:247], a[52:55], a[248:251], v[244:247]
    v_mfma_f32_16x16x32_bf16 v[248:251], a[56:59], a[248:251], v[248:251]
    v_mfma_f32_16x16x32_bf16 v[252:255], a[60:63], a[248:251], v[252:255]
    ds_read_b128 a[248:251], v49 offset:28672
    s_waitcnt lgkmcnt(1)
    v_mfma_f32_16x16x32_bf16 v[96:99], a[0:3], a[64:67], v[96:99]
    v_mfma_f32_16x16x32_bf16 v[100:103], a[4:7], a[64:67], v[100:103]
    v_mfma_f32_16x16x32_bf16 v[104:107], a[8:11], a[64:67], v[104:107]
    v_mfma_f32_16x16x32_bf16 v[108:111], a[12:15], a[64:67], v[108:111]
    v_mfma_f32_16x16x32_bf16 v[112:115], a[16:19], a[64:67], v[112:115]
    v_mfma_f32_16x16x32_bf16 v[116:119], a[20:23], a[64:67], v[116:119]
    s_waitcnt vmcnt(17) lgkmcnt(0)
    v_mfma_f32_16x16x32_bf16 v[120:123], a[24:27], a[64:67], v[120:123]
    s_barrier
    v_mfma_f32_16x16x32_bf16 v[124:127], a[28:31], a[64:67], v[124:127]
    ds_read_b64_tr_b16 a[32:33], v40 offset:49152
    ds_read_b64_tr_b16 a[34:35], v40 offset:50176
    v_mfma_f32_16x16x32_bf16 v[128:131], a[0:3], a[68:71], v[128:131]
    s_add_u32 m0, s57, 139264
    ds_read_b64_tr_b16 a[36:37], v41 offset:49152
    ds_read_b64_tr_b16 a[38:39], v41 offset:50176
    v_mfma_f32_16x16x32_bf16 v[132:135], a[4:7], a[68:71], v[132:135]
    buffer_load_dwordx4 v54, s[20:23], s51 offen offset:0 lds
    v_mfma_f32_16x16x32_bf16 v[136:139], a[8:11], a[68:71], v[136:139]
    ds_read_b64_tr_b16 a[40:41], v42 offset:49152
    ds_read_b64_tr_b16 a[42:43], v42 offset:50176
    v_mfma_f32_16x16x32_bf16 v[140:143], a[12:15], a[68:71], v[140:143]
    ds_read_b64_tr_b16 a[44:45], v43 offset:49152
    ds_read_b64_tr_b16 a[46:47], v43 offset:50176
    v_mfma_f32_16x16x32_bf16 v[144:147], a[16:19], a[68:71], v[144:147]
    buffer_load_dwordx4 v55, s[20:23], s51 offen offset:1024 lds
    v_mfma_f32_16x16x32_bf16 v[148:151], a[20:23], a[68:71], v[148:151]
    ds_read_b64_tr_b16 a[48:49], v44 offset:49152
    ds_read_b64_tr_b16 a[50:51], v44 offset:50176
    v_mfma_f32_16x16x32_bf16 v[152:155], a[24:27], a[68:71], v[152:155]
    ds_read_b64_tr_b16 a[52:53], v45 offset:49152
    ds_read_b64_tr_b16 a[54:55], v45 offset:50176
    v_mfma_f32_16x16x32_bf16 v[156:159], a[28:31], a[68:71], v[156:159]
    buffer_load_dwordx4 v56, s[20:23], s51 offen offset:2048 lds
    v_mfma_f32_16x16x32_bf16 v[160:163], a[0:3], a[72:75], v[160:163]
    s_add_u32 m0, s57, 142336
    ds_read_b64_tr_b16 a[56:57], v46 offset:49152
    ds_read_b64_tr_b16 a[58:59], v46 offset:50176
    v_mfma_f32_16x16x32_bf16 v[164:167], a[4:7], a[72:75], v[164:167]
    ds_read_b64_tr_b16 a[60:61], v47 offset:49152
    ds_read_b64_tr_b16 a[62:63], v47 offset:50176
    v_mfma_f32_16x16x32_bf16 v[168:171], a[8:11], a[72:75], v[168:171]
    buffer_load_dwordx4 v57, s[20:23], s51 offen offset:0 lds
    v_mfma_f32_16x16x32_bf16 v[172:175], a[12:15], a[72:75], v[172:175]
    ds_read_b64_tr_b16 a[176:177], v8 offset:32768
    ds_read_b64_tr_b16 a[178:179], v8 offset:36864
    v_mfma_f32_16x16x32_bf16 v[176:179], a[16:19], a[72:75], v[176:179]
    ds_read_b64_tr_b16 a[180:181], v9 offset:32768
    ds_read_b64_tr_b16 a[182:183], v9 offset:36864
    v_mfma_f32_16x16x32_bf16 v[180:183], a[20:23], a[72:75], v[180:183]
    buffer_load_dwordx4 v58, s[20:23], s51 offen offset:1024 lds
    v_mfma_f32_16x16x32_bf16 v[184:187], a[24:27], a[72:75], v[184:187]
    s_add_u32 s51, s51, 128
    s_cmp_ge_u32 s51, s55
    s_cselect_b32 s54, 1280, 0
    v_mfma_f32_16x16x32_bf16 v[188:191], a[28:31], a[72:75], v[188:191]
    s_sub_u32 s51, s51, s54
    s_add_u32 m0, s52, 65536
    ds_read_b64_tr_b16 a[184:185], v10 offset:32768
    v_mfma_f32_16x16x32_bf16 v[192:195], a[0:3], a[76:79], v[192:195]
    buffer_load_dwordx4 v50, s[24:27], s50 offen offset:0 lds
    v_mfma_f32_16x16x32_bf16 v[196:199], a[4:7], a[76:79], v[196:199]
    ds_read_b64_tr_b16 a[186:187], v10 offset:36864
    ds_read_b64_tr_b16 a[188:189], v11 offset:32768
    v_mfma_f32_16x16x32_bf16 v[200:203], a[8:11], a[76:79], v[200:203]
    ds_read_b64_tr_b16 a[190:191], v11 offset:36864
    ds_read_b64_tr_b16 a[192:193], v12 offset:32768
    v_mfma_f32_16x16x32_bf16 v[204:207], a[12:15], a[76:79], v[204:207]
    buffer_load_dwordx4 v51, s[24:27], s50 offen offset:1024 lds
    v_mfma_f32_16x16x32_bf16 v[208:211], a[16:19], a[76:79], v[208:211]
    ds_read_b64_tr_b16 a[194:195], v12 offset:36864
    ds_read_b64_tr_b16 a[196:197], v13 offset:32768
    v_mfma_f32_16x16x32_bf16 v[212:215], a[20:23], a[76:79], v[212:215]
    ds_read_b64_tr_b16 a[198:199], v13 offset:36864
    ds_read_b64_tr_b16 a[200:201], v14 offset:32768
    v_mfma_f32_16x16x32_bf16 v[216:219], a[24:27], a[76:79], v[216:219]
    buffer_load_dwordx4 v52, s[24:27], s50 offen offset:2048 lds
    v_mfma_f32_16x16x32_bf16 v[220:223], a[28:31], a[76:79], v[220:223]
    ds_read_b64_tr_b16 a[202:203], v14 offset:36864
    ds_read_b64_tr_b16 a[204:205], v15 offset:32768
    v_mfma_f32_16x16x32_bf16 v[224:227], a[0:3], a[228:231], v[224:227]
    ds_read_b64_tr_b16 a[206:207], v15 offset:36864
    v_mfma_f32_16x16x32_bf16 v[228:231], a[4:7], a[228:231], v[228:231]
    buffer_load_dwordx4 v53, s[24:27], s50 offen offset:3072 lds
    v_mfma_f32_16x16x32_bf16 v[232:235], a[8:11], a[228:231], v[232:235]
    s_add_u32 s50, s50, 262144
    v_mfma_f32_16x16x32_bf16 v[236:239], a[12:15], a[228:231], v[236:239]
    v_mfma_f32_16x16x32_bf16 v[240:243], a[16:19], a[228:231], v[240:243]
    v_mfma_f32_16x16x32_bf16 v[244:247], a[20:23], a[228:231], v[244:247]
    v_mfma_f32_16x16x32_bf16 v[248:251], a[24:27], a[228:231], v[248:251]
    v_mfma_f32_16x16x32_bf16 v[252:255], a[28:31], a[228:231], v[252:255]
    s_waitcnt lgkmcnt(0)
    v_mfma_f32_16x16x32_bf16 v[96:99], a[32:35], a[232:235], v[96:99]
    s_waitcnt vmcnt(17) lgkmcnt(0)
    v_mfma_f32_16x16x32_bf16 v[100:103], a[36:39], a[232:235], v[100:103]
    s_barrier
    v_mfma_f32_16x16x32_bf16 v[104:107], a[40:43], a[232:235], v[104:107]
    ds_read_b128 a[64:67], v48 offset:0
    ds_read_b128 a[68:71], v48 offset:2048
    v_mfma_f32_16x16x32_bf16 v[108:111], a[44:47], a[232:235], v[108:111]
    s_add_u32 m0, s52, 81920
    ds_read_b128 a[72:75], v48 offset:4096
    ds_read_b128 a[76:79], v48 offset:6144
    v_mfma_f32_16x16x32_bf16 v[112:115], a[48:51], a[232:235], v[112:115]
    buffer_load_dwordx4 v50, s[24:27], s50 offen offset:0 lds
    v_mfma_f32_16x16x32_bf16 v[116:119], a[52:55], a[232:235], v[116:119]
    ds_read_b128 a[228:231], v48 offset:8192
    ds_read_b64_tr_b16 a[0:1], v40 offset:0
    v_mfma_f32_16x16x32_bf16 v[120:123], a[56:59], a[232:235], v[120:123]
    ds_read_b64_tr_b16 a[2:3], v40 offset:1024
    ds_read_b64_tr_b16 a[4:5], v41 offset:0
    v_mfma_f32_16x16x32_bf16 v[124:127], a[60:63], a[232:235], v[124:127]
    ds_read_b64_tr_b16 a[6:7], v41 offset:1024
    ds_read_b64_tr_b16 a[8:9], v42 offset:0
    v_mfma_f32_16x16x32_bf16 v[128:131], a[32:35], a[236:239], v[128:131]
    buffer_load_dwordx4 v51, s[24:27], s50 offen offset:1024 lds
    v_mfma_f32_16x16x32_bf16 v[132:135], a[36:39], a[236:239], v[132:135]
    ds_read_b128 a[232:235], v49 offset:0
    ds_read_b64_tr_b16 a[10:11], v42 offset:1024
    v_mfma_f32_16x16x32_bf16 v[136:139], a[40:43], a[236:239], v[136:139]
    ds_read_b64_tr_b16 a[12:13], v43 offset:0
    ds_read_b64_tr_b16 a[14:15], v43 offset:1024
    v_mfma_f32_16x16x32_bf16 v[140:143], a[44:47], a[236:239], v[140:143]
    ds_read_b64_tr_b16 a[16:17], v44 offset:0
    ds_read_b64_tr_b16 a[18:19], v44 offset:1024
    v_mfma_f32_16x16x32_bf16 v[144:147], a[48:51], a[236:239], v[144:147]
    buffer_load_dwordx4 v52, s[24:27], s50 offen offset:2048 lds
    v_mfma_f32_16x16x32_bf16 v[148:151], a[52:55], a[236:239], v[148:151]
    ds_read_b64_tr_b16 a[20:21], v45 offset:0
    ds_read_b64_tr_b16 a[22:23], v45 offset:1024
    v_mfma_f32_16x16x32_bf16 v[152:155], a[56:59], a[236:239], v[152:155]
    ds_read_b64_tr_b16 a[24:25], v46 offset:0
    ds_read_b64_tr_b16 a[26:27], v46 offset:1024
    v_mfma_f32_16x16x32_bf16 v[156:159], a[60:63], a[236:239], v[156:159]
    ds_read_b64_tr_b16 a[28:29], v47 offset:0
    ds_read_b64_tr_b16 a[30:31], v47 offset:1024
    v_mfma_f32_16x16x32_bf16 v[160:163], a[32:35], a[240:243], v[160:163]
    buffer_load_dwordx4 v53, s[24:27], s50 offen offset:3072 lds
    v_mfma_f32_16x16x32_bf16 v[164:167], a[36:39], a[240:243], v[164:167]
    s_add_u32 s50, s50, 262144
    s_cmp_ge_u32 s50, 5242880
    s_cselect_b32 s54, 5242880, 0
    ds_read_b128 a[236:239], v49 offset:2048
    v_mfma_f32_16x16x32_bf16 v[168:171], a[40:43], a[240:243], v[168:171]
    s_sub_u32 s50, s50, s54
    s_add_u32 s75, s100, 16384
    v_mfma_f32_16x16x32_bf16 v[172:175], a[44:47], a[240:243], v[172:175]
    s_and_b32 s75, s75, s79
    s_add_u32 m0, s74, 98304
    v_mfma_f32_16x16x32_bf16 v[176:179], a[48:51], a[240:243], v[176:179]
    buffer_load_dwordx4 v18, s[84:87], s75 offen offset:0 nt lds
    v_mfma_f32_16x16x32_bf16 v[180:183], a[52:55], a[240:243], v[180:183]
    v_mfma_f32_16x16x32_bf16 v[184:187], a[56:59], a[240:243], v[184:187]
    v_mfma_f32_16x16x32_bf16 v[188:191], a[60:63], a[240:243], v[188:191]
    v_mfma_f32_16x16x32_bf16 v[192:195], a[32:35], a[244:247], v[192:195]
    buffer_load_dwordx4 v19, s[84:87], s75 offen offset:1024 nt lds
    v_mfma_f32_16x16x32_bf16 v[196:199], a[36:39], a[244:247], v[196:199]
    s_add_u32 s75, s101, 16384
    s_and_b32 s75, s75, s79
    ds_read_b128 a[240:243], v49 offset:4096
    v_mfma_f32_16x16x32_bf16 v[200:203], a[40:43], a[244:247], v[200:203]
    s_add_u32 s75, s75, 131072
    v_mfma_f32_16x16x32_bf16 v[204:207], a[44:47], a[244:247], v[204:207]
    s_add_u32 m0, s74, 106496
    v_mfma_f32_16x16x32_bf16 v[208:211], a[48:51], a[244:247], v[208:211]
    buffer_load_dwordx4 v18, s[84:87], s75 offen offset:0 nt lds
    v_mfma_f32_16x16x32_bf16 v[212:215], a[52:55], a[244:247], v[212:215]
    v_mfma_f32_16x16x32_bf16 v[216:219], a[56:59], a[244:247], v[216:219]
    v_mfma_f32_16x16x32_bf16 v[220:223], a[60:63], a[244:247], v[220:223]
    v_mfma_f32_16x16x32_bf16 v[224:227], a[32:35], a[248:251], v[224:227]
    buffer_load_dwordx4 v19, s[84:87], s75 offen offset:1024 nt lds
    v_mfma_f32_16x16x32_bf16 v[228:231], a[36:39], a[248:251], v[228:231]
    ds_read_b128 a[244:247], v49 offset:6144
    v_mfma_f32_16x16x32_bf16 v[232:235], a[40:43], a[248:251], v[232:235]
    v_mfma_f32_16x16x32_bf16 v[236:239], a[44:47], a[248:251], v[236:239]
    v_mfma_f32_16x16x32_bf16 v[240:243], a[48:51], a[248:251], v[240:243]
    v_mfma_f32_16x16x32_bf16 v[244:247], a[52:55], a[248:251], v[244:247]
    v_mfma_f32_16x16x32_bf16 v[248:251], a[56:59], a[248:251], v[248:251]
    v_mfma_f32_16x16x32_bf16 v[252:255], a[60:63], a[248:251], v[252:255]
    ds_read_b128 a[248:251], v49 offset:8192
    s_waitcnt lgkmcnt(1)
    v_mfma_f32_16x16x32_bf16 v[96:99], a[0:3], a[64:67], v[96:99]
    v_mfma_f32_16x16x32_bf16 v[100:103], a[4:7], a[64:67], v[100:103]
    v_mfma_f32_16x16x32_bf16 v[104:107], a[8:11], a[64:67], v[104:107]
    v_mfma_f32_16x16x32_bf16 v[108:111], a[12:15], a[64:67], v[108:111]
    v_mfma_f32_16x16x32_bf16 v[112:115], a[16:19], a[64:67], v[112:115]
    v_mfma_f32_16x16x32_bf16 v[116:119], a[20:23], a[64:67], v[116:119]
    s_waitcnt vmcnt(21) lgkmcnt(0)
    v_mfma_f32_16x16x32_bf16 v[120:123], a[24:27], a[64:67], v[120:123]
    s_barrier
    v_mfma_f32_16x16x32_bf16 v[124:127], a[28:31], a[64:67], v[124:127]
    ds_read_b64_tr_b16 a[32:33], v40 offset:16384
    ds_read_b64_tr_b16 a[34:35], v40 offset:17408
    v_mfma_f32_16x16x32_bf16 v[128:131], a[0:3], a[68:71], v[128:131]
    s_add_u32 s75, s100, 24576
    s_and_b32 s75, s75, s79
    s_add_u32 m0, s74, 114688
    v_mfma_f32_16x16x32_bf16 v[132:135], a[4:7], a[68:71], v[132:135]
    buffer_load_dwordx4 v18, s[84:87], s75 offen offset:0 nt lds
    v_mfma_f32_16x16x32_bf16 v[136:139], a[8:11], a[68:71], v[136:139]
    ds_read_b64_tr_b16 a[36:37], v41 offset:16384
    ds_read_b64_tr_b16 a[38:39], v41 offset:17408
    v_mfma_f32_16x16x32_bf16 v[140:143], a[12:15], a[68:71], v[140:143]
    ds_read_b64_tr_b16 a[40:41], v42 offset:16384
    ds_read_b64_tr_b16 a[42:43], v42 offset:17408
    v_mfma_f32_16x16x32_bf16 v[144:147], a[16:19], a[68:71], v[144:147]
    ds_read_b64_tr_b16 a[44:45], v43 offset:16384
    ds_read_b64_tr_b16 a[46:47], v43 offset:17408
    v_mfma_f32_16x16x32_bf16 v[148:151], a[20:23], a[68:71], v[148:151]
    buffer_load_dwordx4 v19, s[84:87], s75 offen offset:1024 nt lds
    v_mfma_f32_16x16x32_bf16 v[152:155], a[24:27], a[68:71], v[152:155]
    s_add_u32 s75, s101, 24576
    ds_read_b64_tr_b16 a[48:49], v44 offset:16384
    ds_read_b64_tr_b16 a[50:51], v44 offset:17408
    v_mfma_f32_16x16x32_bf16 v[156:159], a[28:31], a[68:71], v[156:159]
    s_and_b32 s75, s75, s79
    ds_read_b64_tr_b16 a[52:53], v45 offset:16384
    ds_read_b64_tr_b16 a[54:55], v45 offset:17408
    v_mfma_f32_16x16x32_bf16 v[160:163], a[0:3], a[72:75], v[160:163]
    s_add_u32 s75, s75, 131072
    ds_read_b64_tr_b16 a[56:57], v46 offset:16384
    ds_read_b64_tr_b16 a[58:59], v46 offset:17408
    v_mfma_f32_16x16x32_bf16 v[164:167], a[4:7], a[72:75], v[164:167]
    s_add_u32 m0, s74, 122880
    ds_read_b64_tr_b16 a[60:61], v47 offset:16384
    ds_read_b64_tr_b16 a[62:63], v47 offset:17408
    v_mfma_f32_16x16x32_bf16 v[168:171], a[8:11], a[72:75], v[168:171]
    buffer_load_dwordx4 v18, s[84:87], s75 offen offset:0 nt lds
    v_mfma_f32_16x16x32_bf16 v[172:175], a[12:15], a[72:75], v[172:175]
    v_mfma_f32_16x16x32_bf16 v[176:179], a[16:19], a[72:75], v[176:179]
    v_mfma_f32_16x16x32_bf16 v[180:183], a[20:23], a[72:75], v[180:183]
    v_mfma_f32_16x16x32_bf16 v[184:187], a[24:27], a[72:75], v[184:187]
    v_mfma_f32_16x16x32_bf16 v[188:191], a[28:31], a[72:75], v[188:191]
    buffer_load_dwordx4 v19, s[84:87], s75 offen offset:1024 nt lds
    v_mfma_f32_16x16x32_bf16 v[192:195], a[0:3], a[76:79], v[192:195]
    s_add_u32 s75, s100, 32768
    v_mfma_f32_16x16x32_bf16 v[196:199], a[4:7], a[76:79], v[196:199]
    s_and_b32 s75, s75, s79
    v_mfma_f32_16x16x32_bf16 v[200:203], a[8:11], a[76:79], v[200:203]
    s_add_u32 m0, s74, 32768
    v_mfma_f32_16x16x32_bf16 v[204:207], a[12:15], a[76:79], v[204:207]
    buffer_load_dwordx4 v16, s[80:83], s75 offen offset:0 nt lds
    v_mfma_f32_16x16x32_bf16 v[208:211], a[16:19], a[76:79], v[208:211]
    v_mfma_f32_16x16x32_bf16 v[212:215], a[20:23], a[76:79], v[212:215]
    v_mfma_f32_16x16x32_bf16 v[216:219], a[24:27], a[76:79], v[216:219]
    v_mfma_f32_16x16x32_bf16 v[220:223], a[28:31], a[76:79], v[220:223]
    v_mfma_f32_16x16x32_bf16 v[224:227], a[0:3], a[228:231], v[224:227]
    buffer_load_dwordx4 v17, s[80:83], s75 offen offset:1024 nt lds
    v_mfma_f32_16x16x32_bf16 v[228:231], a[4:7], a[228:231], v[228:231]
    v_mfma_f32_16x16x32_bf16 v[232:235], a[8:11], a[228:231], v[232:235]
    v_mfma_f32_16x16x32_bf16 v[236:239], a[12:15], a[228:231], v[236:239]
    v_mfma_f32_16x16x32_bf16 v[240:243], a[16:19], a[228:231], v[240:243]
    v_mfma_f32_16x16x32_bf16 v[244:247], a[20:23], a[228:231], v[244:247]
    v_mfma_f32_16x16x32_bf16 v[248:251], a[24:27], a[228:231], v[248:251]
    v_mfma_f32_16x16x32_bf16 v[252:255], a[28:31], a[228:231], v[252:255]
    s_waitcnt lgkmcnt(0)
    v_mfma_f32_16x16x32_bf16 v[96:99], a[32:35], a[232:235], v[96:99]
    s_waitcnt vmcnt(14) lgkmcnt(0)
    v_mfma_f32_16x16x32_bf16 v[100:103], a[36:39], a[232:235], v[100:103]
    s_barrier
    v_mfma_f32_16x16x32_bf16 v[104:107], a[40:43], a[232:235], v[104:107]
    ds_read_b128 a[64:67], v48 offset:20480
    ds_read_b128 a[68:71], v48 offset:22528
    v_mfma_f32_16x16x32_bf16 v[108:111], a[44:47], a[232:235], v[108:111]
    s_add_u32 s75, s101, 32768
    s_and_b32 s75, s75, s79
    s_add_u32 s75, s75, 131072
    s_add_u32 m0, s74, 40960
    v_mfma_f32_16x16x32_bf16 v[112:115], a[48:51], a[232:235], v[112:115]
    buffer_load_dwordx4 v16, s[80:83], s75 offen offset:0 nt lds
    v_mfma_f32_16x16x32_bf16 v[116:119], a[52:55], a[232:235], v[116:119]
    ds_read_b128 a[72:75], v48 offset:24576
    ds_read_b128 a[76:79], v48 offset:26624
    v_mfma_f32_16x16x32_bf16 v[120:123], a[56:59], a[232:235], v[120:123]
    ds_read_b128 a[228:231], v48 offset:28672
    ds_read_b64_tr_b16 a[0:1], v40 offset:32768
    v_mfma_f32_16x16x32_bf16 v[124:127], a[60:63], a[232:235], v[124:127]
    ds_read_b64_tr_b16 a[2:3], v40 offset:33792
    ds_read_b64_tr_b16 a[4:5], v41 offset:32768
    v_mfma_f32_16x16x32_bf16 v[128:131], a[32:35], a[236:239], v[128:131]
    ds_read_b128 a[232:235], v49 offset:20480
    ds_read_b64_tr_b16 a[6:7], v41 offset:33792
    v_mfma_f32_16x16x32_bf16 v[132:135], a[36:39], a[236:239], v[132:135]
    ds_read_b64_tr_b16 a[8:9], v42 offset:32768
    ds_read_b64_tr_b16 a[10:11], v42 offset:33792
    v_mfma_f32_16x16x32_bf16 v[136:139], a[40:43], a[236:239], v[136:139]
    ds_read_b64_tr_b16 a[12:13], v43 offset:32768
    ds_read_b64_tr_b16 a[14:15], v43 offset:33792
    v_mfma_f32_16x16x32_bf16 v[140:143], a[44:47], a[236:239], v[140:143]
    ds_read_b64_tr_b16 a[16:17], v44 offset:32768
    ds_read_b64_tr_b16 a[18:19], v44 offset:33792
    v_mfma_f32_16x16x32_bf16 v[144:147], a[48:51], a[236:239], v[144:147]
    ds_read_b64_tr_b16 a[20:21], v45 offset:32768
    ds_read_b64_tr_b16 a[22:23], v45 offset:33792
    v_mfma_f32_16x16x32_bf16 v[148:151], a[52:55], a[236:239], v[148:151]
    ds_read_b64_tr_b16 a[24:25], v46 offset:32768
    ds_read_b64_tr_b16 a[26:27], v46 offset:33792
    v_mfma_f32_16x16x32_bf16 v[152:155], a[56:59], a[236:239], v[152:155]
    ds_read_b64_tr_b16 a[28:29], v47 offset:32768
    ds_read_b64_tr_b16 a[30:31], v47 offset:33792
    v_mfma_f32_16x16x32_bf16 v[156:159], a[60:63], a[236:239], v[156:159]
    v_mfma_f32_16x16x32_bf16 v[160:163], a[32:35], a[240:243], v[160:163]
    ds_read_b128 a[236:239], v49 offset:22528
    v_mfma_f32_16x16x32_bf16 v[164:167], a[36:39], a[240:243], v[164:167]
    v_mfma_f32_16x16x32_bf16 v[168:171], a[40:43], a[240:243], v[168:171]
    v_mfma_f32_16x16x32_bf16 v[172:175], a[44:47], a[240:243], v[172:175]
    v_mfma_f32_16x16x32_bf16 v[176:179], a[48:51], a[240:243], v[176:179]
    buffer_load_dwordx4 v17, s[80:83], s75 offen offset:1024 nt lds
    v_mfma_f32_16x16x32_bf16 v[180:183], a[52:55], a[240:243], v[180:183]
    v_mfma_f32_16x16x32_bf16 v[184:187], a[56:59], a[240:243], v[184:187]
    v_mfma_f32_16x16x32_bf16 v[188:191], a[60:63], a[240:243], v[188:191]
    v_mfma_f32_16x16x32_bf16 v[192:195], a[32:35], a[244:247], v[192:195]
    ds_read_b128 a[240:243], v49 offset:24576
    v_mfma_f32_16x16x32_bf16 v[196:199], a[36:39], a[244:247], v[196:199]
    v_mfma_f32_16x16x32_bf16 v[200:203], a[40:43], a[244:247], v[200:203]
    v_mfma_f32_16x16x32_bf16 v[204:207], a[44:47], a[244:247], v[204:207]
    v_mfma_f32_16x16x32_bf16 v[208:211], a[48:51], a[244:247], v[208:211]
    v_mfma_f32_16x16x32_bf16 v[212:215], a[52:55], a[244:247], v[212:215]
    v_mfma_f32_16x16x32_bf16 v[216:219], a[56:59], a[244:247], v[216:219]
    v_mfma_f32_16x16x32_bf16 v[220:223], a[60:63], a[244:247], v[220:223]
    v_mfma_f32_16x16x32_bf16 v[224:227], a[32:35], a[248:251], v[224:227]
    ds_read_b128 a[244:247], v49 offset:26624
    v_mfma_f32_16x16x32_bf16 v[228:231], a[36:39], a[248:251], v[228:231]
    v_mfma_f32_16x16x32_bf16 v[232:235], a[40:43], a[248:251], v[232:235]
    v_mfma_f32_16x16x32_bf16 v[236:239], a[44:47], a[248:251], v[236:239]
    v_mfma_f32_16x16x32_bf16 v[240:243], a[48:51], a[248:251], v[240:243]
    v_mfma_f32_16x16x32_bf16 v[244:247], a[52:55], a[248:251], v[244:247]
    v_mfma_f32_16x16x32_bf16 v[248:251], a[56:59], a[248:251], v[248:251]
    v_mfma_f32_16x16x32_bf16 v[252:255], a[60:63], a[248:251], v[252:255]
    ds_read_b128 a[248:251], v49 offset:28672
    s_waitcnt lgkmcnt(1)
    v_mfma_f32_16x16x32_bf16 v[96:99], a[0:3], a[64:67], v[96:99]
    v_mfma_f32_16x16x32_bf16 v[100:103], a[4:7], a[64:67], v[100:103]
    v_mfma_f32_16x16x32_bf16 v[104:107], a[8:11], a[64:67], v[104:107]
    v_mfma_f32_16x16x32_bf16 v[108:111], a[12:15], a[64:67], v[108:111]
    v_mfma_f32_16x16x32_bf16 v[112:115], a[16:19], a[64:67], v[112:115]
    v_mfma_f32_16x16x32_bf16 v[116:119], a[20:23], a[64:67], v[116:119]
    s_waitcnt vmcnt(12) lgkmcnt(0)
    v_mfma_f32_16x16x32_bf16 v[120:123], a[24:27], a[64:67], v[120:123]
    s_barrier
    v_mfma_f32_16x16x32_bf16 v[124:127], a[28:31], a[64:67], v[124:127]
    ds_read_b64_tr_b16 a[32:33], v40 offset:49152
    ds_read_b64_tr_b16 a[34:35], v40 offset:50176
    v_mfma_f32_16x16x32_bf16 v[128:131], a[0:3], a[68:71], v[128:131]
    s_add_u32 s75, s100, 32768
    s_and_b32 s75, s75, s79
    s_add_u32 m0, s74, 65536
    v_mfma_f32_16x16x32_bf16 v[132:135], a[4:7], a[68:71], v[132:135]
    buffer_load_dwordx4 v18, s[84:87], s75 offen offset:0 nt lds
    v_mfma_f32_16x16x32_bf16 v[136:139], a[8:11], a[68:71], v[136:139]
    ds_read_b64_tr_b16 a[36:37], v41 offset:49152
    ds_read_b64_tr_b16 a[38:39], v41 offset:50176
    v_mfma_f32_16x16x32_bf16 v[140:143], a[12:15], a[68:71], v[140:143]
    ds_read_b64_tr_b16 a[40:41], v42 offset:49152
    ds_read_b64_tr_b16 a[42:43], v42 offset:50176
    v_mfma_f32_16x16x32_bf16 v[144:147], a[16:19], a[68:71], v[144:147]
    ds_read_b64_tr_b16 a[44:45], v43 offset:49152
    ds_read_b64_tr_b16 a[46:47], v43 offset:50176
    v_mfma_f32_16x16x32_bf16 v[148:151], a[20:23], a[68:71], v[148:151]
    ds_read_b64_tr_b16 a[48:49], v44 offset:49152
    ds_read_b64_tr_b16 a[50:51], v44 offset:50176
    v_mfma_f32_16x16x32_bf16 v[152:155], a[24:27], a[68:71], v[152:155]
    ds_read_b64_tr_b16 a[52:53], v45 offset:49152
    ds_read_b64_tr_b16 a[54:55], v45 offset:50176
    v_mfma_f32_16x16x32_bf16 v[156:159], a[28:31], a[68:71], v[156:159]
    ds_read_b64_tr_b16 a[56:57], v46 offset:49152
    ds_read_b64_tr_b16 a[58:59], v46 offset:50176
    v_mfma_f32_16x16x32_bf16 v[160:163], a[0:3], a[72:75], v[160:163]
    buffer_load_dwordx4 v19, s[84:87], s75 offen offset:1024 nt lds
    v_mfma_f32_16x16x32_bf16 v[164:167], a[4:7], a[72:75], v[164:167]
    s_add_u32 s75, s101, 32768
    ds_read_b64_tr_b16 a[60:61], v47 offset:49152
    ds_read_b64_tr_b16 a[62:63], v47 offset:50176
    v_mfma_f32_16x16x32_bf16 v[168:171], a[8:11], a[72:75], v[168:171]
    s_and_b32 s75, s75, s79
    v_mfma_f32_16x16x32_bf16 v[172:175], a[12:15], a[72:75], v[172:175]
    v_mfma_f32_16x16x32_bf16 v[176:179], a[16:19], a[72:75], v[176:179]
    s_add_u32 s75, s75, 131072
    v_mfma_f32_16x16x32_bf16 v[180:183], a[20:23], a[72:75], v[180:183]
    s_add_u32 m0, s74, 73728
    v_mfma_f32_16x16x32_bf16 v[184:187], a[24:27], a[72:75], v[184:187]
    v_mfma_f32_16x16x32_bf16 v[188:191], a[28:31], a[72:75], v[188:191]
    buffer_load_dwordx4 v18, s[84:87], s75 offen offset:0 nt lds
    v_mfma_f32_16x16x32_bf16 v[192:195], a[0:3], a[76:79], v[192:195]
    v_mfma_f32_16x16x32_bf16 v[196:199], a[4:7], a[76:79], v[196:199]
    v_mfma_f32_16x16x32_bf16 v[200:203], a[8:11], a[76:79], v[200:203]
    v_mfma_f32_16x16x32_bf16 v[204:207], a[12:15], a[76:79], v[204:207]
    v_mfma_f32_16x16x32_bf16 v[208:211], a[16:19], a[76:79], v[208:211]
    v_mfma_f32_16x16x32_bf16 v[212:215], a[20:23], a[76:79], v[212:215]
    v_mfma_f32_16x16x32_bf16 v[216:219], a[24:27], a[76:79], v[216:219]
    buffer_load_dwordx4 v19, s[84:87], s75 offen offset:1024 nt lds
    v_mfma_f32_16x16x32_bf16 v[220:223], a[28:31], a[76:79], v[220:223]
    v_mfma_f32_16x16x32_bf16 v[224:227], a[0:3], a[228:231], v[224:227]
    v_mfma_f32_16x16x32_bf16 v[228:231], a[4:7], a[228:231], v[228:231]
    v_mfma_f32_16x16x32_bf16 v[232:235], a[8:11], a[228:231], v[232:235]
    v_mfma_f32_16x16x32_bf16 v[236:239], a[12:15], a[228:231], v[236:239]
    v_mfma_f32_16x16x32_bf16 v[240:243], a[16:19], a[228:231], v[240:243]
    v_mfma_f32_16x16x32_bf16 v[244:247], a[20:23], a[228:231], v[244:247]
    v_mfma_f32_16x16x32_bf16 v[248:251], a[24:27], a[228:231], v[248:251]
    v_mfma_f32_16x16x32_bf16 v[252:255], a[28:31], a[228:231], v[252:255]
    s_waitcnt lgkmcnt(0)
    s_mov_b32 s68, 1040356334
    s_mov_b32 s69, s68
    v_mfma_f32_16x16x32_bf16 v[96:99], a[32:35], a[232:235], v[96:99]
    v_mfma_f32_16x16x32_bf16 v[100:103], a[36:39], a[232:235], v[100:103]
    s_barrier
    v_mfma_f32_16x16x32_bf16 v[104:107], a[40:43], a[232:235], v[104:107]
    s_add_u32 s75, s100, 40960
    s_and_b32 s75, s75, s79
    v_mfma_f32_16x16x32_bf16 v[108:111], a[44:47], a[232:235], v[108:111]
    s_add_u32 m0, s74, 49152
    v_mfma_f32_16x16x32_bf16 v[112:115], a[48:51], a[232:235], v[112:115]
    buffer_load_dwordx4 v16, s[80:83], s75 offen offset:0 nt lds
    v_mfma_f32_16x16x32_bf16 v[116:119], a[52:55], a[232:235], v[116:119]
    buffer_load_dwordx4 v17, s[80:83], s75 offen offset:1024 nt lds
    v_mfma_f32_16x16x32_bf16 v[120:123], a[56:59], a[232:235], v[120:123]
    s_add_u32 s75, s101, 40960
    s_and_b32 s75, s75, s79
    v_mfma_f32_16x16x32_bf16 v[124:127], a[60:63], a[232:235], v[124:127]
    s_add_u32 s75, s75, 131072
    s_add_u32 m0, s74, 57344
    v_mfma_f32_16x16x32_bf16 v[128:131], a[32:35], a[236:239], v[128:131]
    buffer_load_dwordx4 v16, s[80:83], s75 offen offset:0 nt lds
    v_mfma_f32_16x16x32_bf16 v[132:135], a[36:39], a[236:239], v[132:135]
    buffer_load_dwordx4 v17, s[80:83], s75 offen offset:1024 nt lds
    v_mfma_f32_16x16x32_bf16 v[136:139], a[40:43], a[236:239], v[136:139]
    v_mul_f32 v96, s68, v96
    v_mul_f32 v97, s68, v97
    v_mfma_f32_16x16x32_bf16 v[140:143], a[44:47], a[236:239], v[140:143]
    v_mul_f32 v98, s68, v98
    v_mul_f32 v99, s68, v99
    v_mfma_f32_16x16x32_bf16 v[144:147], a[48:51], a[236:239], v[144:147]
    v_mul_f32 v100, s68, v100
    v_mul_f32 v101, s68, v101
    v_mfma_f32_16x16x32_bf16 v[148:151], a[52:55], a[236:239], v[148:151]
    v_mul_f32 v102, s68, v102
    v_mul_f32 v103, s68, v103
    v_mfma_f32_16x16x32_bf16 v[152:155], a[56:59], a[236:239], v[152:155]
    v_mul_f32 v104, s68, v104
    v_mul_f32 v105, s68, v105
    v_mfma_f32_16x16x32_bf16 v[156:159], a[60:63], a[236:239], v[156:159]
    v_mul_f32 v106, s68, v106
    v_mul_f32 v107, s68, v107
    v_mfma_f32_16x16x32_bf16 v[160:163], a[32:35], a[240:243], v[160:163]
    v_mul_f32 v108, s68, v108
    v_mul_f32 v109, s68, v109
    v_mfma_f32_16x16x32_bf16 v[164:167], a[36:39], a[240:243], v[164:167]
    v_mul_f32 v110, s68, v110
    v_mul_f32 v111, s68, v111
    v_mfma_f32_16x16x32_bf16 v[168:171], a[40:43], a[240:243], v[168:171]
    v_mul_f32 v112, s68, v112
    v_mul_f32 v113, s68, v113
    v_mfma_f32_16x16x32_bf16 v[172:175], a[44:47], a[240:243], v[172:175]
    v_mul_f32 v114, s68, v114
    v_mul_f32 v115, s68, v115
    v_mfma_f32_16x16x32_bf16 v[176:179], a[48:51], a[240:243], v[176:179]
    v_mul_f32 v116, s68, v116
    v_mul_f32 v117, s68, v117
    v_mfma_f32_16x16x32_bf16 v[180:183], a[52:55], a[240:243], v[180:183]
    v_mul_f32 v118, s68, v118
    v_mul_f32 v119, s68, v119
    v_mfma_f32_16x16x32_bf16 v[184:187], a[56:59], a[240:243], v[184:187]
    v_mul_f32 v120, s68, v120
    v_mul_f32 v121, s68, v121
    v_mfma_f32_16x16x32_bf16 v[188:191], a[60:63], a[240:243], v[188:191]
    v_mul_f32 v122, s68, v122
    v_mul_f32 v123, s68, v123
    v_mfma_f32_16x16x32_bf16 v[192:195], a[32:35], a[244:247], v[192:195]
    v_mul_f32 v124, s68, v124
    v_mul_f32 v125, s68, v125
    v_mfma_f32_16x16x32_bf16 v[196:199], a[36:39], a[244:247], v[196:199]
    v_mul_f32 v126, s68, v126
    v_mul_f32 v127, s68, v127
    v_mfma_f32_16x16x32_bf16 v[200:203], a[40:43], a[244:247], v[200:203]
    v_mul_f32 v128, s68, v128
    v_mul_f32 v129, s68, v129
    v_mfma_f32_16x16x32_bf16 v[204:207], a[44:47], a[244:247], v[204:207]
    v_mul_f32 v130, s68, v130
    v_mul_f32 v131, s68, v131
    v_mfma_f32_16x16x32_bf16 v[208:211], a[48:51], a[244:247], v[208:211]
    v_mul_f32 v132, s68, v132
    v_mul_f32 v133, s68, v133
    v_mfma_f32_16x16x32_bf16 v[212:215], a[52:55], a[244:247], v[212:215]
    v_mul_f32 v134, s68, v134
    v_mul_f32 v135, s68, v135
    v_mfma_f32_16x16x32_bf16 v[216:219], a[56:59], a[244:247], v[216:219]
    v_mul_f32 v136, s68, v136
    v_mul_f32 v137, s68, v137
    v_mfma_f32_16x16x32_bf16 v[220:223], a[60:63], a[244:247], v[220:223]
    v_mul_f32 v138, s68, v138
    v_mul_f32 v139, s68, v139
    v_mfma_f32_16x16x32_bf16 v[224:227], a[32:35], a[248:251], v[224:227]
    v_mul_f32 v140, s68, v140
    v_mul_f32 v141, s68, v141
    v_mfma_f32_16x16x32_bf16 v[228:231], a[36:39], a[248:251], v[228:231]
    v_mul_f32 v142, s68, v142
    v_mul_f32 v143, s68, v143
    v_mfma_f32_16x16x32_bf16 v[232:235], a[40:43], a[248:251], v[232:235]
    v_mul_f32 v144, s68, v144
    v_mul_f32 v145, s68, v145
    v_mfma_f32_16x16x32_bf16 v[236:239], a[44:47], a[248:251], v[236:239]
    v_mul_f32 v146, s68, v146
    v_mul_f32 v147, s68, v147
    v_mfma_f32_16x16x32_bf16 v[240:243], a[48:51], a[248:251], v[240:243]
    v_mul_f32 v148, s68, v148
    v_mul_f32 v149, s68, v149
    v_mfma_f32_16x16x32_bf16 v[244:247], a[52:55], a[248:251], v[244:247]
    v_mul_f32 v150, s68, v150
    v_mul_f32 v151, s68, v151
    v_mfma_f32_16x16x32_bf16 v[248:251], a[56:59], a[248:251], v[248:251]
    v_mul_f32 v152, s68, v152
    v_mul_f32 v153, s68, v153
    v_mfma_f32_16x16x32_bf16 v[252:255], a[60:63], a[248:251], v[252:255]
    v_mul_f32 v154, s68, v154
    v_mul_f32 v155, s68, v155
    v_mul_f32 v156, s68, v156
    v_mul_f32 v157, s68, v157
    v_mul_f32 v158, s68, v158
    v_mul_f32 v159, s68, v159
    v_cvt_pk_bf16_f32 v20, v96, v97
    v_cvt_pk_bf16_f32 v21, v98, v99
    v_cvt_pk_bf16_f32 v22, v100, v101
    v_cvt_pk_bf16_f32 v23, v102, v103
    v_cvt_pk_bf16_f32 v24, v104, v105
    v_cvt_pk_bf16_f32 v25, v106, v107
    v_cvt_pk_bf16_f32 v26, v108, v109
    v_cvt_pk_bf16_f32 v27, v110, v111
    v_cvt_pk_bf16_f32 v28, v112, v113
    v_cvt_pk_bf16_f32 v29, v114, v115
    v_cvt_pk_bf16_f32 v30, v116, v117
    v_cvt_pk_bf16_f32 v31, v118, v119
    v_cvt_pk_bf16_f32 v32, v120, v121
    v_cvt_pk_bf16_f32 v33, v122, v123
    v_cvt_pk_bf16_f32 v34, v124, v125
    v_cvt_pk_bf16_f32 v35, v126, v127
    v_permlane16_swap_b32 v20, v22
    v_permlane16_swap_b32 v21, v23
    v_permlane16_swap_b32 v24, v26
    v_permlane16_swap_b32 v25, v27
    v_permlane16_swap_b32 v28, v30
    v_permlane16_swap_b32 v29, v31
    v_permlane16_swap_b32 v32, v34
    v_permlane16_swap_b32 v33, v35
    v_accvgpr_write_b32 a0, v20
    v_accvgpr_write_b32 a1, v21
    v_accvgpr_write_b32 a2, v22
    v_accvgpr_write_b32 a3, v23
    v_accvgpr_write_b32 a4, v24
    v_accvgpr_write_b32 a5, v25
    v_accvgpr_write_b32 a6, v26
    v_accvgpr_write_b32 a7, v27
    v_accvgpr_write_b32 a8, v28
    v_accvgpr_write_b32 a9, v29
    v_accvgpr_write_b32 a10, v30
    v_accvgpr_write_b32 a11, v31
    v_accvgpr_write_b32 a12, v32
    v_accvgpr_write_b32 a13, v33
    v_accvgpr_write_b32 a14, v34
    v_accvgpr_write_b32 a15, v35
    s_nop 1
    s_waitcnt lgkmcnt(0)
    v_mfma_f32_16x16x32_bf16 v[40:43], a[80:83], a[0:3], 0
    v_mfma_f32_16x16x32_bf16 v[40:43], a[84:87], a[4:7], v[40:43]
    v_mfma_f32_16x16x32_bf16 v[40:43], a[88:91], a[8:11], v[40:43]
    v_mfma_f32_16x16x32_bf16 v[40:43], a[92:95], a[12:15], v[40:43]
    v_cvt_pk_bf16_f32 v20, v128, v129
    v_cvt_pk_bf16_f32 v21, v130, v131
    v_cvt_pk_bf16_f32 v22, v132, v133
    v_cvt_pk_bf16_f32 v23, v134, v135
    v_cvt_pk_bf16_f32 v24, v136, v137
    v_cvt_pk_bf16_f32 v25, v138, v139
    v_cvt_pk_bf16_f32 v26, v140, v141
    v_cvt_pk_bf16_f32 v27, v142, v143
    v_cvt_pk_bf16_f32 v28, v144, v145
    v_cvt_pk_bf16_f32 v29, v146, v147
    v_cvt_pk_bf16_f32 v30, v148, v149
    v_cvt_pk_bf16_f32 v31, v150, v151
    v_cvt_pk_bf16_f32 v32, v152, v153
    v_cvt_pk_bf16_f32 v33, v154, v155
    v_cvt_pk_bf16_f32 v34, v156, v157
    v_cvt_pk_bf16_f32 v35, v158, v159
    v_permlane16_swap_b32 v20, v22
    v_permlane16_swap_b32 v21, v23
    v_permlane16_swap_b32 v24, v26
    v_permlane16_swap_b32 v25, v27
    v_permlane16_swap_b32 v28, v30
    v_permlane16_swap_b32 v29, v31
    v_permlane16_swap_b32 v32, v34
    v_permlane16_swap_b32 v33, v35
    v_accvgpr_write_b32 a16, v20
    v_accvgpr_write_b32 a17, v21
    v_accvgpr_write_b32 a18, v22
    v_accvgpr_write_b32 a19, v23
    v_accvgpr_write_b32 a20, v24
    v_accvgpr_write_b32 a21, v25
    v_accvgpr_write_b32 a22, v26
    v_accvgpr_write_b32 a23, v27
    v_accvgpr_write_b32 a24, v28
    v_accvgpr_write_b32 a25, v29
    v_accvgpr_write_b32 a26, v30
    v_accvgpr_write_b32 a27, v31
    v_accvgpr_write_b32 a28, v32
    v_accvgpr_write_b32 a29, v33
    v_accvgpr_write_b32 a30, v34
    v_accvgpr_write_b32 a31, v35
    s_nop 1
    v_mfma_f32_16x16x32_bf16 v[44:47], a[80:83], a[16:19], 0
    v_mfma_f32_16x16x32_bf16 v[44:47], a[84:87], a[20:23], v[44:47]
    v_mfma_f32_16x16x32_bf16 v[44:47], a[88:91], a[24:27], v[44:47]
    v_mfma_f32_16x16x32_bf16 v[44:47], a[92:95], a[28:31], v[44:47]
    v_pk_mul_f32 v[160:161], v[160:161], s[68:69]
    v_pk_mul_f32 v[162:163], v[162:163], s[68:69]
    v_pk_mul_f32 v[164:165], v[164:165], s[68:69]
    v_pk_mul_f32 v[166:167], v[166:167], s[68:69]
    v_cvt_pk_bf16_f32 v20, v160, v161
    v_cvt_pk_bf16_f32 v21, v162, v163
    v_cvt_pk_bf16_f32 v22, v164, v165
    v_cvt_pk_bf16_f32 v23, v166, v167
    v_pk_mul_f32 v[168:169], v[168:169], s[68:69]
    v_pk_mul_f32 v[170:171], v[170:171], s[68:69]
    v_pk_mul_f32 v[172:173], v[172:173], s[68:69]
    v_pk_mul_f32 v[174:175], v[174:175], s[68:69]
    v_cvt_pk_bf16_f32 v24, v168, v169
    v_cvt_pk_bf16_f32 v25, v170, v171
    v_cvt_pk_bf16_f32 v26, v172, v173
    v_cvt_pk_bf16_f32 v27, v174, v175
    v_pk_mul_f32 v[176:177], v[176:177], s[68:69]
    v_pk_mul_f32 v[178:179], v[178:179], s[68:69]
    v_pk_mul_f32 v[180:181], v[180:181], s[68:69]
    v_pk_mul_f32 v[182:183], v[182:183], s[68:69]
    v_cvt_pk_bf16_f32 v28, v176, v177
    v_cvt_pk_bf16_f32 v29, v178, v179
    v_cvt_pk_bf16_f32 v30, v180, v181
    v_cvt_pk_bf16_f32 v31, v182, v183
    v_pk_mul_f32 v[184:185], v[184:185], s[68:69]
    v_pk_mul_f32 v[186:187], v[186:187], s[68:69]
    v_pk_mul_f32 v[188:189], v[188:189], s[68:69]
    v_pk_mul_f32 v[190:191], v[190:191], s[68:69]
    v_cvt_pk_bf16_f32 v32, v184, v185
    v_cvt_pk_bf16_f32 v33, v186, v187
    v_cvt_pk_bf16_f32 v34, v188, v189
    v_cvt_pk_bf16_f32 v35, v190, v191
    v_permlane16_swap_b32 v20, v22
    v_permlane16_swap_b32 v21, v23
    v_permlane16_swap_b32 v24, v26
    v_permlane16_swap_b32 v25, v27
    v_permlane16_swap_b32 v28, v30
    v_permlane16_swap_b32 v29, v31
    v_permlane16_swap_b32 v32, v34
    v_permlane16_swap_b32 v33, v35
    v_accvgpr_write_b32 a32, v20
    v_accvgpr_write_b32 a33, v21
    v_accvgpr_write_b32 a34, v22
    v_accvgpr_write_b32 a35, v23
    v_accvgpr_write_b32 a36, v24
    v_accvgpr_write_b32 a37, v25
    v_accvgpr_write_b32 a38, v26
    v_accvgpr_write_b32 a39, v27
    v_accvgpr_write_b32 a40, v28
    v_accvgpr_write_b32 a41, v29
    v_accvgpr_write_b32 a42, v30
    v_accvgpr_write_b32 a43, v31
    v_accvgpr_write_b32 a44, v32
    v_accvgpr_write_b32 a45, v33
    v_accvgpr_write_b32 a46, v34
    v_accvgpr_write_b32 a47, v35
    s_nop 1
    v_mfma_f32_16x16x32_bf16 v[48:51], a[80:83], a[32:35], 0
    v_mfma_f32_16x16x32_bf16 v[48:51], a[84:87], a[36:39], v[48:51]
    v_mfma_f32_16x16x32_bf16 v[48:51], a[88:91], a[40:43], v[48:51]
    v_mfma_f32_16x16x32_bf16 v[48:51], a[92:95], a[44:47], v[48:51]
    v_pk_mul_f32 v[192:193], v[192:193], s[68:69]
    v_pk_mul_f32 v[194:195], v[194:195], s[68:69]
    v_pk_mul_f32 v[196:197], v[196:197], s[68:69]
    v_pk_mul_f32 v[198:199], v[198:199], s[68:69]
    v_cvt_pk_bf16_f32 v20, v192, v193
    v_cvt_pk_bf16_f32 v21, v194, v195
    v_cvt_pk_bf16_f32 v22, v196, v197
    v_cvt_pk_bf16_f32 v23, v198, v199
    v_pk_mul_f32 v[200:201], v[200:201], s[68:69]
    v_pk_mul_f32 v[202:203], v[202:203], s[68:69]
    v_pk_mul_f32 v[204:205], v[204:205], s[68:69]
    v_pk_mul_f32 v[206:207], v[206:207], s[68:69]
    v_cvt_pk_bf16_f32 v24, v200, v201
    v_cvt_pk_bf16_f32 v25, v202, v203
    v_cvt_pk_bf16_f32 v26, v204, v205
    v_cvt_pk_bf16_f32 v27, v206, v207
    v_pk_mul_f32 v[208:209], v[208:209], s[68:69]
    v_pk_mul_f32 v[210:211], v[210:211], s[68:69]
    v_pk_mul_f32 v[212:213], v[212:213], s[68:69]
    v_pk_mul_f32 v[214:215], v[214:215], s[68:69]
    v_cvt_pk_bf16_f32 v28, v208, v209
    v_cvt_pk_bf16_f32 v29, v210, v211
    v_cvt_pk_bf16_f32 v30, v212, v213
    v_cvt_pk_bf16_f32 v31, v214, v215
    v_pk_mul_f32 v[216:217], v[216:217], s[68:69]
    v_pk_mul_f32 v[218:219], v[218:219], s[68:69]
    v_pk_mul_f32 v[220:221], v[220:221], s[68:69]
    v_pk_mul_f32 v[222:223], v[222:223], s[68:69]
    v_cvt_pk_bf16_f32 v32, v216, v217
    v_cvt_pk_bf16_f32 v33, v218, v219
    v_cvt_pk_bf16_f32 v34, v220, v221
    v_cvt_pk_bf16_f32 v35, v222, v223
    v_permlane16_swap_b32 v20, v22
    v_permlane16_swap_b32 v21, v23
    v_permlane16_swap_b32 v24, v26
    v_permlane16_swap_b32 v25, v27
    v_permlane16_swap_b32 v28, v30
    v_permlane16_swap_b32 v29, v31
    v_permlane16_swap_b32 v32, v34
    v_permlane16_swap_b32 v33, v35
    v_accvgpr_write_b32 a48, v20
    v_accvgpr_write_b32 a49, v21
    v_accvgpr_write_b32 a50, v22
    v_accvgpr_write_b32 a51, v23
    v_accvgpr_write_b32 a52, v24
    v_accvgpr_write_b32 a53, v25
    v_accvgpr_write_b32 a54, v26
    v_accvgpr_write_b32 a55, v27
    v_accvgpr_write_b32 a56, v28
    v_accvgpr_write_b32 a57, v29
    v_accvgpr_write_b32 a58, v30
    v_accvgpr_write_b32 a59, v31
    v_accvgpr_write_b32 a60, v32
    v_accvgpr_write_b32 a61, v33
    v_accvgpr_write_b32 a62, v34
    v_accvgpr_write_b32 a63, v35
    s_nop 1
    s_add_u32 s75, s100, 40960
    s_and_b32 s75, s75, s79
    s_add_u32 m0, s74, 81920
    s_nop 0
    buffer_load_dwordx4 v18, s[84:87], s75 offen offset:0 nt lds
    buffer_load_dwordx4 v19, s[84:87], s75 offen offset:1024 nt lds
    v_mfma_f32_16x16x32_bf16 v[52:55], a[80:83], a[48:51], 0
    v_mfma_f32_16x16x32_bf16 v[52:55], a[84:87], a[52:55], v[52:55]
    v_mfma_f32_16x16x32_bf16 v[52:55], a[88:91], a[56:59], v[52:55]
    v_mfma_f32_16x16x32_bf16 v[52:55], a[92:95], a[60:63], v[52:55]
    v_pk_mul_f32 v[224:225], v[224:225], s[68:69]
    v_pk_mul_f32 v[226:227], v[226:227], s[68:69]
    v_pk_mul_f32 v[228:229], v[228:229], s[68:69]
    v_pk_mul_f32 v[230:231], v[230:231], s[68:69]
    v_cvt_pk_bf16_f32 v20, v224, v225
    v_cvt_pk_bf16_f32 v21, v226, v227
    v_cvt_pk_bf16_f32 v22, v228, v229
    v_cvt_pk_bf16_f32 v23, v230, v231
    v_pk_mul_f32 v[232:233], v[232:233], s[68:69]
    v_pk_mul_f32 v[234:235], v[234:235], s[68:69]
    v_pk_mul_f32 v[236:237], v[236:237], s[68:69]
    v_pk_mul_f32 v[238:239], v[238:239], s[68:69]
    v_cvt_pk_bf16_f32 v24, v232, v233
    v_cvt_pk_bf16_f32 v25, v234, v235
    v_cvt_pk_bf16_f32 v26, v236, v237
    v_cvt_pk_bf16_f32 v27, v238, v239
    v_pk_mul_f32 v[240:241], v[240:241], s[68:69]
    v_pk_mul_f32 v[242:243], v[242:243], s[68:69]
    v_pk_mul_f32 v[244:245], v[244:245], s[68:69]
    v_pk_mul_f32 v[246:247], v[246:247], s[68:69]
    v_cvt_pk_bf16_f32 v28, v240, v241
    v_cvt_pk_bf16_f32 v29, v242, v243
    v_cvt_pk_bf16_f32 v30, v244, v245
    v_cvt_pk_bf16_f32 v31, v246, v247
    v_pk_mul_f32 v[248:249], v[248:249], s[68:69]
    v_pk_mul_f32 v[250:251], v[250:251], s[68:69]
    v_pk_mul_f32 v[252:253], v[252:253], s[68:69]
    v_pk_mul_f32 v[254:255], v[254:255], s[68:69]
    v_cvt_pk_bf16_f32 v32, v248, v249
    v_cvt_pk_bf16_f32 v33, v250, v251
    v_cvt_pk_bf16_f32 v34, v252, v253
    v_cvt_pk_bf16_f32 v35, v254, v255
    v_permlane16_swap_b32 v20, v22
    v_permlane16_swap_b32 v21, v23
    v_permlane16_swap_b32 v24, v26
    v_permlane16_swap_b32 v25, v27
    v_permlane16_swap_b32 v28, v30
    v_permlane16_swap_b32 v29, v31
    v_permlane16_swap_b32 v32, v34
    v_permlane16_swap_b32 v33, v35
    v_accvgpr_write_b32 a64, v20
    v_accvgpr_write_b32 a65, v21
    v_accvgpr_write_b32 a66, v22
    v_accvgpr_write_b32 a67, v23
    v_accvgpr_write_b32 a68, v24
    v_accvgpr_write_b32 a69, v25
    v_accvgpr_write_b32 a70, v26
    v_accvgpr_write_b32 a71, v27
    v_accvgpr_write_b32 a72, v28
    v_accvgpr_write_b32 a73, v29
    v_accvgpr_write_b32 a74, v30
    v_accvgpr_write_b32 a75, v31
    v_accvgpr_write_b32 a76, v32
    v_accvgpr_write_b32 a77, v33
    v_accvgpr_write_b32 a78, v34
    v_accvgpr_write_b32 a79, v35
    s_nop 1
    s_add_u32 s75, s101, 40960
    s_and_b32 s75, s75, s79
    s_add_u32 s75, s75, 131072
    s_add_u32 m0, s74, 90112
    s_nop 0
    buffer_load_dwordx4 v18, s[84:87], s75 offen offset:0 nt lds
    buffer_load_dwordx4 v19, s[84:87], s75 offen offset:1024 nt lds
    v_mfma_f32_16x16x32_bf16 v[56:59], a[80:83], a[64:67], 0
    v_mfma_f32_16x16x32_bf16 v[56:59], a[84:87], a[68:71], v[56:59]
    v_mfma_f32_16x16x32_bf16 v[56:59], a[88:91], a[72:75], v[56:59]
    v_mfma_f32_16x16x32_bf16 v[56:59], a[92:95], a[76:79], v[56:59]
    v_mov_b32 v28, v64
    v_mov_b32 v29, v65
    v_mov_b32 v30, v66
    v_mov_b32 v31, v67
    v_mov_b32 v88, v68
ATT_MAX:
    v_mov_b32 v32, 0
    v_mov_b32 v20, 0
    v_mov_b32 v36, 0
    v_mov_b32 v24, 0
    v_mov_b32 v60, 0
    v_mov_b32 v20, 0x3f803f80
    v_accvgpr_write_b32 a228, v20
    v_accvgpr_write_b32 a229, v20
    v_accvgpr_write_b32 a230, v20
    v_accvgpr_write_b32 a231, v20
    v_max3_f32 v40, v40, v41, v42
    v_max_f32 v40, v40, v43
    v_mov_b32 v41, v40
    v_max3_f32 v44, v44, v45, v46
    v_max_f32 v44, v44, v47
    v_mov_b32 v45, v44
    v_max3_f32 v48, v48, v49, v50
    v_max_f32 v48, v48, v51
    v_mov_b32 v49, v48
    v_max3_f32 v52, v52, v53, v54
    v_max_f32 v52, v52, v55
    v_mov_b32 v53, v52
    v_max3_f32 v56, v56, v57, v58
    v_max_f32 v56, v56, v59
    v_mov_b32 v57, v56
    s_nop 1
    v_permlane16_swap_b32 v40, v41
    v_permlane16_swap_b32 v44, v45
    v_permlane16_swap_b32 v48, v49
    v_permlane16_swap_b32 v52, v53
    v_permlane16_swap_b32 v56, v57
    v_max_f32 v40, v40, v41
    v_mov_b32 v41, v40
    v_max_f32 v44, v44, v45
    v_mov_b32 v45, v44
    v_max_f32 v48, v48, v49
    v_mov_b32 v49, v48
    v_max_f32 v52, v52, v53
    v_mov_b32 v53, v52
    v_max_f32 v56, v56, v57
    v_mov_b32 v57, v56
    s_nop 1
    v_permlane32_swap_b32 v40, v41
    v_permlane32_swap_b32 v44, v45
    v_permlane32_swap_b32 v48, v49
    v_permlane32_swap_b32 v52, v53
    v_permlane32_swap_b32 v56, v57
    v_max_f32 v40, v40, v41
    v_sub_f32 v40, 0, v40
    v_mov_b32 v41, v40
    v_mov_b32 v42, v40
    v_mov_b32 v43, v40
    v_max_f32 v44, v44, v45
    v_sub_f32 v44, 0, v44
    v_mov_b32 v45, v44
    v_mov_b32 v46, v44
    v_mov_b32 v47, v44
    v_max_f32 v48, v48, v49
    v_sub_f32 v48, 0, v48
    v_mov_b32 v49, v48
    v_mov_b32 v50, v48
    v_mov_b32 v51, v48
    v_max_f32 v52, v52, v53
    v_sub_f32 v52, 0, v52
    v_mov_b32 v53, v52
    v_mov_b32 v54, v52
    v_mov_b32 v55, v52
    v_max_f32 v56, v56, v57
    v_sub_f32 v56, 0, v56
    v_mov_b32 v57, v56
    v_mov_b32 v58, v56
    v_mov_b32 v59, v56
ATT_MAIN:
    s_nop 1
    v_mfma_f32_16x16x32_bf16 v[64:67], a[80:83], a[0:3], v[40:43]
    v_mfma_f32_16x16x32_bf16 v[64:67], a[84:87], a[4:7], v[64:67]
    v_mfma_f32_16x16x32_bf16 v[64:67], a[88:91], a[8:11], v[64:67]
    v_mfma_f32_16x16x32_bf16 v[64:67], a[92:95], a[12:15], v[64:67]
    v_mfma_f32_16x16x32_bf16 v[68:71], a[96:99], a[0:3], v[40:43]
    v_mfma_f32_16x16x32_bf16 v[68:71], a[100:103], a[4:7], v[68:71]
    v_mfma_f32_16x16x32_bf16 v[68:71], a[104:107], a[8:11], v[68:71]
    v_mfma_f32_16x16x32_bf16 v[68:71], a[108:111], a[12:15], v[68:71]
    s_nop 3
    v_exp_f32 v64, v64
    v_exp_f32 v65, v65
    v_exp_f32 v66, v66
    v_exp_f32 v67, v67
    v_cvt_pk_bf16_f32 v80, v64, v65
    v_cvt_pk_bf16_f32 v81, v66, v67
    v_exp_f32 v68, v68
    v_mfma_f32_16x16x32_bf16 v[72:75], a[80:83], a[16:19], v[44:47]
    v_mfma_f32_16x16x32_bf16 v[72:75], a[84:87], a[20:23], v[72:75]
    v_mfma_f32_16x16x32_bf16 v[72:75], a[88:91], a[24:27], v[72:75]
    v_mfma_f32_16x16x32_bf16 v[72:75], a[92:95], a[28:31], v[72:75]
    v_mfma_f32_16x16x32_bf16 v[76:79], a[96:99], a[16:19], v[44:47]
    v_mfma_f32_16x16x32_bf16 v[76:79], a[100:103], a[20:23], v[76:79]
    v_mfma_f32_16x16x32_bf16 v[76:79], a[104:107], a[24:27], v[76:79]
    s_add_u32 s75, s100, 49152
    v_mfma_f32_16x16x32_bf16 v[76:79], a[108:111], a[28:31], v[76:79]
    s_and_b32 s75, s75, s79
    v_exp_f32 v69, v69
    v_exp_f32 v70, v70
    v_exp_f32 v71, v71
    v_cvt_pk_bf16_f32 v82, v68, v69
    v_cvt_pk_bf16_f32 v83, v70, v71
    v_exp_f32 v72, v72
    s_nop 0
    v_mfma_f32_16x16x32_bf16 v[96:99], a[144:147], v[80:83], 0
    s_add_u32 m0, s74, 131072
    v_mfma_f32_16x16x32_bf16 v[100:103], a[148:151], v[80:83], 0
    buffer_load_dwordx4 v16, s[80:83], s75 offen offset:0 nt lds
    v_mfma_f32_16x16x32_bf16 v[104:107], a[152:155], v[80:83], 0
    v_mfma_f32_16x16x32_bf16 v[108:111], a[156:159], v[80:83], 0
    v_mfma_f32_16x16x32_bf16 v[112:115], a[160:163], v[80:83], 0
    v_mfma_f32_16x16x32_bf16 v[116:119], a[164:167], v[80:83], 0
    v_mfma_f32_16x16x32_bf16 v[120:123], a[168:171], v[80:83], 0
    v_mfma_f32_16x16x32_bf16 v[124:127], a[172:175], v[80:83], 0
    v_exp_f32 v73, v73
    v_exp_f32 v74, v74
    v_exp_f32 v75, v75
    v_exp_f32 v76, v76
    v_cvt_pk_bf16_f32 v84, v72, v73
    v_cvt_pk_bf16_f32 v85, v74, v75
    v_mfma_f32_16x16x32_bf16 v[32:35], a[228:231], v[80:83], 0
    v_mfma_f32_16x16x32_bf16 v[64:67], a[80:83], a[32:35], v[48:51]
    buffer_load_dwordx4 v17, s[80:83], s75 offen offset:1024 nt lds
    v_mfma_f32_16x16x32_bf16 v[64:67], a[84:87], a[36:39], v[64:67]
    v_mfma_f32_16x16x32_bf16 v[64:67], a[88:91], a[40:43], v[64:67]
    v_mfma_f32_16x16x32_bf16 v[64:67], a[92:95], a[44:47], v[64:67]
    v_mfma_f32_16x16x32_bf16 v[68:71], a[96:99], a[32:35], v[48:51]
    v_mfma_f32_16x16x32_bf16 v[68:71], a[100:103], a[36:39], v[68:71]
    v_mfma_f32_16x16x32_bf16 v[68:71], a[104:107], a[40:43], v[68:71]
    v_mfma_f32_16x16x32_bf16 v[68:71], a[108:111], a[44:47], v[68:71]
    s_add_u32 s75, s101, 49152
    v_exp_f32 v77, v77
    v_exp_f32 v78, v78
    v_exp_f32 v79, v79
    v_cvt_pk_bf16_f32 v86, v76, v77
    v_cvt_pk_bf16_f32 v87, v78, v79
    v_exp_f32 v64, v64
    s_nop 0
    v_mfma_f32_16x16x32_bf16 v[128:131], a[144:147], v[84:87], 0
    s_and_b32 s75, s75, s79
    v_mfma_f32_16x16x32_bf16 v[132:135], a[148:151], v[84:87], 0
    s_add_u32 s75, s75, 131072
    v_mfma_f32_16x16x32_bf16 v[136:139], a[152:155], v[84:87], 0
    s_add_u32 m0, s74, 139264
    v_mfma_f32_16x16x32_bf16 v[140:143], a[156:159], v[84:87], 0
    buffer_load_dwordx4 v16, s[80:83], s75 offen offset:0 nt lds
    v_mfma_f32_16x16x32_bf16 v[144:147], a[160:163], v[84:87], 0
    v_mfma_f32_16x16x32_bf16 v[148:151], a[164:167], v[84:87], 0
    v_mfma_f32_16x16x32_bf16 v[152:155], a[168:171], v[84:87], 0
    v_mfma_f32_16x16x32_bf16 v[156:159], a[172:175], v[84:87], 0
    v_exp_f32 v65, v65
    v_exp_f32 v66, v66
    v_exp_f32 v67, v67
    v_exp_f32 v68, v68
    v_cvt_pk_bf16_f32 v80, v64, v65
    v_cvt_pk_bf16_f32 v81, v66, v67
    v_mfma_f32_16x16x32_bf16 v[20:23], a[228:231], v[84:87], 0
    v_mfma_f32_16x16x32_bf16 v[72:75], a[80:83], a[48:51], v[52:55]
    v_mfma_f32_16x16x32_bf16 v[72:75], a[84:87], a[52:55], v[72:75]
    v_mfma_f32_16x16x32_bf16 v[72:75], a[88:91], a[56:59], v[72:75]
    buffer_load_dwordx4 v17, s[80:83], s75 offen offset:1024 nt lds
    v_mfma_f32_16x16x32_bf16 v[72:75], a[92:95], a[60:63], v[72:75]
    v_mfma_f32_16x16x32_bf16 v[76:79], a[96:99], a[48:51], v[52:55]
    v_mfma_f32_16x16x32_bf16 v[76:79], a[100:103], a[52:55], v[76:79]
    v_mfma_f32_16x16x32_bf16 v[76:79], a[104:107], a[56:59], v[76:79]
    v_mfma_f32_16x16x32_bf16 v[76:79], a[108:111], a[60:63], v[76:79]
    v_exp_f32 v69, v69
    v_exp_f32 v70, v70
    v_exp_f32 v71, v71
    v_cvt_pk_bf16_f32 v82, v68, v69
    v_cvt_pk_bf16_f32 v83, v70, v71
    v_exp_f32 v72, v72
    s_nop 0
    v_mfma_f32_16x16x32_bf16 v[160:163], a[144:147], v[80:83], 0
    v_mfma_f32_16x16x32_bf16 v[164:167], a[148:151], v[80:83], 0
    v_mfma_f32_16x16x32_bf16 v[168:171], a[152:155], v[80:83], 0
    v_mfma_f32_16x16x32_bf16 v[172:175], a[156:159], v[80:83], 0
    v_mfma_f32_16x16x32_bf16 v[176:179], a[160:163], v[80:83], 0
    v_mfma_f32_16x16x32_bf16 v[180:183], a[164:167], v[80:83], 0
    v_mfma_f32_16x16x32_bf16 v[184:187], a[168:171], v[80:83], 0
    v_mfma_f32_16x16x32_bf16 v[188:191], a[172:175], v[80:83], 0
    v_exp_f32 v73, v73
    v_exp_f32 v74, v74
    v_exp_f32 v75, v75
    v_exp_f32 v76, v76
    v_cvt_pk_bf16_f32 v84, v72, v73
    v_cvt_pk_bf16_f32 v85, v74, v75
    v_mfma_f32_16x16x32_bf16 v[36:39], a[228:231], v[80:83], 0
    v_mfma_f32_16x16x32_bf16 v[64:67], a[80:83], a[64:67], v[56:59]
    v_mfma_f32_16x16x32_bf16 v[64:67], a[84:87], a[68:71], v[64:67]
    v_mfma_f32_16x16x32_bf16 v[64:67], a[88:91], a[72:75], v[64:67]
    v_mfma_f32_16x16x32_bf16 v[64:67], a[92:95], a[76:79], v[64:67]
    s_add_u32 s75, s100, 49152
    v_mfma_f32_16x16x32_bf16 v[68:71], a[96:99], a[64:67], v[56:59]
    s_and_b32 s75, s75, s79
    v_mfma_f32_16x16x32_bf16 v[68:71], a[100:103], a[68:71], v[68:71]
    s_add_u32 m0, s74, 147456
    v_mfma_f32_16x16x32_bf16 v[68:71], a[104:107], a[72:75], v[68:71]
    buffer_load_dwordx4 v18, s[84:87], s75 offen offset:0 nt lds
    v_mfma_f32_16x16x32_bf16 v[68:71], a[108:111], a[76:79], v[68:71]
    v_exp_f32 v77, v77
    v_exp_f32 v78, v78
    v_exp_f32 v79, v79
    v_cvt_pk_bf16_f32 v86, v76, v77
    v_cvt_pk_bf16_f32 v87, v78, v79
    v_exp_f32 v64, v64
    s_nop 0
    v_mfma_f32_16x16x32_bf16 v[192:195], a[144:147], v[84:87], 0
    v_mfma_f32_16x16x32_bf16 v[196:199], a[148:151], v[84:87], 0
    v_mfma_f32_16x16x32_bf16 v[200:203], a[152:155], v[84:87], 0
    v_mfma_f32_16x16x32_bf16 v[204:207], a[156:159], v[84:87], 0
    v_mfma_f32_16x16x32_bf16 v[208:211], a[160:163], v[84:87], 0
    v_mfma_f32_16x16x32_bf16 v[212:215], a[164:167], v[84:87], 0
    v_mfma_f32_16x16x32_bf16 v[216:219], a[168:171], v[84:87], 0
    buffer_load_dwordx4 v19, s[84:87], s75 offen offset:1024 nt lds
    v_mfma_f32_16x16x32_bf16 v[220:223], a[172:175], v[84:87], 0
    v_exp_f32 v65, v65
    v_exp_f32 v66, v66
    v_exp_f32 v67, v67
    v_exp_f32 v68, v68
    v_cvt_pk_bf16_f32 v80, v64, v65
    v_cvt_pk_bf16_f32 v81, v66, v67
    v_mfma_f32_16x16x32_bf16 v[24:27], a[228:231], v[84:87], 0
    v_mfma_f32_16x16x32_bf16 v[72:75], a[112:115], a[0:3], v[40:43]
    v_mfma_f32_16x16x32_bf16 v[72:75], a[116:119], a[4:7], v[72:75]
    v_mfma_f32_16x16x32_bf16 v[72:75], a[120:123], a[8:11], v[72:75]
    v_mfma_f32_16x16x32_bf16 v[72:75], a[124:127], a[12:15], v[72:75]
    v_mfma_f32_16x16x32_bf16 v[76:79], a[128:131], a[0:3], v[40:43]
    v_mfma_f32_16x16x32_bf16 v[76:79], a[132:135], a[4:7], v[76:79]
    v_mfma_f32_16x16x32_bf16 v[76:79], a[136:139], a[8:11], v[76:79]
    v_mfma_f32_16x16x32_bf16 v[76:79], a[140:143], a[12:15], v[76:79]
    s_waitcnt vmcnt(63) lgkmcnt(0)
    v_exp_f32 v69, v69
    v_exp_f32 v70, v70
    v_exp_f32 v71, v71
    v_cvt_pk_bf16_f32 v82, v68, v69
    v_cvt_pk_bf16_f32 v83, v70, v71
    v_exp_f32 v72, v72
    s_nop 0
    v_mfma_f32_16x16x32_bf16 v[224:227], a[144:147], v[80:83], 0
    s_barrier
    v_mfma_f32_16x16x32_bf16 v[228:231], a[148:151], v[80:83], 0
    ds_read_b128 a[80:83], v4 offset:0
    v_mfma_f32_16x16x32_bf16 v[232:235], a[152:155], v[80:83], 0
    ds_read_b128 a[84:87], v5 offset:0
    v_mfma_f32_16x16x32_bf16 v[236:239], a[156:159], v[80:83], 0
    v_mfma_f32_16x16x32_bf16 v[240:243], a[160:163], v[80:83], 0
    ds_read_b128 a[88:91], v6 offset:0
    v_mfma_f32_16x16x32_bf16 v[244:247], a[164:167], v[80:83], 0
    v_mfma_f32_16x16x32_bf16 v[248:251], a[168:171], v[80:83], 0
    s_add_u32 s75, s101, 49152
    ds_read_b128 a[92:95], v7 offset:0
    v_mfma_f32_16x16x32_bf16 v[252:255], a[172:175], v[80:83], 0
    s_and_b32 s75, s75, s79
    v_exp_f32 v73, v73
    v_exp_f32 v74, v74
    v_exp_f32 v75, v75
    v_exp_f32 v76, v76
    v_cvt_pk_bf16_f32 v84, v72, v73
    v_cvt_pk_bf16_f32 v85, v74, v75
    v_mfma_f32_16x16x32_bf16 v[60:63], a[228:231], v[80:83], 0
    s_add_u32 s75, s75, 131072
    v_mfma_f32_16x16x32_bf16 v[64:67], a[112:115], a[16:19], v[44:47]
    s_add_u32 m0, s74, 155648
    ds_read_b128 a[96:99], v4 offset:4096
    v_mfma_f32_16x16x32_bf16 v[64:67], a[116:119], a[20:23], v[64:67]
    buffer_load_dwordx4 v18, s[84:87], s75 offen offset:0 nt lds
    v_mfma_f32_16x16x32_bf16 v[64:67], a[120:123], a[24:27], v[64:67]
    v_mfma_f32_16x16x32_bf16 v[64:67], a[124:127], a[28:31], v[64:67]
    ds_read_b128 a[100:103], v5 offset:4096
    v_mfma_f32_16x16x32_bf16 v[68:71], a[128:131], a[16:19], v[44:47]
    v_mfma_f32_16x16x32_bf16 v[68:71], a[132:135], a[20:23], v[68:71]
    ds_read_b128 a[104:107], v6 offset:4096
    v_mfma_f32_16x16x32_bf16 v[68:71], a[136:139], a[24:27], v[68:71]
    v_mfma_f32_16x16x32_bf16 v[68:71], a[140:143], a[28:31], v[68:71]
    v_exp_f32 v77, v77
    v_exp_f32 v78, v78
    v_exp_f32 v79, v79
    v_cvt_pk_bf16_f32 v86, v76, v77
    v_cvt_pk_bf16_f32 v87, v78, v79
    v_exp_f32 v64, v64
    s_nop 0
    v_mfma_f32_16x16x32_bf16 v[96:99], a[176:179], v[84:87], v[96:99]
    ds_read_b128 a[108:111], v7 offset:4096
    v_mfma_f32_16x16x32_bf16 v[100:103], a[180:183], v[84:87], v[100:103]
    buffer_load_dwordx4 v19, s[84:87], s75 offen offset:1024 nt lds
    v_mfma_f32_16x16x32_bf16 v[104:107], a[184:187], v[84:87], v[104:107]
    v_mfma_f32_16x16x32_bf16 v[108:111], a[188:191], v[84:87], v[108:111]
    v_mfma_f32_16x16x32_bf16 v[112:115], a[192:195], v[84:87], v[112:115]
    v_mfma_f32_16x16x32_bf16 v[116:119], a[196:199], v[84:87], v[116:119]
    v_mfma_f32_16x16x32_bf16 v[120:123], a[200:203], v[84:87], v[120:123]
    v_mfma_f32_16x16x32_bf16 v[124:127], a[204:207], v[84:87], v[124:127]
    v_exp_f32 v65, v65
    v_exp_f32 v66, v66
    v_exp_f32 v67, v67
    v_exp_f32 v68, v68
    v_cvt_pk_bf16_f32 v80, v64, v65
    v_cvt_pk_bf16_f32 v81, v66, v67
    v_mfma_f32_16x16x32_bf16 v[32:35], a[228:231], v[84:87], v[32:35]
    s_waitcnt vmcnt(28) lgkmcnt(0)
    v_mfma_f32_16x16x32_bf16 v[72:75], a[112:115], a[32:35], v[48:51]
    s_barrier
    v_mfma_f32_16x16x32_bf16 v[72:75], a[116:119], a[36:39], v[72:75]
    ds_read_b64_tr_b16 a[144:145], v8 offset:32768
    v_mfma_f32_16x16x32_bf16 v[72:75], a[120:123], a[40:43], v[72:75]
    v_mfma_f32_16x16x32_bf16 v[72:75], a[124:127], a[44:47], v[72:75]
    ds_read_b64_tr_b16 a[146:147], v8 offset:36864
    v_mfma_f32_16x16x32_bf16 v[76:79], a[128:131], a[32:35], v[48:51]
    v_mfma_f32_16x16x32_bf16 v[76:79], a[132:135], a[36:39], v[76:79]
    v_mfma_f32_16x16x32_bf16 v[76:79], a[136:139], a[40:43], v[76:79]
    ds_read_b64_tr_b16 a[148:149], v9 offset:32768
    v_mfma_f32_16x16x32_bf16 v[76:79], a[140:143], a[44:47], v[76:79]
    v_exp_f32 v69, v69
    v_exp_f32 v70, v70
    v_exp_f32 v71, v71
    v_cvt_pk_bf16_f32 v82, v68, v69
    v_cvt_pk_bf16_f32 v83, v70, v71
    v_exp_f32 v72, v72
    s_nop 0
    v_mfma_f32_16x16x32_bf16 v[128:131], a[176:179], v[80:83], v[128:131]
    v_mfma_f32_16x16x32_bf16 v[132:135], a[180:183], v[80:83], v[132:135]
    v_mfma_f32_16x16x32_bf16 v[136:139], a[184:187], v[80:83], v[136:139]
    s_add_u32 s75, s100, 57344
    ds_read_b64_tr_b16 a[150:151], v9 offset:36864
    v_mfma_f32_16x16x32_bf16 v[140:143], a[188:191], v[80:83], v[140:143]
    s_and_b32 s75, s75, s79
    v_mfma_f32_16x16x32_bf16 v[144:147], a[192:195], v[80:83], v[144:147]
    s_add_u32 m0, s74, 0
    ds_read_b64_tr_b16 a[152:153], v10 offset:32768
    v_mfma_f32_16x16x32_bf16 v[148:151], a[196:199], v[80:83], v[148:151]
    buffer_load_dwordx4 v16, s[80:83], s75 offen offset:0 nt lds
    v_mfma_f32_16x16x32_bf16 v[152:155], a[200:203], v[80:83], v[152:155]
    v_mfma_f32_16x16x32_bf16 v[156:159], a[204:207], v[80:83], v[156:159]
    v_exp_f32 v73, v73
    v_exp_f32 v74, v74
    v_exp_f32 v75, v75
    v_exp_f32 v76, v76
    v_cvt_pk_bf16_f32 v84, v72, v73
    v_cvt_pk_bf16_f32 v85, v74, v75
    v_mfma_f32_16x16x32_bf16 v[20:23], a[228:231], v[80:83], v[20:23]
    v_mfma_f32_16x16x32_bf16 v[64:67], a[112:115], a[48:51], v[52:55]
    ds_read_b64_tr_b16 a[154:155], v10 offset:36864
    v_mfma_f32_16x16x32_bf16 v[64:67], a[116:119], a[52:55], v[64:67]
    v_mfma_f32_16x16x32_bf16 v[64:67], a[120:123], a[56:59], v[64:67]
    v_mfma_f32_16x16x32_bf16 v[64:67], a[124:127], a[60:63], v[64:67]
    ds_read_b64_tr_b16 a[156:157], v11 offset:32768
    v_mfma_f32_16x16x32_bf16 v[68:71], a[128:131], a[48:51], v[52:55]
    buffer_load_dwordx4 v17, s[80:83], s75 offen offset:1024 nt lds
    v_mfma_f32_16x16x32_bf16 v[68:71], a[132:135], a[52:55], v[68:71]
    v_mfma_f32_16x16x32_bf16 v[68:71], a[136:139], a[56:59], v[68:71]
    ds_read_b64_tr_b16 a[158:159], v11 offset:36864
    v_mfma_f32_16x16x32_bf16 v[68:71], a[140:143], a[60:63], v[68:71]
    v_exp_f32 v77, v77
    v_exp_f32 v78, v78
    v_exp_f32 v79, v79
    v_cvt_pk_bf16_f32 v86, v76, v77
    v_cvt_pk_bf16_f32 v87, v78, v79
    v_exp_f32 v64, v64
    s_nop 0
    v_mfma_f32_16x16x32_bf16 v[160:163], a[176:179], v[84:87], v[160:163]
    v_mfma_f32_16x16x32_bf16 v[164:167], a[180:183], v[84:87], v[164:167]
    v_mfma_f32_16x16x32_bf16 v[168:171], a[184:187], v[84:87], v[168:171]
    ds_read_b64_tr_b16 a[160:161], v12 offset:32768
    v_mfma_f32_16x16x32_bf16 v[172:175], a[188:191], v[84:87], v[172:175]
    v_mfma_f32_16x16x32_bf16 v[176:179], a[192:195], v[84:87], v[176:179]
    v_mfma_f32_16x16x32_bf16 v[180:183], a[196:199], v[84:87], v[180:183]
    ds_read_b64_tr_b16 a[162:163], v12 offset:36864
    v_mfma_f32_16x16x32_bf16 v[184:187], a[200:203], v[84:87], v[184:187]
    v_mfma_f32_16x16x32_bf16 v[188:191], a[204:207], v[84:87], v[188:191]
    v_exp_f32 v65, v65
    v_exp_f32 v66, v66
    v_exp_f32 v67, v67
    v_exp_f32 v68, v68
    v_cvt_pk_bf16_f32 v80, v64, v65
    v_cvt_pk_bf16_f32 v81, v66, v67
    v_mfma_f32_16x16x32_bf16 v[36:39], a[228:231], v[84:87], v[36:39]
    ds_read_b64_tr_b16 a[164:165], v13 offset:32768
    v_mfma_f32_16x16x32_bf16 v[72:75], a[112:115], a[64:67], v[56:59]
    v_mfma_f32_16x16x32_bf16 v[72:75], a[116:119], a[68:71], v[72:75]
    v_mfma_f32_16x16x32_bf16 v[72:75], a[120:123], a[72:75], v[72:75]
    ds_read_b64_tr_b16 a[166:167], v13 offset:36864
    v_mfma_f32_16x16x32_bf16 v[72:75], a[124:127], a[76:79], v[72:75]
    v_mfma_f32_16x16x32_bf16 v[76:79], a[128:131], a[64:67], v[56:59]
    s_add_u32 s75, s101, 57344
    v_mfma_f32_16x16x32_bf16 v[76:79], a[132:135], a[68:71], v[76:79]
    s_and_b32 s75, s75, s79
    ds_read_b64_tr_b16 a[168:169], v14 offset:32768
    v_mfma_f32_16x16x32_bf16 v[76:79], a[136:139], a[72:75], v[76:79]
    s_add_u32 s75, s75, 131072
    v_mfma_f32_16x16x32_bf16 v[76:79], a[140:143], a[76:79], v[76:79]
    s_add_u32 m0, s74, 8192
    v_exp_f32 v69, v69
    v_exp_f32 v70, v70
    v_exp_f32 v71, v71
    v_cvt_pk_bf16_f32 v82, v68, v69
    v_cvt_pk_bf16_f32 v83, v70, v71
    v_exp_f32 v72, v72
    s_nop 0
    v_mfma_f32_16x16x32_bf16 v[192:195], a[176:179], v[80:83], v[192:195]
    buffer_load_dwordx4 v16, s[80:83], s75 offen offset:0 nt lds
    v_mfma_f32_16x16x32_bf16 v[196:199], a[180:183], v[80:83], v[196:199]
    ds_read_b64_tr_b16 a[170:171], v14 offset:36864
    v_mfma_f32_16x16x32_bf16 v[200:203], a[184:187], v[80:83], v[200:203]
    v_mfma_f32_16x16x32_bf16 v[204:207], a[188:191], v[80:83], v[204:207]
    v_mfma_f32_16x16x32_bf16 v[208:211], a[192:195], v[80:83], v[208:211]
    ds_read_b64_tr_b16 a[172:173], v15 offset:32768
    v_mfma_f32_16x16x32_bf16 v[212:215], a[196:199], v[80:83], v[212:215]
    v_mfma_f32_16x16x32_bf16 v[216:219], a[200:203], v[80:83], v[216:219]
    v_mfma_f32_16x16x32_bf16 v[220:223], a[204:207], v[80:83], v[220:223]
    v_exp_f32 v73, v73
    v_exp_f32 v74, v74
    v_exp_f32 v75, v75
    v_exp_f32 v76, v76
    v_cvt_pk_bf16_f32 v84, v72, v73
    v_cvt_pk_bf16_f32 v85, v74, v75
    v_mfma_f32_16x16x32_bf16 v[24:27], a[228:231], v[80:83], v[24:27]
    buffer_load_dwordx4 v17, s[80:83], s75 offen offset:1024 nt lds
    v_mfma_f32_16x16x32_bf16 v[64:67], a[80:83], a[0:3], v[40:43]
    ds_read_b64_tr_b16 a[174:175], v15 offset:36864
    v_mfma_f32_16x16x32_bf16 v[64:67], a[84:87], a[4:7], v[64:67]
    v_mfma_f32_16x16x32_bf16 v[64:67], a[88:91], a[8:11], v[64:67]
    v_mfma_f32_16x16x32_bf16 v[64:67], a[92:95], a[12:15], v[64:67]
    v_mfma_f32_16x16x32_bf16 v[68:71], a[96:99], a[0:3], v[40:43]
    v_mfma_f32_16x16x32_bf16 v[68:71], a[100:103], a[4:7], v[68:71]
    v_mfma_f32_16x16x32_bf16 v[68:71], a[104:107], a[8:11], v[68:71]
    v_mfma_f32_16x16x32_bf16 v[68:71], a[108:111], a[12:15], v[68:71]
    s_waitcnt vmcnt(49) lgkmcnt(0)
    v_exp_f32 v77, v77
    v_exp_f32 v78, v78
    v_exp_f32 v79, v79
    v_cvt_pk_bf16_f32 v86, v76, v77
    v_cvt_pk_bf16_f32 v87, v78, v79
    v_exp_f32 v64, v64
    s_nop 0
    v_mfma_f32_16x16x32_bf16 v[224:227], a[176:179], v[84:87], v[224:227]
    s_barrier
    v_mfma_f32_16x16x32_bf16 v[228:231], a[180:183], v[84:87], v[228:231]
    ds_read_b128 a[112:115], v4 offset:16384
    v_mfma_f32_16x16x32_bf16 v[232:235], a[184:187], v[84:87], v[232:235]
    ds_read_b128 a[116:119], v5 offset:16384
    v_mfma_f32_16x16x32_bf16 v[236:239], a[188:191], v[84:87], v[236:239]
    v_mfma_f32_16x16x32_bf16 v[240:243], a[192:195], v[84:87], v[240:243]
    ds_read_b128 a[120:123], v6 offset:16384
    v_mfma_f32_16x16x32_bf16 v[244:247], a[196:199], v[84:87], v[244:247]
    v_mfma_f32_16x16x32_bf16 v[248:251], a[200:203], v[84:87], v[248:251]
    ds_read_b128 a[124:127], v7 offset:16384
    v_mfma_f32_16x16x32_bf16 v[252:255], a[204:207], v[84:87], v[252:255]
    v_exp_f32 v65, v65
    v_exp_f32 v66, v66
    v_exp_f32 v67, v67
    v_exp_f32 v68, v68
    v_cvt_pk_bf16_f32 v80, v64, v65
    v_cvt_pk_bf16_f32 v81, v66, v67
    v_mfma_f32_16x16x32_bf16 v[60:63], a[228:231], v[84:87], v[60:63]
    s_add_u32 s75, s100, 57344
    v_mfma_f32_16x16x32_bf16 v[72:75], a[80:83], a[16:19], v[44:47]
    s_and_b32 s75, s75, s79
    ds_read_b128 a[128:131], v4 offset:20480
    v_mfma_f32_16x16x32_bf16 v[72:75], a[84:87], a[20:23], v[72:75]
    s_add_u32 m0, s74, 98304
    v_mfma_f32_16x16x32_bf16 v[72:75], a[88:91], a[24:27], v[72:75]
    buffer_load_dwordx4 v18, s[84:87], s75 offen offset:0 nt lds
    v_mfma_f32_16x16x32_bf16 v[72:75], a[92:95], a[28:31], v[72:75]
    ds_read_b128 a[132:135], v5 offset:20480
    v_mfma_f32_16x16x32_bf16 v[76:79], a[96:99], a[16:19], v[44:47]
    v_mfma_f32_16x16x32_bf16 v[76:79], a[100:103], a[20:23], v[76:79]
    ds_read_b128 a[136:139], v6 offset:20480
    v_mfma_f32_16x16x32_bf16 v[76:79], a[104:107], a[24:27], v[76:79]
    v_mfma_f32_16x16x32_bf16 v[76:79], a[108:111], a[28:31], v[76:79]
    v_exp_f32 v69, v69
    v_exp_f32 v70, v70
    v_exp_f32 v71, v71
    v_cvt_pk_bf16_f32 v82, v68, v69
    v_cvt_pk_bf16_f32 v83, v70, v71
    v_exp_f32 v72, v72
    s_nop 0
    v_mfma_f32_16x16x32_bf16 v[96:99], a[144:147], v[80:83], v[96:99]
    ds_read_b128 a[140:143], v7 offset:20480
    v_mfma_f32_16x16x32_bf16 v[100:103], a[148:151], v[80:83], v[100:103]
    v_mfma_f32_16x16x32_bf16 v[104:107], a[152:155], v[80:83], v[104:107]
    buffer_load_dwordx4 v19, s[84:87], s75 offen offset:1024 nt lds
    v_mfma_f32_16x16x32_bf16 v[108:111], a[156:159], v[80:83], v[108:111]
    v_mfma_f32_16x16x32_bf16 v[112:115], a[160:163], v[80:83], v[112:115]
    v_mfma_f32_16x16x32_bf16 v[116:119], a[164:167], v[80:83], v[116:119]
    v_mfma_f32_16x16x32_bf16 v[120:123], a[168:171], v[80:83], v[120:123]
    v_mfma_f32_16x16x32_bf16 v[124:127], a[172:175], v[80:83], v[124:127]
    v_exp_f32 v73, v73
    v_exp_f32 v74, v74
    v_exp_f32 v75, v75
    v_exp_f32 v76, v76
    v_cvt_pk_bf16_f32 v84, v72, v73
    v_cvt_pk_bf16_f32 v85, v74, v75
    v_mfma_f32_16x16x32_bf16 v[32:35], a[228:231], v[80:83], v[32:35]
    s_waitcnt vmcnt(30) lgkmcnt(0)
    v_mfma_f32_16x16x32_bf16 v[64:67], a[80:83], a[32:35], v[48:51]
    s_barrier
    v_mfma_f32_16x16x32_bf16 v[64:67], a[84:87], a[36:39], v[64:67]
    ds_read_b64_tr_b16 a[176:177], v8 offset:49152
    v_mfma_f32_16x16x32_bf16 v[64:67], a[88:91], a[40:43], v[64:67]
    v_mfma_f32_16x16x32_bf16 v[64:67], a[92:95], a[44:47], v[64:67]
    ds_read_b64_tr_b16 a[178:179], v8 offset:53248
    v_mfma_f32_16x16x32_bf16 v[68:71], a[96:99], a[32:35], v[48:51]
    v_mfma_f32_16x16x32_bf16 v[68:71], a[100:103], a[36:39], v[68:71]
    v_mfma_f32_16x16x32_bf16 v[68:71], a[104:107], a[40:43], v[68:71]
    ds_read_b64_tr_b16 a[180:181], v9 offset:49152
    v_mfma_f32_16x16x32_bf16 v[68:71], a[108:111], a[44:47], v[68:71]
    v_exp_f32 v77, v77
    v_exp_f32 v78, v78
    v_exp_f32 v79, v79
    v_cvt_pk_bf16_f32 v86, v76, v77
    v_cvt_pk_bf16_f32 v87, v78, v79
    v_exp_f32 v64, v64
    s_nop 0
    v_mfma_f32_16x16x32_bf16 v[128:131], a[144:147], v[84:87], v[128:131]
    v_mfma_f32_16x16x32_bf16 v[132:135], a[148:151], v[84:87], v[132:135]
    v_mfma_f32_16x16x32_bf16 v[136:139], a[152:155], v[84:87], v[136:139]
    s_add_u32 s75, s101, 57344
    ds_read_b64_tr_b16 a[182:183], v9 offset:53248
    v_mfma_f32_16x16x32_bf16 v[140:143], a[156:159], v[84:87], v[140:143]
    s_and_b32 s75, s75, s79
    v_mfma_f32_16x16x32_bf16 v[144:147], a[160:163], v[84:87], v[144:147]
    s_add_u32 s75, s75, 131072
    ds_read_b64_tr_b16 a[184:185], v10 offset:49152
    v_mfma_f32_16x16x32_bf16 v[148:151], a[164:167], v[84:87], v[148:151]
    s_add_u32 m0, s74, 106496
    v_mfma_f32_16x16x32_bf16 v[152:155], a[168:171], v[84:87], v[152:155]
    buffer_load_dwordx4 v18, s[84:87], s75 offen offset:0 nt lds
    v_mfma_f32_16x16x32_bf16 v[156:159], a[172:175], v[84:87], v[156:159]
    v_exp_f32 v65, v65
    v_exp_f32 v66, v66
    v_exp_f32 v67, v67
    v_exp_f32 v68, v68
    v_cvt_pk_bf16_f32 v80, v64, v65
    v_cvt_pk_bf16_f32 v81, v66, v67
    v_mfma_f32_16x16x32_bf16 v[20:23], a[228:231], v[84:87], v[20:23]
    v_mfma_f32_16x16x32_bf16 v[72:75], a[80:83], a[48:51], v[52:55]
    ds_read_b64_tr_b16 a[186:187], v10 offset:53248
    v_mfma_f32_16x16x32_bf16 v[72:75], a[84:87], a[52:55], v[72:75]
    v_mfma_f32_16x16x32_bf16 v[72:75], a[88:91], a[56:59], v[72:75]
    v_mfma_f32_16x16x32_bf16 v[72:75], a[92:95], a[60:63], v[72:75]
    ds_read_b64_tr_b16 a[188:189], v11 offset:49152
    v_mfma_f32_16x16x32_bf16 v[76:79], a[96:99], a[48:51], v[52:55]
    v_mfma_f32_16x16x32_bf16 v[76:79], a[100:103], a[52:55], v[76:79]
    buffer_load_dwordx4 v19, s[84:87], s75 offen offset:1024 nt lds
    v_mfma_f32_16x16x32_bf16 v[76:79], a[104:107], a[56:59], v[76:79]
    ds_read_b64_tr_b16 a[190:191], v11 offset:53248
    v_mfma_f32_16x16x32_bf16 v[76:79], a[108:111], a[60:63], v[76:79]
    v_exp_f32 v69, v69
    v_exp_f32 v70, v70
    v_exp_f32 v71, v71
    v_cvt_pk_bf16_f32 v82, v68, v69
    v_cvt_pk_bf16_f32 v83, v70, v71
    v_exp_f32 v72, v72
    s_nop 0
    v_mfma_f32_16x16x32_bf16 v[160:163], a[144:147], v[80:83], v[160:163]
    v_mfma_f32_16x16x32_bf16 v[164:167], a[148:151], v[80:83], v[164:167]
    v_mfma_f32_16x16x32_bf16 v[168:171], a[152:155], v[80:83], v[168:171]
    ds_read_b64_tr_b16 a[192:193], v12 offset:49152
    v_mfma_f32_16x16x32_bf16 v[172:175], a[156:159], v[80:83], v[172:175]
    v_mfma_f32_16x16x32_bf16 v[176:179], a[160:163], v[80:83], v[176:179]
    v_mfma_f32_16x16x32_bf16 v[180:183], a[164:167], v[80:83], v[180:183]
    ds_read_b64_tr_b16 a[194:195], v12 offset:53248
    v_mfma_f32_16x16x32_bf16 v[184:187], a[168:171], v[80:83], v[184:187]
    v_mfma_f32_16x16x32_bf16 v[188:191], a[172:175], v[80:83], v[188:191]
    v_exp_f32 v73, v73
    v_exp_f32 v74, v74
    v_exp_f32 v75, v75
    v_exp_f32 v76, v76
    v_cvt_pk_bf16_f32 v84, v72, v73
    v_cvt_pk_bf16_f32 v85, v74, v75
    v_mfma_f32_16x16x32_bf16 v[36:39], a[228:231], v[80:83], v[36:39]
    ds_read_b64_tr_b16 a[196:197], v13 offset:49152
    v_mfma_f32_16x16x32_bf16 v[64:67], a[80:83], a[64:67], v[56:59]
    v_mfma_f32_16x16x32_bf16 v[64:67], a[84:87], a[68:71], v[64:67]
    v_mfma_f32_16x16x32_bf16 v[64:67], a[88:91], a[72:75], v[64:67]
    ds_read_b64_tr_b16 a[198:199], v13 offset:53248
    v_mfma_f32_16x16x32_bf16 v[64:67], a[92:95], a[76:79], v[64:67]
    v_mfma_f32_16x16x32_bf16 v[68:71], a[96:99], a[64:67], v[56:59]
    v_mfma_f32_16x16x32_bf16 v[68:71], a[100:103], a[68:71], v[68:71]
    ds_read_b64_tr_b16 a[200:201], v14 offset:49152
    v_mfma_f32_16x16x32_bf16 v[68:71], a[104:107], a[72:75], v[68:71]
    s_add_u32 s75, s100, 65536
    v_mfma_f32_16x16x32_bf16 v[68:71], a[108:111], a[76:79], v[68:71]
    s_and_b32 s75, s75, s79
    v_exp_f32 v77, v77
    v_exp_f32 v78, v78
    v_exp_f32 v79, v79
    v_cvt_pk_bf16_f32 v86, v76, v77
    v_cvt_pk_bf16_f32 v87, v78, v79
    v_exp_f32 v64, v64
    s_nop 0
    v_mfma_f32_16x16x32_bf16 v[192:195], a[144:147], v[84:87], v[192:195]
    s_add_u32 m0, s74, 16384
    ds_read_b64_tr_b16 a[202:203], v14 offset:53248
    v_mfma_f32_16x16x32_bf16 v[196:199], a[148:151], v[84:87], v[196:199]
    buffer_load_dwordx4 v16, s[80:83], s75 offen offset:0 nt lds
    v_mfma_f32_16x16x32_bf16 v[200:203], a[152:155], v[84:87], v[200:203]
    v_mfma_f32_16x16x32_bf16 v[204:207], a[156:159], v[84:87], v[204:207]
    v_mfma_f32_16x16x32_bf16 v[208:211], a[160:163], v[84:87], v[208:211]
    ds_read_b64_tr_b16 a[204:205], v15 offset:49152
    v_mfma_f32_16x16x32_bf16 v[212:215], a[164:167], v[84:87], v[212:215]
    v_mfma_f32_16x16x32_bf16 v[216:219], a[168:171], v[84:87], v[216:219]
    v_mfma_f32_16x16x32_bf16 v[220:223], a[172:175], v[84:87], v[220:223]
    v_exp_f32 v65, v65
    v_exp_f32 v66, v66
    v_exp_f32 v67, v67
    v_exp_f32 v68, v68
    v_cvt_pk_bf16_f32 v80, v64, v65
    v_cvt_pk_bf16_f32 v81, v66, v67
    v_mfma_f32_16x16x32_bf16 v[24:27], a[228:231], v[84:87], v[24:27]
    ds_read_b64_tr_b16 a[206:207], v15 offset:53248
    v_mfma_f32_16x16x32_bf16 v[72:75], a[112:115], a[0:3], v[40:43]
    buffer_load_dwordx4 v17, s[80:83], s75 offen offset:1024 nt lds
    v_mfma_f32_16x16x32_bf16 v[72:75], a[116:119], a[4:7], v[72:75]
    v_mfma_f32_16x16x32_bf16 v[72:75], a[120:123], a[8:11], v[72:75]
    v_mfma_f32_16x16x32_bf16 v[72:75], a[124:127], a[12:15], v[72:75]
    v_mfma_f32_16x16x32_bf16 v[76:79], a[128:131], a[0:3], v[40:43]
    v_mfma_f32_16x16x32_bf16 v[76:79], a[132:135], a[4:7], v[76:79]
    v_mfma_f32_16x16x32_bf16 v[76:79], a[136:139], a[8:11], v[76:79]
    v_mfma_f32_16x16x32_bf16 v[76:79], a[140:143], a[12:15], v[76:79]
    s_waitcnt vmcnt(30) lgkmcnt(0)
    v_exp_f32 v69, v69
    v_exp_f32 v70, v70
    v_exp_f32 v71, v71
    v_cvt_pk_bf16_f32 v82, v68, v69
    v_cvt_pk_bf16_f32 v83, v70, v71
    v_exp_f32 v72, v72
    s_nop 0
    v_mfma_f32_16x16x32_bf16 v[224:227], a[144:147], v[80:83], v[224:227]
    s_barrier
    v_mfma_f32_16x16x32_bf16 v[228:231], a[148:151], v[80:83], v[228:231]
    ds_read_b128 a[80:83], v4 offset:32768
    v_mfma_f32_16x16x32_bf16 v[232:235], a[152:155], v[80:83], v[232:235]
    v_mfma_f32_16x16x32_bf16 v[236:239], a[156:159], v[80:83], v[236:239]
    ds_read_b128 a[84:87], v5 offset:32768
    v_mfma_f32_16x16x32_bf16 v[240:243], a[160:163], v[80:83], v[240:243]
    v_mfma_f32_16x16x32_bf16 v[244:247], a[164:167], v[80:83], v[244:247]
    ds_read_b128 a[88:91], v6 offset:32768
    v_mfma_f32_16x16x32_bf16 v[248:251], a[168:171], v[80:83], v[248:251]
    v_mfma_f32_16x16x32_bf16 v[252:255], a[172:175], v[80:83], v[252:255]
    v_exp_f32 v73, v73
    v_exp_f32 v74, v74
    v_exp_f32 v75, v75
    v_exp_f32 v76, v76
    v_cvt_pk_bf16_f32 v84, v72, v73
    v_cvt_pk_bf16_f32 v85, v74, v75
    v_mfma_f32_16x16x32_bf16 v[60:63], a[228:231], v[80:83], v[60:63]
    s_add_u32 s75, s101, 65536
    ds_read_b128 a[92:95], v7 offset:32768
    v_mfma_f32_16x16x32_bf16 v[64:67], a[112:115], a[16:19], v[44:47]
    s_and_b32 s75, s75, s79
    v_mfma_f32_16x16x32_bf16 v[64:67], a[116:119], a[20:23], v[64:67]
    s_add_u32 s75, s75, 131072
    ds_read_b128 a[96:99], v4 offset:36864
    v_mfma_f32_16x16x32_bf16 v[64:67], a[120:123], a[24:27], v[64:67]
    s_add_u32 m0, s74, 24576
    v_mfma_f32_16x16x32_bf16 v[64:67], a[124:127], a[28:31], v[64:67]
    buffer_load_dwordx4 v16, s[80:83], s75 offen offset:0 nt lds
    v_mfma_f32_16x16x32_bf16 v[68:71], a[128:131], a[16:19], v[44:47]
    ds_read_b128 a[100:103], v5 offset:36864
    v_mfma_f32_16x16x32_bf16 v[68:71], a[132:135], a[20:23], v[68:71]
    v_mfma_f32_16x16x32_bf16 v[68:71], a[136:139], a[24:27], v[68:71]
    ds_read_b128 a[104:107], v6 offset:36864
    v_mfma_f32_16x16x32_bf16 v[68:71], a[140:143], a[28:31], v[68:71]
    v_exp_f32 v77, v77
    v_exp_f32 v78, v78
    v_exp_f32 v79, v79
    v_cvt_pk_bf16_f32 v86, v76, v77
    v_cvt_pk_bf16_f32 v87, v78, v79
    v_exp_f32 v64, v64
    s_nop 0
    v_mfma_f32_16x16x32_bf16 v[96:99], a[176:179], v[84:87], v[96:99]
    v_mfma_f32_16x16x32_bf16 v[100:103], a[180:183], v[84:87], v[100:103]
    ds_read_b128 a[108:111], v7 offset:36864
    v_mfma_f32_16x16x32_bf16 v[104:107], a[184:187], v[84:87], v[104:107]
    v_mfma_f32_16x16x32_bf16 v[108:111], a[188:191], v[84:87], v[108:111]
    buffer_load_dwordx4 v17, s[80:83], s75 offen offset:1024 nt lds
    v_mfma_f32_16x16x32_bf16 v[112:115], a[192:195], v[84:87], v[112:115]
    v_mfma_f32_16x16x32_bf16 v[116:119], a[196:199], v[84:87], v[116:119]
    v_mfma_f32_16x16x32_bf16 v[120:123], a[200:203], v[84:87], v[120:123]
    v_mfma_f32_16x16x32_bf16 v[124:127], a[204:207], v[84:87], v[124:127]
    v_exp_f32 v65, v65
    v_exp_f32 v66, v66
    v_exp_f32 v67, v67
    v_exp_f32 v68, v68
    v_cvt_pk_bf16_f32 v80, v64, v65
    v_cvt_pk_bf16_f32 v81, v66, v67
    v_mfma_f32_16x16x32_bf16 v[32:35], a[228:231], v[84:87], v[32:35]
    s_waitcnt vmcnt(28) lgkmcnt(0)
    v_mfma_f32_16x16x32_bf16 v[72:75], a[112:115], a[32:35], v[48:51]
    s_barrier
    v_mfma_f32_16x16x32_bf16 v[72:75], a[116:119], a[36:39], v[72:75]
    ds_read_b64_tr_b16 a[144:145], v8 offset:0
    v_mfma_f32_16x16x32_bf16 v[72:75], a[120:123], a[40:43], v[72:75]
    v_mfma_f32_16x16x32_bf16 v[72:75], a[124:127], a[44:47], v[72:75]
    ds_read_b64_tr_b16 a[146:147], v8 offset:4096
    v_mfma_f32_16x16x32_bf16 v[76:79], a[128:131], a[32:35], v[48:51]
    v_mfma_f32_16x16x32_bf16 v[76:79], a[132:135], a[36:39], v[76:79]
    v_mfma_f32_16x16x32_bf16 v[76:79], a[136:139], a[40:43], v[76:79]
    ds_read_b64_tr_b16 a[148:149], v9 offset:0
    v_mfma_f32_16x16x32_bf16 v[76:79], a[140:143], a[44:47], v[76:79]
    v_exp_f32 v69, v69
    v_exp_f32 v70, v70
    v_exp_f32 v71, v71
    v_cvt_pk_bf16_f32 v82, v68, v69
    v_cvt_pk_bf16_f32 v83, v70, v71
    v_exp_f32 v72, v72
    s_nop 0
    v_mfma_f32_16x16x32_bf16 v[128:131], a[176:179], v[80:83], v[128:131]
    v_mfma_f32_16x16x32_bf16 v[132:135], a[180:183], v[80:83], v[132:135]
    v_mfma_f32_16x16x32_bf16 v[136:139], a[184:187], v[80:83], v[136:139]
    ds_read_b64_tr_b16 a[150:151], v9 offset:4096
    v_mfma_f32_16x16x32_bf16 v[140:143], a[188:191], v[80:83], v[140:143]
    v_mfma_f32_16x16x32_bf16 v[144:147], a[192:195], v[80:83], v[144:147]
    ds_read_b64_tr_b16 a[152:153], v10 offset:0
    v_mfma_f32_16x16x32_bf16 v[148:151], a[196:199], v[80:83], v[148:151]
    s_add_u32 s75, s100, 65536
    v_mfma_f32_16x16x32_bf16 v[152:155], a[200:203], v[80:83], v[152:155]
    s_and_b32 s75, s75, s79
    v_mfma_f32_16x16x32_bf16 v[156:159], a[204:207], v[80:83], v[156:159]
    s_add_u32 m0, s74, 114688
    v_exp_f32 v73, v73
    v_exp_f32 v74, v74
    v_exp_f32 v75, v75
    v_exp_f32 v76, v76
    v_cvt_pk_bf16_f32 v84, v72, v73
    v_cvt_pk_bf16_f32 v85, v74, v75
    v_mfma_f32_16x16x32_bf16 v[20:23], a[228:231], v[80:83], v[20:23]
    buffer_load_dwordx4 v18, s[84:87], s75 offen offset:0 nt lds
    v_mfma_f32_16x16x32_bf16 v[64:67], a[112:115], a[48:51], v[52:55]
    ds_read_b64_tr_b16 a[154:155], v10 offset:4096
    v_mfma_f32_16x16x32_bf16 v[64:67], a[116:119], a[52:55], v[64:67]
    v_mfma_f32_16x16x32_bf16 v[64:67], a[120:123], a[56:59], v[64:67]
    v_mfma_f32_16x16x32_bf16 v[64:67], a[124:127], a[60:63], v[64:67]
    ds_read_b64_tr_b16 a[156:157], v11 offset:0
    v_mfma_f32_16x16x32_bf16 v[68:71], a[128:131], a[48:51], v[52:55]
    v_mfma_f32_16x16x32_bf16 v[68:71], a[132:135], a[52:55], v[68:71]
    ds_read_b64_tr_b16 a[158:159], v11 offset:4096
    v_mfma_f32_16x16x32_bf16 v[68:71], a[136:139], a[56:59], v[68:71]
    v_mfma_f32_16x16x32_bf16 v[68:71], a[140:143], a[60:63], v[68:71]
    v_exp_f32 v77, v77
    v_exp_f32 v78, v78
    v_exp_f32 v79, v79
    v_cvt_pk_bf16_f32 v86, v76, v77
    v_cvt_pk_bf16_f32 v87, v78, v79
    v_exp_f32 v64, v64
    s_nop 0
    v_mfma_f32_16x16x32_bf16 v[160:163], a[176:179], v[84:87], v[160:163]
    buffer_load_dwordx4 v19, s[84:87], s75 offen offset:1024 nt lds
    v_mfma_f32_16x16x32_bf16 v[164:167], a[180:183], v[84:87], v[164:167]
    v_mfma_f32_16x16x32_bf16 v[168:171], a[184:187], v[84:87], v[168:171]
    ds_read_b64_tr_b16 a[160:161], v12 offset:0
    v_mfma_f32_16x16x32_bf16 v[172:175], a[188:191], v[84:87], v[172:175]
    v_mfma_f32_16x16x32_bf16 v[176:179], a[192:195], v[84:87], v[176:179]
    v_mfma_f32_16x16x32_bf16 v[180:183], a[196:199], v[84:87], v[180:183]
    ds_read_b64_tr_b16 a[162:163], v12 offset:4096
    v_mfma_f32_16x16x32_bf16 v[184:187], a[200:203], v[84:87], v[184:187]
    v_mfma_f32_16x16x32_bf16 v[188:191], a[204:207], v[84:87], v[188:191]
    v_exp_f32 v65, v65
    v_exp_f32 v66, v66
    v_exp_f32 v67, v67
    v_exp_f32 v68, v68
    v_cvt_pk_bf16_f32 v80, v64, v65
    v_cvt_pk_bf16_f32 v81, v66, v67
    v_mfma_f32_16x16x32_bf16 v[36:39], a[228:231], v[84:87], v[36:39]
    ds_read_b64_tr_b16 a[164:165], v13 offset:0
    v_mfma_f32_16x16x32_bf16 v[72:75], a[112:115], a[64:67], v[56:59]
    v_mfma_f32_16x16x32_bf16 v[72:75], a[116:119], a[68:71], v[72:75]
    v_mfma_f32_16x16x32_bf16 v[72:75], a[120:123], a[72:75], v[72:75]
    ds_read_b64_tr_b16 a[166:167], v13 offset:4096
    v_mfma_f32_16x16x32_bf16 v[72:75], a[124:127], a[76:79], v[72:75]
    v_mfma_f32_16x16x32_bf16 v[76:79], a[128:131], a[64:67], v[56:59]
    v_mfma_f32_16x16x32_bf16 v[76:79], a[132:135], a[68:71], v[76:79]
    ds_read_b64_tr_b16 a[168:169], v14 offset:0
    v_mfma_f32_16x16x32_bf16 v[76:79], a[136:139], a[72:75], v[76:79]
    s_add_u32 s75, s101, 65536
    v_mfma_f32_16x16x32_bf16 v[76:79], a[140:143], a[76:79], v[76:79]
    s_and_b32 s75, s75, s79
    v_exp_f32 v69, v69
    v_exp_f32 v70, v70
    v_exp_f32 v71, v71
    v_cvt_pk_bf16_f32 v82, v68, v69
    v_cvt_pk_bf16_f32 v83, v70, v71
    v_exp_f32 v72, v72
    s_nop 0
    v_mfma_f32_16x16x32_bf16 v[192:195], a[176:179], v[80:83], v[192:195]
    s_add_u32 s75, s75, 131072
    ds_read_b64_tr_b16 a[170:171], v14 offset:4096
    v_mfma_f32_16x16x32_bf16 v[196:199], a[180:183], v[80:83], v[196:199]
    s_add_u32 m0, s74, 122880
    v_mfma_f32_16x16x32_bf16 v[200:203], a[184:187], v[80:83], v[200:203]
    buffer_load_dwordx4 v18, s[84:87], s75 offen offset:0 nt lds
    v_mfma_f32_16x16x32_bf16 v[204:207], a[188:191], v[80:83], v[204:207]
    v_mfma_f32_16x16x32_bf16 v[208:211], a[192:195], v[80:83], v[208:211]
    ds_read_b64_tr_b16 a[172:173], v15 offset:0
    v_mfma_f32_16x16x32_bf16 v[212:215], a[196:199], v[80:83], v[212:215]
    v_mfma_f32_16x16x32_bf16 v[216:219], a[200:203], v[80:83], v[216:219]
    v_mfma_f32_16x16x32_bf16 v[220:223], a[204:207], v[80:83], v[220:223]
    v_exp_f32 v73, v73
    v_exp_f32 v74, v74
    v_exp_f32 v75, v75
    v_exp_f32 v76, v76
    v_cvt_pk_bf16_f32 v84, v72, v73
    v_cvt_pk_bf16_f32 v85, v74, v75
    v_mfma_f32_16x16x32_bf16 v[24:27], a[228:231], v[80:83], v[24:27]
    ds_read_b64_tr_b16 a[174:175], v15 offset:4096
    v_mfma_f32_16x16x32_bf16 v[64:67], a[80:83], a[0:3], v[40:43]
    v_mfma_f32_16x16x32_bf16 v[64:67], a[84:87], a[4:7], v[64:67]
    buffer_load_dwordx4 v19, s[84:87], s75 offen offset:1024 nt lds
    v_mfma_f32_16x16x32_bf16 v[64:67], a[88:91], a[8:11], v[64:67]
    v_mfma_f32_16x16x32_bf16 v[64:67], a[92:95], a[12:15], v[64:67]
    v_mfma_f32_16x16x32_bf16 v[68:71], a[96:99], a[0:3], v[40:43]
    v_mfma_f32_16x16x32_bf16 v[68:71], a[100:103], a[4:7], v[68:71]
    v_mfma_f32_16x16x32_bf16 v[68:71], a[104:107], a[8:11], v[68:71]
    v_mfma_f32_16x16x32_bf16 v[68:71], a[108:111], a[12:15], v[68:71]
    s_waitcnt vmcnt(28) lgkmcnt(0)
    v_exp_f32 v77, v77
    v_exp_f32 v78, v78
    v_exp_f32 v79, v79
    v_cvt_pk_bf16_f32 v86, v76, v77
    v_cvt_pk_bf16_f32 v87, v78, v79
    v_exp_f32 v64, v64
    s_nop 0
    v_mfma_f32_16x16x32_bf16 v[224:227], a[176:179], v[84:87], v[224:227]
    s_barrier
    v_mfma_f32_16x16x32_bf16 v[228:231], a[180:183], v[84:87], v[228:231]
    ds_read_b128 a[112:115], v4 offset:49152
    v_mfma_f32_16x16x32_bf16 v[232:235], a[184:187], v[84:87], v[232:235]
    v_mfma_f32_16x16x32_bf16 v[236:239], a[188:191], v[84:87], v[236:239]
    ds_read_b128 a[116:119], v5 offset:49152
    v_mfma_f32_16x16x32_bf16 v[240:243], a[192:195], v[84:87], v[240:243]
    v_mfma_f32_16x16x32_bf16 v[244:247], a[196:199], v[84:87], v[244:247]
    ds_read_b128 a[120:123], v6 offset:49152
    v_mfma_f32_16x16x32_bf16 v[248:251], a[200:203], v[84:87], v[248:251]
    v_mfma_f32_16x16x32_bf16 v[252:255], a[204:207], v[84:87], v[252:255]
    v_exp_f32 v65, v65
    v_exp_f32 v66, v66
    v_exp_f32 v67, v67
    v_exp_f32 v68, v68
    v_cvt_pk_bf16_f32 v80, v64, v65
    v_cvt_pk_bf16_f32 v81, v66, v67
    v_mfma_f32_16x16x32_bf16 v[60:63], a[228:231], v[84:87], v[60:63]
    ds_read_b128 a[124:127], v7 offset:49152
    v_mfma_f32_16x16x32_bf16 v[72:75], a[80:83], a[16:19], v[44:47]
    v_mfma_f32_16x16x32_bf16 v[72:75], a[84:87], a[20:23], v[72:75]
    ds_read_b128 a[128:131], v4 offset:53248
    v_mfma_f32_16x16x32_bf16 v[72:75], a[88:91], a[24:27], v[72:75]
    s_add_u32 s75, s100, 73728
    v_mfma_f32_16x16x32_bf16 v[72:75], a[92:95], a[28:31], v[72:75]
    s_and_b32 s75, s75, s79
    ds_read_b128 a[132:135], v5 offset:53248
    v_mfma_f32_16x16x32_bf16 v[76:79], a[96:99], a[16:19], v[44:47]
    s_add_u32 m0, s74, 32768
    v_mfma_f32_16x16x32_bf16 v[76:79], a[100:103], a[20:23], v[76:79]
    buffer_load_dwordx4 v16, s[80:83], s75 offen offset:0 nt lds
    v_mfma_f32_16x16x32_bf16 v[76:79], a[104:107], a[24:27], v[76:79]
    ds_read_b128 a[136:139], v6 offset:53248
    v_mfma_f32_16x16x32_bf16 v[76:79], a[108:111], a[28:31], v[76:79]
    v_exp_f32 v69, v69
    v_exp_f32 v70, v70
    v_exp_f32 v71, v71
    v_cvt_pk_bf16_f32 v82, v68, v69
    v_cvt_pk_bf16_f32 v83, v70, v71
    v_exp_f32 v72, v72
    s_nop 0
    v_mfma_f32_16x16x32_bf16 v[96:99], a[144:147], v[80:83], v[96:99]
    v_mfma_f32_16x16x32_bf16 v[100:103], a[148:151], v[80:83], v[100:103]
    ds_read_b128 a[140:143], v7 offset:53248
    v_mfma_f32_16x16x32_bf16 v[104:107], a[152:155], v[80:83], v[104:107]
    v_mfma_f32_16x16x32_bf16 v[108:111], a[156:159], v[80:83], v[108:111]
    v_mfma_f32_16x16x32_bf16 v[112:115], a[160:163], v[80:83], v[112:115]
    v_mfma_f32_16x16x32_bf16 v[116:119], a[164:167], v[80:83], v[116:119]
    buffer_load_dwordx4 v17, s[80:83], s75 offen offset:1024 nt lds
    v_mfma_f32_16x16x32_bf16 v[120:123], a[168:171], v[80:83], v[120:123]
    v_mfma_f32_16x16x32_bf16 v[124:127], a[172:175], v[80:83], v[124:127]
    v_exp_f32 v73, v73
    v_exp_f32 v74, v74
    v_exp_f32 v75, v75
    v_exp_f32 v76, v76
    v_cvt_pk_bf16_f32 v84, v72, v73
    v_cvt_pk_bf16_f32 v85, v74, v75
    v_mfma_f32_16x16x32_bf16 v[32:35], a[228:231], v[80:83], v[32:35]
    s_waitcnt vmcnt(26) lgkmcnt(0)
    v_mfma_f32_16x16x32_bf16 v[64:67], a[80:83], a[32:35], v[48:51]
    s_barrier
    v_mfma_f32_16x16x32_bf16 v[64:67], a[84:87], a[36:39], v[64:67]
    ds_read_b64_tr_b16 a[176:177], v8 offset:16384
    v_mfma_f32_16x16x32_bf16 v[64:67], a[88:91], a[40:43], v[64:67]
    v_mfma_f32_16x16x32_bf16 v[64:67], a[92:95], a[44:47], v[64:67]
    ds_read_b64_tr_b16 a[178:179], v8 offset:20480
    v_mfma_f32_16x16x32_bf16 v[68:71], a[96:99], a[32:35], v[48:51]
    v_mfma_f32_16x16x32_bf16 v[68:71], a[100:103], a[36:39], v[68:71]
    v_mfma_f32_16x16x32_bf16 v[68:71], a[104:107], a[40:43], v[68:71]
    ds_read_b64_tr_b16 a[180:181], v9 offset:16384
    v_mfma_f32_16x16x32_bf16 v[68:71], a[108:111], a[44:47], v[68:71]
    v_exp_f32 v77, v77
    v_exp_f32 v78, v78
    v_exp_f32 v79, v79
    v_cvt_pk_bf16_f32 v86, v76, v77
    v_cvt_pk_bf16_f32 v87, v78, v79
    v_exp_f32 v64, v64
    s_nop 0
    v_mfma_f32_16x16x32_bf16 v[128:131], a[144:147], v[84:87], v[128:131]
    v_mfma_f32_16x16x32_bf16 v[132:135], a[148:151], v[84:87], v[132:135]
    v_mfma_f32_16x16x32_bf16 v[136:139], a[152:155], v[84:87], v[136:139]
    ds_read_b64_tr_b16 a[182:183], v9 offset:20480
    v_mfma_f32_16x16x32_bf16 v[140:143], a[156:159], v[84:87], v[140:143]
    v_mfma_f32_16x16x32_bf16 v[144:147], a[160:163], v[84:87], v[144:147]
    ds_read_b64_tr_b16 a[184:185], v10 offset:16384
    v_mfma_f32_16x16x32_bf16 v[148:151], a[164:167], v[84:87], v[148:151]
    s_add_u32 s75, s101, 73728
    v_mfma_f32_16x16x32_bf16 v[152:155], a[168:171], v[84:87], v[152:155]
    s_and_b32 s75, s75, s79
    v_mfma_f32_16x16x32_bf16 v[156:159], a[172:175], v[84:87], v[156:159]
    s_add_u32 s75, s75, 131072
    v_exp_f32 v65, v65
    v_exp_f32 v66, v66
    v_exp_f32 v67, v67
    v_exp_f32 v68, v68
    v_cvt_pk_bf16_f32 v80, v64, v65
    v_cvt_pk_bf16_f32 v81, v66, v67
    v_mfma_f32_16x16x32_bf16 v[20:23], a[228:231], v[84:87], v[20:23]
    s_add_u32 m0, s74, 40960
    ds_read_b64_tr_b16 a[186:187], v10 offset:20480
    v_mfma_f32_16x16x32_bf16 v[72:75], a[80:83], a[48:51], v[52:55]
    buffer_load_dwordx4 v16, s[80:83], s75 offen offset:0 nt lds
    v_mfma_f32_16x16x32_bf16 v[72:75], a[84:87], a[52:55], v[72:75]
    v_mfma_f32_16x16x32_bf16 v[72:75], a[88:91], a[56:59], v[72:75]
    v_mfma_f32_16x16x32_bf16 v[72:75], a[92:95], a[60:63], v[72:75]
    ds_read_b64_tr_b16 a[188:189], v11 offset:16384
    v_mfma_f32_16x16x32_bf16 v[76:79], a[96:99], a[48:51], v[52:55]
    v_mfma_f32_16x16x32_bf16 v[76:79], a[100:103], a[52:55], v[76:79]
    ds_read_b64_tr_b16 a[190:191], v11 offset:20480
    v_mfma_f32_16x16x32_bf16 v[76:79], a[104:107], a[56:59], v[76:79]
    v_mfma_f32_16x16x32_bf16 v[76:79], a[108:111], a[60:63], v[76:79]
    v_exp_f32 v69, v69
    v_exp_f32 v70, v70
    v_exp_f32 v71, v71
    v_cvt_pk_bf16_f32 v82, v68, v69
    v_cvt_pk_bf16_f32 v83, v70, v71
    v_exp_f32 v72, v72
    s_nop 0
    v_mfma_f32_16x16x32_bf16 v[160:163], a[144:147], v[80:83], v[160:163]
    buffer_load_dwordx4 v17, s[80:83], s75 offen offset:1024 nt lds
    v_mfma_f32_16x16x32_bf16 v[164:167], a[148:151], v[80:83], v[164:167]
    v_mfma_f32_16x16x32_bf16 v[168:171], a[152:155], v[80:83], v[168:171]
    ds_read_b64_tr_b16 a[192:193], v12 offset:16384
    v_mfma_f32_16x16x32_bf16 v[172:175], a[156:159], v[80:83], v[172:175]
    v_mfma_f32_16x16x32_bf16 v[176:179], a[160:163], v[80:83], v[176:179]
    v_mfma_f32_16x16x32_bf16 v[180:183], a[164:167], v[80:83], v[180:183]
    ds_read_b64_tr_b16 a[194:195], v12 offset:20480
    v_mfma_f32_16x16x32_bf16 v[184:187], a[168:171], v[80:83], v[184:187]
    v_mfma_f32_16x16x32_bf16 v[188:191], a[172:175], v[80:83], v[188:191]
    v_exp_f32 v73, v73
    v_exp_f32 v74, v74
    v_exp_f32 v75, v75
    v_exp_f32 v76, v76
    v_cvt_pk_bf16_f32 v84, v72, v73
    v_cvt_pk_bf16_f32 v85, v74, v75
    v_mfma_f32_16x16x32_bf16 v[36:39], a[228:231], v[80:83], v[36:39]
    ds_read_b64_tr_b16 a[196:197], v13 offset:16384
    v_mfma_f32_16x16x32_bf16 v[64:67], a[80:83], a[64:67], v[56:59]
    v_mfma_f32_16x16x32_bf16 v[64:67], a[84:87], a[68:71], v[64:67]
    v_mfma_f32_16x16x32_bf16 v[64:67], a[88:91], a[72:75], v[64:67]
    ds_read_b64_tr_b16 a[198:199], v13 offset:20480
    v_mfma_f32_16x16x32_bf16 v[64:67], a[92:95], a[76:79], v[64:67]
    v_mfma_f32_16x16x32_bf16 v[68:71], a[96:99], a[64:67], v[56:59]
    v_mfma_f32_16x16x32_bf16 v[68:71], a[100:103], a[68:71], v[68:71]
    ds_read_b64_tr_b16 a[200:201], v14 offset:16384
    v_mfma_f32_16x16x32_bf16 v[68:71], a[104:107], a[72:75], v[68:71]
    v_mfma_f32_16x16x32_bf16 v[68:71], a[108:111], a[76:79], v[68:71]
    v_exp_f32 v77, v77
    v_exp_f32 v78, v78
    v_exp_f32 v79, v79
    v_cvt_pk_bf16_f32 v86, v76, v77
    v_cvt_pk_bf16_f32 v87, v78, v79
    v_exp_f32 v64, v64
    s_nop 0
    v_mfma_f32_16x16x32_bf16 v[192:195], a[144:147], v[84:87], v[192:195]
    s_add_u32 s75, s100, 73728
    ds_read_b64_tr_b16 a[202:203], v14 offset:20480
    v_mfma_f32_16x16x32_bf16 v[196:199], a[148:151], v[84:87], v[196:199]
    s_and_b32 s75, s75, s79
    v_mfma_f32_16x16x32_bf16 v[200:203], a[152:155], v[84:87], v[200:203]
    s_add_u32 m0, s74, 65536
    v_mfma_f32_16x16x32_bf16 v[204:207], a[156:159], v[84:87], v[204:207]
    buffer_load_dwordx4 v18, s[84:87], s75 offen offset:0 nt lds
    v_mfma_f32_16x16x32_bf16 v[208:211], a[160:163], v[84:87], v[208:211]
    ds_read_b64_tr_b16 a[204:205], v15 offset:16384
    v_mfma_f32_16x16x32_bf16 v[212:215], a[164:167], v[84:87], v[212:215]
    v_mfma_f32_16x16x32_bf16 v[216:219], a[168:171], v[84:87], v[216:219]
    v_mfma_f32_16x16x32_bf16 v[220:223], a[172:175], v[84:87], v[220:223]
    v_exp_f32 v65, v65
    v_exp_f32 v66, v66
    v_exp_f32 v67, v67
    v_exp_f32 v68, v68
    v_cvt_pk_bf16_f32 v80, v64, v65
    v_cvt_pk_bf16_f32 v81, v66, v67
    v_mfma_f32_16x16x32_bf16 v[24:27], a[228:231], v[84:87], v[24:27]
    ds_read_b64_tr_b16 a[206:207], v15 offset:20480
    v_mfma_f32_16x16x32_bf16 v[72:75], a[112:115], a[0:3], v[40:43]
    v_mfma_f32_16x16x32_bf16 v[72:75], a[116:119], a[4:7], v[72:75]
    v_mfma_f32_16x16x32_bf16 v[72:75], a[120:123], a[8:11], v[72:75]
    buffer_load_dwordx4 v19, s[84:87], s75 offen offset:1024 nt lds
    v_mfma_f32_16x16x32_bf16 v[72:75], a[124:127], a[12:15], v[72:75]
    v_mfma_f32_16x16x32_bf16 v[76:79], a[128:131], a[0:3], v[40:43]
    v_mfma_f32_16x16x32_bf16 v[76:79], a[132:135], a[4:7], v[76:79]
    v_mfma_f32_16x16x32_bf16 v[76:79], a[136:139], a[8:11], v[76:79]
    v_mfma_f32_16x16x32_bf16 v[76:79], a[140:143], a[12:15], v[76:79]
    s_waitcnt lgkmcnt(0)
    v_exp_f32 v69, v69
    v_exp_f32 v70, v70
    v_exp_f32 v71, v71
    v_cvt_pk_bf16_f32 v82, v68, v69
    v_cvt_pk_bf16_f32 v83, v70, v71
    v_exp_f32 v72, v72
    s_nop 0
    v_mfma_f32_16x16x32_bf16 v[224:227], a[144:147], v[80:83], v[224:227]
    v_mfma_f32_16x16x32_bf16 v[228:231], a[148:151], v[80:83], v[228:231]
    v_mfma_f32_16x16x32_bf16 v[232:235], a[152:155], v[80:83], v[232:235]
    v_mfma_f32_16x16x32_bf16 v[236:239], a[156:159], v[80:83], v[236:239]
    v_mfma_f32_16x16x32_bf16 v[240:243], a[160:163], v[80:83], v[240:243]
    v_mfma_f32_16x16x32_bf16 v[244:247], a[164:167], v[80:83], v[244:247]
    v_mfma_f32_16x16x32_bf16 v[248:251], a[168:171], v[80:83], v[248:251]
    v_mfma_f32_16x16x32_bf16 v[252:255], a[172:175], v[80:83], v[252:255]
    v_exp_f32 v73, v73
    v_exp_f32 v74, v74
    v_exp_f32 v75, v75
    v_exp_f32 v76, v76
    v_cvt_pk_bf16_f32 v84, v72, v73
    v_cvt_pk_bf16_f32 v85, v74, v75
    v_mfma_f32_16x16x32_bf16 v[60:63], a[228:231], v[80:83], v[60:63]
    v_mfma_f32_16x16x32_bf16 v[64:67], a[112:115], a[16:19], v[44:47]
    v_mfma_f32_16x16x32_bf16 v[64:67], a[116:119], a[20:23], v[64:67]
    v_mfma_f32_16x16x32_bf16 v[64:67], a[120:123], a[24:27], v[64:67]
    s_add_u32 s75, s101, 73728
    v_mfma_f32_16x16x32_bf16 v[64:67], a[124:127], a[28:31], v[64:67]
    s_and_b32 s75, s75, s79
    v_mfma_f32_16x16x32_bf16 v[68:71], a[128:131], a[16:19], v[44:47]
    s_add_u32 s75, s75, 131072
    v_mfma_f32_16x16x32_bf16 v[68:71], a[132:135], a[20:23], v[68:71]
    s_add_u32 m0, s74, 73728
    v_mfma_f32_16x16x32_bf16 v[68:71], a[136:139], a[24:27], v[68:71]
    buffer_load_dwordx4 v18, s[84:87], s75 offen offset:0 nt lds
    v_mfma_f32_16x16x32_bf16 v[68:71], a[140:143], a[28:31], v[68:71]
    v_exp_f32 v77, v77
    v_exp_f32 v78, v78
    v_exp_f32 v79, v79
    v_cvt_pk_bf16_f32 v86, v76, v77
    v_cvt_pk_bf16_f32 v87, v78, v79
    v_exp_f32 v64, v64
    s_nop 0
    v_mfma_f32_16x16x32_bf16 v[96:99], a[176:179], v[84:87], v[96:99]
    v_mfma_f32_16x16x32_bf16 v[100:103], a[180:183], v[84:87], v[100:103]
    v_mfma_f32_16x16x32_bf16 v[104:107], a[184:187], v[84:87], v[104:107]
    v_mfma_f32_16x16x32_bf16 v[108:111], a[188:191], v[84:87], v[108:111]
    v_mfma_f32_16x16x32_bf16 v[112:115], a[192:195], v[84:87], v[112:115]
    v_mfma_f32_16x16x32_bf16 v[116:119], a[196:199], v[84:87], v[116:119]
    v_mfma_f32_16x16x32_bf16 v[120:123], a[200:203], v[84:87], v[120:123]
    buffer_load_dwordx4 v19, s[84:87], s75 offen offset:1024 nt lds
    v_mfma_f32_16x16x32_bf16 v[124:127], a[204:207], v[84:87], v[124:127]
    v_exp_f32 v65, v65
    v_exp_f32 v66, v66
    v_exp_f32 v67, v67
    v_exp_f32 v68, v68
    v_cvt_pk_bf16_f32 v80, v64, v65
    v_cvt_pk_bf16_f32 v81, v66, v67
    v_mfma_f32_16x16x32_bf16 v[32:35], a[228:231], v[84:87], v[32:35]
    v_mfma_f32_16x16x32_bf16 v[72:75], a[112:115], a[32:35], v[48:51]
    v_mfma_f32_16x16x32_bf16 v[72:75], a[116:119], a[36:39], v[72:75]
    v_mfma_f32_16x16x32_bf16 v[72:75], a[120:123], a[40:43], v[72:75]
    v_mfma_f32_16x16x32_bf16 v[72:75], a[124:127], a[44:47], v[72:75]
    v_mfma_f32_16x16x32_bf16 v[76:79], a[128:131], a[32:35], v[48:51]
    v_mfma_f32_16x16x32_bf16 v[76:79], a[132:135], a[36:39], v[76:79]
    v_mfma_f32_16x16x32_bf16 v[76:79], a[136:139], a[40:43], v[76:79]
    v_mfma_f32_16x16x32_bf16 v[76:79], a[140:143], a[44:47], v[76:79]
    v_exp_f32 v69, v69
    v_exp_f32 v70, v70
    v_exp_f32 v71, v71
    v_cvt_pk_bf16_f32 v82, v68, v69
    v_cvt_pk_bf16_f32 v83, v70, v71
    v_exp_f32 v72, v72
    s_nop 0
    v_mfma_f32_16x16x32_bf16 v[128:131], a[176:179], v[80:83], v[128:131]
    v_mfma_f32_16x16x32_bf16 v[132:135], a[180:183], v[80:83], v[132:135]
    v_mfma_f32_16x16x32_bf16 v[136:139], a[184:187], v[80:83], v[136:139]
    v_mfma_f32_16x16x32_bf16 v[140:143], a[188:191], v[80:83], v[140:143]
    v_mfma_f32_16x16x32_bf16 v[144:147], a[192:195], v[80:83], v[144:147]
    v_mfma_f32_16x16x32_bf16 v[148:151], a[196:199], v[80:83], v[148:151]
    v_mfma_f32_16x16x32_bf16 v[152:155], a[200:203], v[80:83], v[152:155]
    v_mfma_f32_16x16x32_bf16 v[156:159], a[204:207], v[80:83], v[156:159]
    s_add_u32 s75, s100, 81920
    v_exp_f32 v73, v73
    v_exp_f32 v74, v74
    v_exp_f32 v75, v75
    v_exp_f32 v76, v76
    v_cvt_pk_bf16_f32 v84, v72, v73
    v_cvt_pk_bf16_f32 v85, v74, v75
    v_mfma_f32_16x16x32_bf16 v[20:23], a[228:231], v[80:83], v[20:23]
    s_waitcnt vmcnt(28) lgkmcnt(0)
    s_and_b32 s75, s75, s79
    v_add_u32 v4, 0x20000, v4
    v_add_u32 v5, 0x20000, v5
    v_add_u32 v6, 0x20000, v6
    v_add_u32 v7, 0x20000, v7
    v_mfma_f32_16x16x32_bf16 v[64:67], a[112:115], a[48:51], v[52:55]
    s_barrier
    s_add_u32 m0, s74, 49152
    v_mfma_f32_16x16x32_bf16 v[64:67], a[116:119], a[52:55], v[64:67]
    buffer_load_dwordx4 v16, s[80:83], s75 offen offset:0 nt lds
    v_mfma_f32_16x16x32_bf16 v[64:67], a[120:123], a[56:59], v[64:67]
    ds_read_b128 a[80:83], v4 offset:0
    v_mfma_f32_16x16x32_bf16 v[64:67], a[124:127], a[60:63], v[64:67]
    v_mfma_f32_16x16x32_bf16 v[68:71], a[128:131], a[48:51], v[52:55]
    ds_read_b128 a[84:87], v5 offset:0
    v_mfma_f32_16x16x32_bf16 v[68:71], a[132:135], a[52:55], v[68:71]
    v_mfma_f32_16x16x32_bf16 v[68:71], a[136:139], a[56:59], v[68:71]
    v_mfma_f32_16x16x32_bf16 v[68:71], a[140:143], a[60:63], v[68:71]
    v_exp_f32 v77, v77
    v_exp_f32 v78, v78
    v_exp_f32 v79, v79
    v_cvt_pk_bf16_f32 v86, v76, v77
    v_cvt_pk_bf16_f32 v87, v78, v79
    v_exp_f32 v64, v64
    s_nop 0
    v_mfma_f32_16x16x32_bf16 v[160:163], a[176:179], v[84:87], v[160:163]
    ds_read_b128 a[88:91], v6 offset:0
    v_mfma_f32_16x16x32_bf16 v[164:167], a[180:183], v[84:87], v[164:167]
    buffer_load_dwordx4 v17, s[80:83], s75 offen offset:1024 nt lds
    v_mfma_f32_16x16x32_bf16 v[168:171], a[184:187], v[84:87], v[168:171]
    v_mfma_f32_16x16x32_bf16 v[172:175], a[188:191], v[84:87], v[172:175]
    v_mfma_f32_16x16x32_bf16 v[176:179], a[192:195], v[84:87], v[176:179]
    ds_read_b128 a[92:95], v7 offset:0
    v_mfma_f32_16x16x32_bf16 v[180:183], a[196:199], v[84:87], v[180:183]
    v_mfma_f32_16x16x32_bf16 v[184:187], a[200:203], v[84:87], v[184:187]
    v_mfma_f32_16x16x32_bf16 v[188:191], a[204:207], v[84:87], v[188:191]
    v_exp_f32 v65, v65
    v_exp_f32 v66, v66
    v_exp_f32 v67, v67
    v_exp_f32 v68, v68
    v_cvt_pk_bf16_f32 v80, v64, v65
    v_cvt_pk_bf16_f32 v81, v66, v67
    v_mfma_f32_16x16x32_bf16 v[36:39], a[228:231], v[84:87], v[36:39]
    s_waitcnt vmcnt(26) lgkmcnt(0)
    ds_read_b128 a[96:99], v4 offset:4096
    v_add_u32 v8, 0x10000, v8
    v_add_u32 v9, 0x10000, v9
    v_add_u32 v10, 0x10000, v10
    v_add_u32 v11, 0x10000, v11
    v_add_u32 v12, 0x10000, v12
    v_add_u32 v13, 0x10000, v13
    v_add_u32 v14, 0x10000, v14
    v_add_u32 v15, 0x10000, v15
    v_mfma_f32_16x16x32_bf16 v[72:75], a[112:115], a[64:67], v[56:59]
    s_barrier
    v_mfma_f32_16x16x32_bf16 v[72:75], a[116:119], a[68:71], v[72:75]
    ds_read_b128 a[100:103], v5 offset:4096
    v_mfma_f32_16x16x32_bf16 v[72:75], a[120:123], a[72:75], v[72:75]
    ds_read_b64_tr_b16 a[144:145], v8 offset:16384
    v_mfma_f32_16x16x32_bf16 v[72:75], a[124:127], a[76:79], v[72:75]
    ds_read_b64_tr_b16 a[146:147], v8 offset:20480
    v_mfma_f32_16x16x32_bf16 v[76:79], a[128:131], a[64:67], v[56:59]
    ds_read_b128 a[104:107], v6 offset:4096
    v_mfma_f32_16x16x32_bf16 v[76:79], a[132:135], a[68:71], v[76:79]
    v_mfma_f32_16x16x32_bf16 v[76:79], a[136:139], a[72:75], v[76:79]
    ds_read_b64_tr_b16 a[148:149], v9 offset:16384
    v_mfma_f32_16x16x32_bf16 v[76:79], a[140:143], a[76:79], v[76:79]
    v_exp_f32 v69, v69
    v_exp_f32 v70, v70
    v_exp_f32 v71, v71
    v_cvt_pk_bf16_f32 v82, v68, v69
    v_cvt_pk_bf16_f32 v83, v70, v71
    v_exp_f32 v72, v72
    s_nop 0
    v_mfma_f32_16x16x32_bf16 v[192:195], a[176:179], v[80:83], v[192:195]
    ds_read_b128 a[108:111], v7 offset:4096
    v_mfma_f32_16x16x32_bf16 v[196:199], a[180:183], v[80:83], v[196:199]
    s_add_u32 s75, s101, 81920
    v_mfma_f32_16x16x32_bf16 v[200:203], a[184:187], v[80:83], v[200:203]
    s_and_b32 s75, s75, s79
    ds_read_b64_tr_b16 a[150:151], v9 offset:20480
    v_mfma_f32_16x16x32_bf16 v[204:207], a[188:191], v[80:83], v[204:207]
    s_add_u32 s75, s75, 131072
    ds_read_b64_tr_b16 a[152:153], v10 offset:16384
    v_mfma_f32_16x16x32_bf16 v[208:211], a[192:195], v[80:83], v[208:211]
    s_add_u32 m0, s74, 57344
    v_mfma_f32_16x16x32_bf16 v[212:215], a[196:199], v[80:83], v[212:215]
    buffer_load_dwordx4 v16, s[80:83], s75 offen offset:0 nt lds
    v_mfma_f32_16x16x32_bf16 v[216:219], a[200:203], v[80:83], v[216:219]
    ds_read_b64_tr_b16 a[154:155], v10 offset:20480
    v_mfma_f32_16x16x32_bf16 v[220:223], a[204:207], v[80:83], v[220:223]
    v_exp_f32 v73, v73
    v_exp_f32 v74, v74
    v_exp_f32 v75, v75
    v_exp_f32 v76, v76
    v_cvt_pk_bf16_f32 v84, v72, v73
    v_cvt_pk_bf16_f32 v85, v74, v75
    v_mfma_f32_16x16x32_bf16 v[24:27], a[228:231], v[80:83], v[24:27]
    s_waitcnt lgkmcnt(0)
    v_subrev_u32 v4, 0x20000, v4
    v_subrev_u32 v5, 0x20000, v5
    v_subrev_u32 v6, 0x20000, v6
    v_subrev_u32 v7, 0x20000, v7
    v_mfma_f32_16x16x32_bf16 v[64:67], a[80:83], a[0:3], v[40:43]
    ds_read_b64_tr_b16 a[156:157], v11 offset:16384
    v_mfma_f32_16x16x32_bf16 v[64:67], a[84:87], a[4:7], v[64:67]
    ds_read_b64_tr_b16 a[158:159], v11 offset:20480
    v_mfma_f32_16x16x32_bf16 v[64:67], a[88:91], a[8:11], v[64:67]
    v_mfma_f32_16x16x32_bf16 v[64:67], a[92:95], a[12:15], v[64:67]
    ds_read_b64_tr_b16 a[160:161], v12 offset:16384
    v_mfma_f32_16x16x32_bf16 v[68:71], a[96:99], a[0:3], v[40:43]
    buffer_load_dwordx4 v17, s[80:83], s75 offen offset:1024 nt lds
    v_mfma_f32_16x16x32_bf16 v[68:71], a[100:103], a[4:7], v[68:71]
    v_mfma_f32_16x16x32_bf16 v[68:71], a[104:107], a[8:11], v[68:71]
    ds_read_b64_tr_b16 a[162:163], v12 offset:20480
    v_mfma_f32_16x16x32_bf16 v[68:71], a[108:111], a[12:15], v[68:71]
    v_exp_f32 v77, v77
    v_exp_f32 v78, v78
    v_exp_f32 v79, v79
    v_cvt_pk_bf16_f32 v86, v76, v77
    v_cvt_pk_bf16_f32 v87, v78, v79
    v_exp_f32 v64, v64
    s_nop 0
    v_mfma_f32_16x16x32_bf16 v[224:227], a[176:179], v[84:87], v[224:227]
    ds_read_b64_tr_b16 a[164:165], v13 offset:16384
    v_mfma_f32_16x16x32_bf16 v[228:231], a[180:183], v[84:87], v[228:231]
    v_mfma_f32_16x16x32_bf16 v[232:235], a[184:187], v[84:87], v[232:235]
    ds_read_b64_tr_b16 a[166:167], v13 offset:20480
    v_mfma_f32_16x16x32_bf16 v[236:239], a[188:191], v[84:87], v[236:239]
    v_mfma_f32_16x16x32_bf16 v[240:243], a[192:195], v[84:87], v[240:243]
    ds_read_b64_tr_b16 a[168:169], v14 offset:16384
    v_mfma_f32_16x16x32_bf16 v[244:247], a[196:199], v[84:87], v[244:247]
    ds_read_b64_tr_b16 a[170:171], v14 offset:20480
    v_mfma_f32_16x16x32_bf16 v[248:251], a[200:203], v[84:87], v[248:251]
    v_mfma_f32_16x16x32_bf16 v[252:255], a[204:207], v[84:87], v[252:255]
    v_exp_f32 v65, v65
    v_exp_f32 v66, v66
    v_exp_f32 v67, v67
    v_exp_f32 v68, v68
    v_cvt_pk_bf16_f32 v80, v64, v65
    v_cvt_pk_bf16_f32 v81, v66, v67
    v_mfma_f32_16x16x32_bf16 v[60:63], a[228:231], v[84:87], v[60:63]
    ds_read_b64_tr_b16 a[172:173], v15 offset:16384
    v_mfma_f32_16x16x32_bf16 v[72:75], a[80:83], a[16:19], v[44:47]
    v_mfma_f32_16x16x32_bf16 v[72:75], a[84:87], a[20:23], v[72:75]
    ds_read_b64_tr_b16 a[174:175], v15 offset:20480
    v_mfma_f32_16x16x32_bf16 v[72:75], a[88:91], a[24:27], v[72:75]
    v_mfma_f32_16x16x32_bf16 v[72:75], a[92:95], a[28:31], v[72:75]
    v_mfma_f32_16x16x32_bf16 v[76:79], a[96:99], a[16:19], v[44:47]
    s_add_u32 s76, s93, 0
    v_mfma_f32_16x16x32_bf16 v[76:79], a[100:103], a[20:23], v[76:79]
    buffer_load_dwordx4 a[208:211], v90, s[32:35], s76 offen
    v_mfma_f32_16x16x32_bf16 v[76:79], a[104:107], a[24:27], v[76:79]
    v_mfma_f32_16x16x32_bf16 v[76:79], a[108:111], a[28:31], v[76:79]
    s_waitcnt lgkmcnt(0)
    v_exp_f32 v69, v69
    v_exp_f32 v70, v70
    v_exp_f32 v71, v71
    v_cvt_pk_bf16_f32 v82, v68, v69
    v_cvt_pk_bf16_f32 v83, v70, v71
    v_exp_f32 v72, v72
    v_subrev_u32 v8, 0x10000, v8
    v_subrev_u32 v9, 0x10000, v9
    v_subrev_u32 v10, 0x10000, v10
    v_subrev_u32 v11, 0x10000, v11
    v_subrev_u32 v12, 0x10000, v12
    v_subrev_u32 v13, 0x10000, v13
    v_subrev_u32 v14, 0x10000, v14
    v_subrev_u32 v15, 0x10000, v15
    v_mfma_f32_16x16x32_bf16 v[96:99], a[144:147], v[80:83], v[96:99]
    v_mfma_f32_16x16x32_bf16 v[100:103], a[148:151], v[80:83], v[100:103]
    v_mfma_f32_16x16x32_bf16 v[104:107], a[152:155], v[80:83], v[104:107]
    s_add_u32 s75, s100, 81920
    v_mfma_f32_16x16x32_bf16 v[108:111], a[156:159], v[80:83], v[108:111]
    s_and_b32 s75, s75, s79
    v_mfma_f32_16x16x32_bf16 v[112:115], a[160:163], v[80:83], v[112:115]
    s_add_u32 m0, s74, 81920
    v_mfma_f32_16x16x32_bf16 v[116:119], a[164:167], v[80:83], v[116:119]
    buffer_load_dwordx4 v18, s[84:87], s75 offen offset:0 nt lds
    v_mfma_f32_16x16x32_bf16 v[120:123], a[168:171], v[80:83], v[120:123]
    v_mfma_f32_16x16x32_bf16 v[124:127], a[172:175], v[80:83], v[124:127]
    v_exp_f32 v73, v73
    v_exp_f32 v74, v74
    v_exp_f32 v75, v75
    v_exp_f32 v76, v76
    v_cvt_pk_bf16_f32 v84, v72, v73
    v_cvt_pk_bf16_f32 v85, v74, v75
    v_mfma_f32_16x16x32_bf16 v[32:35], a[228:231], v[80:83], v[32:35]
    v_mfma_f32_16x16x32_bf16 v[64:67], a[80:83], a[32:35], v[48:51]
    v_mfma_f32_16x16x32_bf16 v[64:67], a[84:87], a[36:39], v[64:67]
    v_mfma_f32_16x16x32_bf16 v[64:67], a[88:91], a[40:43], v[64:67]
    v_mfma_f32_16x16x32_bf16 v[64:67], a[92:95], a[44:47], v[64:67]
    v_mfma_f32_16x16x32_bf16 v[68:71], a[96:99], a[32:35], v[48:51]
    buffer_load_dwordx4 v19, s[84:87], s75 offen offset:1024 nt lds
    v_mfma_f32_16x16x32_bf16 v[68:71], a[100:103], a[36:39], v[68:71]
    v_mfma_f32_16x16x32_bf16 v[68:71], a[104:107], a[40:43], v[68:71]
    v_mfma_f32_16x16x32_bf16 v[68:71], a[108:111], a[44:47], v[68:71]
    v_exp_f32 v77, v77
    v_exp_f32 v78, v78
    v_exp_f32 v79, v79
    v_cvt_pk_bf16_f32 v86, v76, v77
    v_cvt_pk_bf16_f32 v87, v78, v79
    v_exp_f32 v64, v64
    s_nop 0
    v_mfma_f32_16x16x32_bf16 v[128:131], a[144:147], v[84:87], v[128:131]
    v_mfma_f32_16x16x32_bf16 v[132:135], a[148:151], v[84:87], v[132:135]
    v_mfma_f32_16x16x32_bf16 v[136:139], a[152:155], v[84:87], v[136:139]
    v_mfma_f32_16x16x32_bf16 v[140:143], a[156:159], v[84:87], v[140:143]
    v_mfma_f32_16x16x32_bf16 v[144:147], a[160:163], v[84:87], v[144:147]
    v_mfma_f32_16x16x32_bf16 v[148:151], a[164:167], v[84:87], v[148:151]
    v_mfma_f32_16x16x32_bf16 v[152:155], a[168:171], v[84:87], v[152:155]
    v_mfma_f32_16x16x32_bf16 v[156:159], a[172:175], v[84:87], v[156:159]
    s_add_u32 s75, s101, 81920
    v_exp_f32 v65, v65
    v_exp_f32 v66, v66
    v_exp_f32 v67, v67
    v_exp_f32 v68, v68
    v_cvt_pk_bf16_f32 v80, v64, v65
    v_cvt_pk_bf16_f32 v81, v66, v67
    v_mfma_f32_16x16x32_bf16 v[20:23], a[228:231], v[84:87], v[20:23]
    s_waitcnt vmcnt(27) lgkmcnt(0)
    s_and_b32 s75, s75, s79
    v_mfma_f32_16x16x32_bf16 v[72:75], a[80:83], a[48:51], v[52:55]
    s_barrier
    s_add_u32 s75, s75, 131072
    v_mfma_f32_16x16x32_bf16 v[72:75], a[84:87], a[52:55], v[72:75]
    s_add_u32 m0, s74, 90112
    ds_read_b128 a[112:115], v4 offset:0
    v_mfma_f32_16x16x32_bf16 v[72:75], a[88:91], a[56:59], v[72:75]
    buffer_load_dwordx4 v18, s[84:87], s75 offen offset:0 nt lds
    v_mfma_f32_16x16x32_bf16 v[72:75], a[92:95], a[60:63], v[72:75]
    v_mfma_f32_16x16x32_bf16 v[76:79], a[96:99], a[48:51], v[52:55]
    ds_read_b128 a[116:119], v5 offset:0
    v_mfma_f32_16x16x32_bf16 v[76:79], a[100:103], a[52:55], v[76:79]
    v_mfma_f32_16x16x32_bf16 v[76:79], a[104:107], a[56:59], v[76:79]
    v_mfma_f32_16x16x32_bf16 v[76:79], a[108:111], a[60:63], v[76:79]
    v_exp_f32 v69, v69
    v_exp_f32 v70, v70
    v_exp_f32 v71, v71
    v_cvt_pk_bf16_f32 v82, v68, v69
    v_cvt_pk_bf16_f32 v83, v70, v71
    v_exp_f32 v72, v72
    s_nop 0
    v_mfma_f32_16x16x32_bf16 v[160:163], a[144:147], v[80:83], v[160:163]
    ds_read_b128 a[120:123], v6 offset:0
    v_mfma_f32_16x16x32_bf16 v[164:167], a[148:151], v[80:83], v[164:167]
    v_mfma_f32_16x16x32_bf16 v[168:171], a[152:155], v[80:83], v[168:171]
    buffer_load_dwordx4 v19, s[84:87], s75 offen offset:1024 nt lds
    v_mfma_f32_16x16x32_bf16 v[172:175], a[156:159], v[80:83], v[172:175]
    ds_read_b128 a[124:127], v7 offset:0
    v_mfma_f32_16x16x32_bf16 v[176:179], a[160:163], v[80:83], v[176:179]
    v_mfma_f32_16x16x32_bf16 v[180:183], a[164:167], v[80:83], v[180:183]
    s_add_u32 s76, s93, 1024
    v_mfma_f32_16x16x32_bf16 v[184:187], a[168:171], v[80:83], v[184:187]
    buffer_load_dwordx4 a[212:215], v90, s[32:35], s76 offen
    v_mfma_f32_16x16x32_bf16 v[188:191], a[172:175], v[80:83], v[188:191]
    v_exp_f32 v73, v73
    v_exp_f32 v74, v74
    v_exp_f32 v75, v75
    v_exp_f32 v76, v76
    v_cvt_pk_bf16_f32 v84, v72, v73
    v_cvt_pk_bf16_f32 v85, v74, v75
    v_mfma_f32_16x16x32_bf16 v[36:39], a[228:231], v[80:83], v[36:39]
    s_waitcnt vmcnt(26) lgkmcnt(0)
    ds_read_b128 a[128:131], v4 offset:4096
    v_mfma_f32_16x16x32_bf16 v[64:67], a[80:83], a[64:67], v[56:59]
    s_barrier
    v_mfma_f32_16x16x32_bf16 v[64:67], a[84:87], a[68:71], v[64:67]
    ds_read_b64_tr_b16 a[176:177], v8 offset:32768
    v_mfma_f32_16x16x32_bf16 v[64:67], a[88:91], a[72:75], v[64:67]
    ds_read_b128 a[132:135], v5 offset:4096
    v_mfma_f32_16x16x32_bf16 v[64:67], a[92:95], a[76:79], v[64:67]
    ds_read_b64_tr_b16 a[178:179], v8 offset:36864
    v_mfma_f32_16x16x32_bf16 v[68:71], a[96:99], a[64:67], v[56:59]
    ds_read_b128 a[136:139], v6 offset:4096
    v_mfma_f32_16x16x32_bf16 v[68:71], a[100:103], a[68:71], v[68:71]
    v_mfma_f32_16x16x32_bf16 v[68:71], a[104:107], a[72:75], v[68:71]
    ds_read_b64_tr_b16 a[180:181], v9 offset:32768
    v_mfma_f32_16x16x32_bf16 v[68:71], a[108:111], a[76:79], v[68:71]
    v_exp_f32 v77, v77
    v_exp_f32 v78, v78
    v_exp_f32 v79, v79
    v_cvt_pk_bf16_f32 v86, v76, v77
    v_cvt_pk_bf16_f32 v87, v78, v79
    v_exp_f32 v64, v64
    s_nop 0
    v_mfma_f32_16x16x32_bf16 v[192:195], a[144:147], v[84:87], v[192:195]
    ds_read_b128 a[140:143], v7 offset:4096
    v_mfma_f32_16x16x32_bf16 v[196:199], a[148:151], v[84:87], v[196:199]
    v_mfma_f32_16x16x32_bf16 v[200:203], a[152:155], v[84:87], v[200:203]
    ds_read_b64_tr_b16 a[182:183], v9 offset:36864
    v_mfma_f32_16x16x32_bf16 v[204:207], a[156:159], v[84:87], v[204:207]
    v_mfma_f32_16x16x32_bf16 v[208:211], a[160:163], v[84:87], v[208:211]
    ds_read_b64_tr_b16 a[184:185], v10 offset:32768
    v_mfma_f32_16x16x32_bf16 v[212:215], a[164:167], v[84:87], v[212:215]
    v_mfma_f32_16x16x32_bf16 v[216:219], a[168:171], v[84:87], v[216:219]
    ds_read_b64_tr_b16 a[186:187], v10 offset:36864
    v_mfma_f32_16x16x32_bf16 v[220:223], a[172:175], v[84:87], v[220:223]
    v_exp_f32 v65, v65
    v_exp_f32 v66, v66
    v_exp_f32 v67, v67
    v_exp_f32 v68, v68
    v_cvt_pk_bf16_f32 v80, v64, v65
    v_cvt_pk_bf16_f32 v81, v66, v67
    v_mfma_f32_16x16x32_bf16 v[24:27], a[228:231], v[84:87], v[24:27]
    s_waitcnt lgkmcnt(0)
    ds_read_b64_tr_b16 a[188:189], v11 offset:32768
    v_mfma_f32_16x16x32_bf16 v[72:75], a[112:115], a[0:3], v[40:43]
    v_mfma_f32_16x16x32_bf16 v[72:75], a[116:119], a[4:7], v[72:75]
    ds_read_b64_tr_b16 a[190:191], v11 offset:36864
    v_mfma_f32_16x16x32_bf16 v[72:75], a[120:123], a[8:11], v[72:75]
    v_mfma_f32_16x16x32_bf16 v[72:75], a[124:127], a[12:15], v[72:75]
    ds_read_b64_tr_b16 a[192:193], v12 offset:32768
    v_mfma_f32_16x16x32_bf16 v[76:79], a[128:131], a[0:3], v[40:43]
    v_mfma_f32_16x16x32_bf16 v[76:79], a[132:135], a[4:7], v[76:79]
    ds_read_b64_tr_b16 a[194:195], v12 offset:36864
    v_mfma_f32_16x16x32_bf16 v[76:79], a[136:139], a[8:11], v[76:79]
    v_mfma_f32_16x16x32_bf16 v[76:79], a[140:143], a[12:15], v[76:79]
    v_exp_f32 v69, v69
    v_exp_f32 v70, v70
    v_exp_f32 v71, v71
    v_cvt_pk_bf16_f32 v82, v68, v69
    v_cvt_pk_bf16_f32 v83, v70, v71
    v_exp_f32 v72, v72
    s_nop 0
    v_mfma_f32_16x16x32_bf16 v[224:227], a[144:147], v[80:83], v[224:227]
    ds_read_b64_tr_b16 a[196:197], v13 offset:32768
    v_mfma_f32_16x16x32_bf16 v[228:231], a[148:151], v[80:83], v[228:231]
    ds_read_b64_tr_b16 a[198:199], v13 offset:36864
    v_mfma_f32_16x16x32_bf16 v[232:235], a[152:155], v[80:83], v[232:235]
    v_mfma_f32_16x16x32_bf16 v[236:239], a[156:159], v[80:83], v[236:239]
    ds_read_b64_tr_b16 a[200:201], v14 offset:32768
    v_mfma_f32_16x16x32_bf16 v[240:243], a[160:163], v[80:83], v[240:243]
    v_mfma_f32_16x16x32_bf16 v[244:247], a[164:167], v[80:83], v[244:247]
    ds_read_b64_tr_b16 a[202:203], v14 offset:36864
    v_mfma_f32_16x16x32_bf16 v[248:251], a[168:171], v[80:83], v[248:251]
    v_mfma_f32_16x16x32_bf16 v[252:255], a[172:175], v[80:83], v[252:255]
    v_exp_f32 v73, v73
    v_exp_f32 v74, v74
    v_exp_f32 v75, v75
    v_exp_f32 v76, v76
    v_cvt_pk_bf16_f32 v84, v72, v73
    v_cvt_pk_bf16_f32 v85, v74, v75
    v_mfma_f32_16x16x32_bf16 v[60:63], a[228:231], v[80:83], v[60:63]
    ds_read_b64_tr_b16 a[204:205], v15 offset:32768
    v_mfma_f32_16x16x32_bf16 v[64:67], a[112:115], a[16:19], v[44:47]
    v_mfma_f32_16x16x32_bf16 v[64:67], a[116:119], a[20:23], v[64:67]
    ds_read_b64_tr_b16 a[206:207], v15 offset:36864
    v_mfma_f32_16x16x32_bf16 v[64:67], a[120:123], a[24:27], v[64:67]
    v_mfma_f32_16x16x32_bf16 v[64:67], a[124:127], a[28:31], v[64:67]
    v_mfma_f32_16x16x32_bf16 v[68:71], a[128:131], a[16:19], v[44:47]
    s_add_u32 s76, s93, 2048
    v_mfma_f32_16x16x32_bf16 v[68:71], a[132:135], a[20:23], v[68:71]
    buffer_load_dwordx4 a[216:219], v90, s[32:35], s76 offen
    v_mfma_f32_16x16x32_bf16 v[68:71], a[136:139], a[24:27], v[68:71]
    v_mfma_f32_16x16x32_bf16 v[68:71], a[140:143], a[28:31], v[68:71]
    s_waitcnt lgkmcnt(0)
    v_exp_f32 v77, v77
    v_exp_f32 v78, v78
    v_exp_f32 v79, v79
    v_cvt_pk_bf16_f32 v86, v76, v77
    v_cvt_pk_bf16_f32 v87, v78, v79
    v_exp_f32 v64, v64
    s_nop 0
    v_mfma_f32_16x16x32_bf16 v[96:99], a[176:179], v[84:87], v[96:99]
    v_mfma_f32_16x16x32_bf16 v[100:103], a[180:183], v[84:87], v[100:103]
    v_mfma_f32_16x16x32_bf16 v[104:107], a[184:187], v[84:87], v[104:107]
    v_mfma_f32_16x16x32_bf16 v[108:111], a[188:191], v[84:87], v[108:111]
    v_mfma_f32_16x16x32_bf16 v[112:115], a[192:195], v[84:87], v[112:115]
    v_mfma_f32_16x16x32_bf16 v[116:119], a[196:199], v[84:87], v[116:119]
    v_mfma_f32_16x16x32_bf16 v[120:123], a[200:203], v[84:87], v[120:123]
    v_mfma_f32_16x16x32_bf16 v[124:127], a[204:207], v[84:87], v[124:127]
    v_exp_f32 v65, v65
    v_exp_f32 v66, v66
    v_exp_f32 v67, v67
    v_exp_f32 v68, v68
    v_cvt_pk_bf16_f32 v80, v64, v65
    v_cvt_pk_bf16_f32 v81, v66, v67
    v_mfma_f32_16x16x32_bf16 v[32:35], a[228:231], v[84:87], v[32:35]
    v_mfma_f32_16x16x32_bf16 v[72:75], a[112:115], a[32:35], v[48:51]
    v_mfma_f32_16x16x32_bf16 v[72:75], a[116:119], a[36:39], v[72:75]
    v_mfma_f32_16x16x32_bf16 v[72:75], a[120:123], a[40:43], v[72:75]
    v_mfma_f32_16x16x32_bf16 v[72:75], a[124:127], a[44:47], v[72:75]
    v_mfma_f32_16x16x32_bf16 v[76:79], a[128:131], a[32:35], v[48:51]
    v_mfma_f32_16x16x32_bf16 v[76:79], a[132:135], a[36:39], v[76:79]
    v_mfma_f32_16x16x32_bf16 v[76:79], a[136:139], a[40:43], v[76:79]
    v_mfma_f32_16x16x32_bf16 v[76:79], a[140:143], a[44:47], v[76:79]
    v_exp_f32 v69, v69
    v_exp_f32 v70, v70
    v_exp_f32 v71, v71
    v_cvt_pk_bf16_f32 v82, v68, v69
    v_cvt_pk_bf16_f32 v83, v70, v71
    v_exp_f32 v72, v72
    s_nop 0
    v_mfma_f32_16x16x32_bf16 v[128:131], a[176:179], v[80:83], v[128:131]
    v_mfma_f32_16x16x32_bf16 v[132:135], a[180:183], v[80:83], v[132:135]
    v_mfma_f32_16x16x32_bf16 v[136:139], a[184:187], v[80:83], v[136:139]
    v_mfma_f32_16x16x32_bf16 v[140:143], a[188:191], v[80:83], v[140:143]
    v_mfma_f32_16x16x32_bf16 v[144:147], a[192:195], v[80:83], v[144:147]
    v_mfma_f32_16x16x32_bf16 v[148:151], a[196:199], v[80:83], v[148:151]
    v_mfma_f32_16x16x32_bf16 v[152:155], a[200:203], v[80:83], v[152:155]
    v_mfma_f32_16x16x32_bf16 v[156:159], a[204:207], v[80:83], v[156:159]
    s_add_u32 s75, s100, 90112
    v_exp_f32 v73, v73
    v_exp_f32 v74, v74
    v_exp_f32 v75, v75
    v_exp_f32 v76, v76
    v_cvt_pk_bf16_f32 v84, v72, v73
    v_cvt_pk_bf16_f32 v85, v74, v75
    v_mfma_f32_16x16x32_bf16 v[20:23], a[228:231], v[80:83], v[20:23]
    s_waitcnt vmcnt(23) lgkmcnt(0)
    s_and_b32 s75, s75, s79
    v_mfma_f32_16x16x32_bf16 v[64:67], a[112:115], a[48:51], v[52:55]
    s_barrier
    s_add_u32 m0, s74, 0
    v_mfma_f32_16x16x32_bf16 v[64:67], a[116:119], a[52:55], v[64:67]
    buffer_load_dwordx4 v16, s[80:83], s75 offen offset:0 nt lds
    v_mfma_f32_16x16x32_bf16 v[64:67], a[120:123], a[56:59], v[64:67]
    ds_read_b128 a[80:83], v4 offset:16384
    v_mfma_f32_16x16x32_bf16 v[64:67], a[124:127], a[60:63], v[64:67]
    v_mfma_f32_16x16x32_bf16 v[68:71], a[128:131], a[48:51], v[52:55]
    ds_read_b128 a[84:87], v5 offset:16384
    v_mfma_f32_16x16x32_bf16 v[68:71], a[132:135], a[52:55], v[68:71]
    v_mfma_f32_16x16x32_bf16 v[68:71], a[136:139], a[56:59], v[68:71]
    v_mfma_f32_16x16x32_bf16 v[68:71], a[140:143], a[60:63], v[68:71]
    v_exp_f32 v77, v77
    v_exp_f32 v78, v78
    v_exp_f32 v79, v79
    v_cvt_pk_bf16_f32 v86, v76, v77
    v_cvt_pk_bf16_f32 v87, v78, v79
    v_exp_f32 v64, v64
    s_nop 0
    v_mfma_f32_16x16x32_bf16 v[160:163], a[176:179], v[84:87], v[160:163]
    ds_read_b128 a[88:91], v6 offset:16384
    v_mfma_f32_16x16x32_bf16 v[164:167], a[180:183], v[84:87], v[164:167]
    buffer_load_dwordx4 v17, s[80:83], s75 offen offset:1024 nt lds
    v_mfma_f32_16x16x32_bf16 v[168:171], a[184:187], v[84:87], v[168:171]
    v_mfma_f32_16x16x32_bf16 v[172:175], a[188:191], v[84:87], v[172:175]
    ds_read_b128 a[92:95], v7 offset:16384
    v_mfma_f32_16x16x32_bf16 v[176:179], a[192:195], v[84:87], v[176:179]
    v_mfma_f32_16x16x32_bf16 v[180:183], a[196:199], v[84:87], v[180:183]
    s_add_u32 s75, s101, 90112
    v_mfma_f32_16x16x32_bf16 v[184:187], a[200:203], v[84:87], v[184:187]
    s_and_b32 s75, s75, s79
    ds_read_b128 a[96:99], v4 offset:20480
    v_mfma_f32_16x16x32_bf16 v[188:191], a[204:207], v[84:87], v[188:191]
    s_add_u32 s75, s75, 131072
    v_exp_f32 v65, v65
    v_exp_f32 v66, v66
    v_exp_f32 v67, v67
    v_exp_f32 v68, v68
    v_cvt_pk_bf16_f32 v80, v64, v65
    v_cvt_pk_bf16_f32 v81, v66, v67
    v_mfma_f32_16x16x32_bf16 v[36:39], a[228:231], v[84:87], v[36:39]
    s_waitcnt vmcnt(21) lgkmcnt(0)
    s_add_u32 m0, s74, 8192
    v_mfma_f32_16x16x32_bf16 v[72:75], a[112:115], a[64:67], v[56:59]
    s_barrier
    buffer_load_dwordx4 v16, s[80:83], s75 offen offset:0 nt lds
    v_mfma_f32_16x16x32_bf16 v[72:75], a[116:119], a[68:71], v[72:75]
    ds_read_b128 a[100:103], v5 offset:20480
    v_mfma_f32_16x16x32_bf16 v[72:75], a[120:123], a[72:75], v[72:75]
    ds_read_b64_tr_b16 a[144:145], v8 offset:49152
    v_mfma_f32_16x16x32_bf16 v[72:75], a[124:127], a[76:79], v[72:75]
    ds_read_b64_tr_b16 a[146:147], v8 offset:53248
    v_mfma_f32_16x16x32_bf16 v[76:79], a[128:131], a[64:67], v[56:59]
    ds_read_b128 a[104:107], v6 offset:20480
    v_mfma_f32_16x16x32_bf16 v[76:79], a[132:135], a[68:71], v[76:79]
    v_mfma_f32_16x16x32_bf16 v[76:79], a[136:139], a[72:75], v[76:79]
    ds_read_b128 a[108:111], v7 offset:20480
    v_mfma_f32_16x16x32_bf16 v[76:79], a[140:143], a[76:79], v[76:79]
    v_exp_f32 v69, v69
    v_exp_f32 v70, v70
    v_exp_f32 v71, v71
    v_cvt_pk_bf16_f32 v82, v68, v69
    v_cvt_pk_bf16_f32 v83, v70, v71
    v_exp_f32 v72, v72
    s_nop 0
    v_mfma_f32_16x16x32_bf16 v[192:195], a[176:179], v[80:83], v[192:195]
    buffer_load_dwordx4 v17, s[80:83], s75 offen offset:1024 nt lds
    v_mfma_f32_16x16x32_bf16 v[196:199], a[180:183], v[80:83], v[196:199]
    ds_read_b64_tr_b16 a[148:149], v9 offset:49152
    v_mfma_f32_16x16x32_bf16 v[200:203], a[184:187], v[80:83], v[200:203]
    ds_read_b64_tr_b16 a[150:151], v9 offset:53248
    v_mfma_f32_16x16x32_bf16 v[204:207], a[188:191], v[80:83], v[204:207]
    v_mfma_f32_16x16x32_bf16 v[208:211], a[192:195], v[80:83], v[208:211]
    ds_read_b64_tr_b16 a[152:153], v10 offset:49152
    v_mfma_f32_16x16x32_bf16 v[212:215], a[196:199], v[80:83], v[212:215]
    s_add_u32 s75, s100, 90112
    ds_read_b64_tr_b16 a[154:155], v10 offset:53248
    v_mfma_f32_16x16x32_bf16 v[216:219], a[200:203], v[80:83], v[216:219]
    s_and_b32 s75, s75, s79
    v_mfma_f32_16x16x32_bf16 v[220:223], a[204:207], v[80:83], v[220:223]
    s_add_u32 m0, s74, 98304
    v_exp_f32 v73, v73
    v_exp_f32 v74, v74
    v_exp_f32 v75, v75
    v_exp_f32 v76, v76
    v_cvt_pk_bf16_f32 v84, v72, v73
    v_cvt_pk_bf16_f32 v85, v74, v75
    v_mfma_f32_16x16x32_bf16 v[24:27], a[228:231], v[80:83], v[24:27]
    s_waitcnt lgkmcnt(0)
    buffer_load_dwordx4 v18, s[84:87], s75 offen offset:0 nt lds
    v_mfma_f32_16x16x32_bf16 v[64:67], a[80:83], a[0:3], v[40:43]
    ds_read_b64_tr_b16 a[156:157], v11 offset:49152
    v_mfma_f32_16x16x32_bf16 v[64:67], a[84:87], a[4:7], v[64:67]
    ds_read_b64_tr_b16 a[158:159], v11 offset:53248
    v_mfma_f32_16x16x32_bf16 v[64:67], a[88:91], a[8:11], v[64:67]
    v_mfma_f32_16x16x32_bf16 v[64:67], a[92:95], a[12:15], v[64:67]
    ds_read_b64_tr_b16 a[160:161], v12 offset:49152
    v_mfma_f32_16x16x32_bf16 v[68:71], a[96:99], a[0:3], v[40:43]
    v_mfma_f32_16x16x32_bf16 v[68:71], a[100:103], a[4:7], v[68:71]
    ds_read_b64_tr_b16 a[162:163], v12 offset:53248
    v_mfma_f32_16x16x32_bf16 v[68:71], a[104:107], a[8:11], v[68:71]
    ds_read_b64_tr_b16 a[164:165], v13 offset:49152
    v_mfma_f32_16x16x32_bf16 v[68:71], a[108:111], a[12:15], v[68:71]
    v_exp_f32 v77, v77
    v_exp_f32 v78, v78
    v_exp_f32 v79, v79
    v_cvt_pk_bf16_f32 v86, v76, v77
    v_cvt_pk_bf16_f32 v87, v78, v79
    v_exp_f32 v64, v64
    s_nop 0
    v_mfma_f32_16x16x32_bf16 v[224:227], a[176:179], v[84:87], v[224:227]
    buffer_load_dwordx4 v19, s[84:87], s75 offen offset:1024 nt lds
    v_mfma_f32_16x16x32_bf16 v[228:231], a[180:183], v[84:87], v[228:231]
    v_mfma_f32_16x16x32_bf16 v[232:235], a[184:187], v[84:87], v[232:235]
    ds_read_b64_tr_b16 a[166:167], v13 offset:53248
    v_mfma_f32_16x16x32_bf16 v[236:239], a[188:191], v[84:87], v[236:239]
    s_add_u32 s76, s93, 3072
    ds_read_b64_tr_b16 a[168:169], v14 offset:49152
    v_mfma_f32_16x16x32_bf16 v[240:243], a[192:195], v[84:87], v[240:243]
    buffer_load_dwordx4 a[220:223], v90, s[32:35], s76 offen
    v_mfma_f32_16x16x32_bf16 v[244:247], a[196:199], v[84:87], v[244:247]
    v_mfma_f32_16x16x32_bf16 v[248:251], a[200:203], v[84:87], v[248:251]
    ds_read_b64_tr_b16 a[170:171], v14 offset:53248
    v_mfma_f32_16x16x32_bf16 v[252:255], a[204:207], v[84:87], v[252:255]
    v_exp_f32 v65, v65
    v_exp_f32 v66, v66
    v_exp_f32 v67, v67
    v_exp_f32 v68, v68
    v_cvt_pk_bf16_f32 v80, v64, v65
    v_cvt_pk_bf16_f32 v81, v66, v67
    v_mfma_f32_16x16x32_bf16 v[60:63], a[228:231], v[84:87], v[60:63]
    s_add_u32 s75, s101, 90112
    ds_read_b64_tr_b16 a[172:173], v15 offset:49152
    v_mfma_f32_16x16x32_bf16 v[72:75], a[80:83], a[16:19], v[44:47]
    s_and_b32 s75, s75, s79
    v_mfma_f32_16x16x32_bf16 v[72:75], a[84:87], a[20:23], v[72:75]
    s_add_u32 s75, s75, 131072
    ds_read_b64_tr_b16 a[174:175], v15 offset:53248
    v_mfma_f32_16x16x32_bf16 v[72:75], a[88:91], a[24:27], v[72:75]
    s_add_u32 m0, s74, 106496
    v_mfma_f32_16x16x32_bf16 v[72:75], a[92:95], a[28:31], v[72:75]
    buffer_load_dwordx4 v18, s[84:87], s75 offen offset:0 nt lds
    v_mfma_f32_16x16x32_bf16 v[76:79], a[96:99], a[16:19], v[44:47]
    v_mfma_f32_16x16x32_bf16 v[76:79], a[100:103], a[20:23], v[76:79]
    v_mfma_f32_16x16x32_bf16 v[76:79], a[104:107], a[24:27], v[76:79]
    v_mfma_f32_16x16x32_bf16 v[76:79], a[108:111], a[28:31], v[76:79]
    s_waitcnt lgkmcnt(0)
    v_exp_f32 v69, v69
    v_exp_f32 v70, v70
    v_exp_f32 v71, v71
    v_cvt_pk_bf16_f32 v82, v68, v69
    v_cvt_pk_bf16_f32 v83, v70, v71
    v_exp_f32 v72, v72
    s_nop 0
    v_mfma_f32_16x16x32_bf16 v[96:99], a[144:147], v[80:83], v[96:99]
    v_mfma_f32_16x16x32_bf16 v[100:103], a[148:151], v[80:83], v[100:103]
    v_mfma_f32_16x16x32_bf16 v[104:107], a[152:155], v[80:83], v[104:107]
    v_mfma_f32_16x16x32_bf16 v[108:111], a[156:159], v[80:83], v[108:111]
    buffer_load_dwordx4 v19, s[84:87], s75 offen offset:1024 nt lds
    v_mfma_f32_16x16x32_bf16 v[112:115], a[160:163], v[80:83], v[112:115]
    v_mfma_f32_16x16x32_bf16 v[116:119], a[164:167], v[80:83], v[116:119]
    v_mfma_f32_16x16x32_bf16 v[120:123], a[168:171], v[80:83], v[120:123]
    v_mfma_f32_16x16x32_bf16 v[124:127], a[172:175], v[80:83], v[124:127]
    s_add_u32 s76, s93, 4096
    v_exp_f32 v73, v73
    v_exp_f32 v74, v74
    v_exp_f32 v75, v75
    v_exp_f32 v76, v76
    v_cvt_pk_bf16_f32 v84, v72, v73
    v_cvt_pk_bf16_f32 v85, v74, v75
    v_mfma_f32_16x16x32_bf16 v[32:35], a[228:231], v[80:83], v[32:35]
    buffer_load_dwordx4 a[208:211], v90, s[32:35], s76 offen
    v_mfma_f32_16x16x32_bf16 v[64:67], a[80:83], a[32:35], v[48:51]
    v_mfma_f32_16x16x32_bf16 v[64:67], a[84:87], a[36:39], v[64:67]
    v_mfma_f32_16x16x32_bf16 v[64:67], a[88:91], a[40:43], v[64:67]
    v_mfma_f32_16x16x32_bf16 v[64:67], a[92:95], a[44:47], v[64:67]
    v_mfma_f32_16x16x32_bf16 v[68:71], a[96:99], a[32:35], v[48:51]
    v_mfma_f32_16x16x32_bf16 v[68:71], a[100:103], a[36:39], v[68:71]
    v_mfma_f32_16x16x32_bf16 v[68:71], a[104:107], a[40:43], v[68:71]
    v_mfma_f32_16x16x32_bf16 v[68:71], a[108:111], a[44:47], v[68:71]
    v_exp_f32 v77, v77
    v_exp_f32 v78, v78
    v_exp_f32 v79, v79
    v_cvt_pk_bf16_f32 v86, v76, v77
    v_cvt_pk_bf16_f32 v87, v78, v79
    v_exp_f32 v64, v64
    s_nop 0
    v_mfma_f32_16x16x32_bf16 v[128:131], a[144:147], v[84:87], v[128:131]
    v_mfma_f32_16x16x32_bf16 v[132:135], a[148:151], v[84:87], v[132:135]
    v_mfma_f32_16x16x32_bf16 v[136:139], a[152:155], v[84:87], v[136:139]
    v_mfma_f32_16x16x32_bf16 v[140:143], a[156:159], v[84:87], v[140:143]
    v_mfma_f32_16x16x32_bf16 v[144:147], a[160:163], v[84:87], v[144:147]
    v_mfma_f32_16x16x32_bf16 v[148:151], a[164:167], v[84:87], v[148:151]
    v_mfma_f32_16x16x32_bf16 v[152:155], a[168:171], v[84:87], v[152:155]
    v_mfma_f32_16x16x32_bf16 v[156:159], a[172:175], v[84:87], v[156:159]
    s_add_u32 s75, s100, 98304
    v_exp_f32 v65, v65
    v_exp_f32 v66, v66
    v_exp_f32 v67, v67
    v_exp_f32 v68, v68
    v_cvt_pk_bf16_f32 v80, v64, v65
    v_cvt_pk_bf16_f32 v81, v66, v67
    v_mfma_f32_16x16x32_bf16 v[20:23], a[228:231], v[84:87], v[20:23]
    s_waitcnt vmcnt(25) lgkmcnt(0)
    s_and_b32 s75, s75, s79
    v_mfma_f32_16x16x32_bf16 v[72:75], a[80:83], a[48:51], v[52:55]
    s_barrier
    s_add_u32 m0, s74, 16384
    v_mfma_f32_16x16x32_bf16 v[72:75], a[84:87], a[52:55], v[72:75]
    buffer_load_dwordx4 v16, s[80:83], s75 offen offset:0 nt lds
    v_mfma_f32_16x16x32_bf16 v[72:75], a[88:91], a[56:59], v[72:75]
    ds_read_b128 a[112:115], v4 offset:32768
    v_mfma_f32_16x16x32_bf16 v[72:75], a[92:95], a[60:63], v[72:75]
    v_mfma_f32_16x16x32_bf16 v[76:79], a[96:99], a[48:51], v[52:55]
    ds_read_b128 a[116:119], v5 offset:32768
    v_mfma_f32_16x16x32_bf16 v[76:79], a[100:103], a[52:55], v[76:79]
    v_mfma_f32_16x16x32_bf16 v[76:79], a[104:107], a[56:59], v[76:79]
    v_mfma_f32_16x16x32_bf16 v[76:79], a[108:111], a[60:63], v[76:79]
    v_exp_f32 v69, v69
    v_exp_f32 v70, v70
    v_exp_f32 v71, v71
    v_cvt_pk_bf16_f32 v82, v68, v69
    v_cvt_pk_bf16_f32 v83, v70, v71
    v_exp_f32 v72, v72
    s_nop 0
    v_mfma_f32_16x16x32_bf16 v[160:163], a[144:147], v[80:83], v[160:163]
    ds_read_b128 a[120:123], v6 offset:32768
    v_mfma_f32_16x16x32_bf16 v[164:167], a[148:151], v[80:83], v[164:167]
    buffer_load_dwordx4 v17, s[80:83], s75 offen offset:1024 nt lds
    v_mfma_f32_16x16x32_bf16 v[168:171], a[152:155], v[80:83], v[168:171]
    v_mfma_f32_16x16x32_bf16 v[172:175], a[156:159], v[80:83], v[172:175]
    ds_read_b128 a[124:127], v7 offset:32768
    v_mfma_f32_16x16x32_bf16 v[176:179], a[160:163], v[80:83], v[176:179]
    v_mfma_f32_16x16x32_bf16 v[180:183], a[164:167], v[80:83], v[180:183]
    s_add_u32 s75, s101, 98304
    v_mfma_f32_16x16x32_bf16 v[184:187], a[168:171], v[80:83], v[184:187]
    s_and_b32 s75, s75, s79
    ds_read_b128 a[128:131], v4 offset:36864
    v_mfma_f32_16x16x32_bf16 v[188:191], a[172:175], v[80:83], v[188:191]
    s_add_u32 s75, s75, 131072
    v_exp_f32 v73, v73
    v_exp_f32 v74, v74
    v_exp_f32 v75, v75
    v_exp_f32 v76, v76
    v_cvt_pk_bf16_f32 v84, v72, v73
    v_cvt_pk_bf16_f32 v85, v74, v75
    v_mfma_f32_16x16x32_bf16 v[36:39], a[228:231], v[80:83], v[36:39]
    s_waitcnt vmcnt(23) lgkmcnt(0)
    s_add_u32 m0, s74, 24576
    v_mfma_f32_16x16x32_bf16 v[64:67], a[80:83], a[64:67], v[56:59]
    s_barrier
    buffer_load_dwordx4 v16, s[80:83], s75 offen offset:0 nt lds
    v_mfma_f32_16x16x32_bf16 v[64:67], a[84:87], a[68:71], v[64:67]
    ds_read_b128 a[132:135], v5 offset:36864
    v_mfma_f32_16x16x32_bf16 v[64:67], a[88:91], a[72:75], v[64:67]
    ds_read_b64_tr_b16 a[176:177], v8 offset:0
    v_mfma_f32_16x16x32_bf16 v[64:67], a[92:95], a[76:79], v[64:67]
    ds_read_b64_tr_b16 a[178:179], v8 offset:4096
    v_mfma_f32_16x16x32_bf16 v[68:71], a[96:99], a[64:67], v[56:59]
    ds_read_b128 a[136:139], v6 offset:36864
    v_mfma_f32_16x16x32_bf16 v[68:71], a[100:103], a[68:71], v[68:71]
    v_mfma_f32_16x16x32_bf16 v[68:71], a[104:107], a[72:75], v[68:71]
    ds_read_b128 a[140:143], v7 offset:36864
    v_mfma_f32_16x16x32_bf16 v[68:71], a[108:111], a[76:79], v[68:71]
    v_exp_f32 v77, v77
    v_exp_f32 v78, v78
    v_exp_f32 v79, v79
    v_cvt_pk_bf16_f32 v86, v76, v77
    v_cvt_pk_bf16_f32 v87, v78, v79
    v_exp_f32 v64, v64
    s_nop 0
    v_mfma_f32_16x16x32_bf16 v[192:195], a[144:147], v[84:87], v[192:195]
    buffer_load_dwordx4 v17, s[80:83], s75 offen offset:1024 nt lds
    v_mfma_f32_16x16x32_bf16 v[196:199], a[148:151], v[84:87], v[196:199]
    ds_read_b64_tr_b16 a[180:181], v9 offset:0
    v_mfma_f32_16x16x32_bf16 v[200:203], a[152:155], v[84:87], v[200:203]
    ds_read_b64_tr_b16 a[182:183], v9 offset:4096
    v_mfma_f32_16x16x32_bf16 v[204:207], a[156:159], v[84:87], v[204:207]
    s_add_u32 s76, s93, 5120
    v_mfma_f32_16x16x32_bf16 v[208:211], a[160:163], v[84:87], v[208:211]
    buffer_load_dwordx4 a[212:215], v90, s[32:35], s76 offen
    v_mfma_f32_16x16x32_bf16 v[212:215], a[164:167], v[84:87], v[212:215]
    ds_read_b64_tr_b16 a[184:185], v10 offset:0
    v_mfma_f32_16x16x32_bf16 v[216:219], a[168:171], v[84:87], v[216:219]
    ds_read_b64_tr_b16 a[186:187], v10 offset:4096
    v_mfma_f32_16x16x32_bf16 v[220:223], a[172:175], v[84:87], v[220:223]
    v_exp_f32 v65, v65
    v_exp_f32 v66, v66
    v_exp_f32 v67, v67
    v_exp_f32 v68, v68
    v_cvt_pk_bf16_f32 v80, v64, v65
    v_cvt_pk_bf16_f32 v81, v66, v67
    v_mfma_f32_16x16x32_bf16 v[24:27], a[228:231], v[84:87], v[24:27]
    s_waitcnt lgkmcnt(0)
    v_mfma_f32_16x16x32_bf16 v[72:75], a[112:115], a[0:3], v[40:43]
    s_add_u32 s75, s100, 98304
    ds_read_b64_tr_b16 a[188:189], v11 offset:0
    v_mfma_f32_16x16x32_bf16 v[72:75], a[116:119], a[4:7], v[72:75]
    s_and_b32 s75, s75, s79
    ds_read_b64_tr_b16 a[190:191], v11 offset:4096
    v_mfma_f32_16x16x32_bf16 v[72:75], a[120:123], a[8:11], v[72:75]
    s_add_u32 m0, s74, 114688
    v_mfma_f32_16x16x32_bf16 v[72:75], a[124:127], a[12:15], v[72:75]
    buffer_load_dwordx4 v18, s[84:87], s75 offen offset:0 nt lds
    v_mfma_f32_16x16x32_bf16 v[76:79], a[128:131], a[0:3], v[40:43]
    ds_read_b64_tr_b16 a[192:193], v12 offset:0
    v_mfma_f32_16x16x32_bf16 v[76:79], a[132:135], a[4:7], v[76:79]
    v_mfma_f32_16x16x32_bf16 v[76:79], a[136:139], a[8:11], v[76:79]
    ds_read_b64_tr_b16 a[194:195], v12 offset:4096
    v_mfma_f32_16x16x32_bf16 v[76:79], a[140:143], a[12:15], v[76:79]
    v_exp_f32 v69, v69
    v_exp_f32 v70, v70
    v_exp_f32 v71, v71
    v_cvt_pk_bf16_f32 v82, v68, v69
    v_cvt_pk_bf16_f32 v83, v70, v71
    v_exp_f32 v72, v72
    s_nop 0
    v_mfma_f32_16x16x32_bf16 v[224:227], a[144:147], v[80:83], v[224:227]
    ds_read_b64_tr_b16 a[196:197], v13 offset:0
    v_mfma_f32_16x16x32_bf16 v[228:231], a[148:151], v[80:83], v[228:231]
    v_mfma_f32_16x16x32_bf16 v[232:235], a[152:155], v[80:83], v[232:235]
    ds_read_b64_tr_b16 a[198:199], v13 offset:4096
    v_mfma_f32_16x16x32_bf16 v[236:239], a[156:159], v[80:83], v[236:239]
    buffer_load_dwordx4 v19, s[84:87], s75 offen offset:1024 nt lds
    v_mfma_f32_16x16x32_bf16 v[240:243], a[160:163], v[80:83], v[240:243]
    ds_read_b64_tr_b16 a[200:201], v14 offset:0
    v_mfma_f32_16x16x32_bf16 v[244:247], a[164:167], v[80:83], v[244:247]
    v_mfma_f32_16x16x32_bf16 v[248:251], a[168:171], v[80:83], v[248:251]
    ds_read_b64_tr_b16 a[202:203], v14 offset:4096
    v_mfma_f32_16x16x32_bf16 v[252:255], a[172:175], v[80:83], v[252:255]
    v_exp_f32 v73, v73
    v_exp_f32 v74, v74
    v_exp_f32 v75, v75
    v_exp_f32 v76, v76
    v_cvt_pk_bf16_f32 v84, v72, v73
    v_cvt_pk_bf16_f32 v85, v74, v75
    v_mfma_f32_16x16x32_bf16 v[60:63], a[228:231], v[80:83], v[60:63]
    ds_read_b64_tr_b16 a[204:205], v15 offset:0
    v_mfma_f32_16x16x32_bf16 v[64:67], a[112:115], a[16:19], v[44:47]
    v_mfma_f32_16x16x32_bf16 v[64:67], a[116:119], a[20:23], v[64:67]
    ds_read_b64_tr_b16 a[206:207], v15 offset:4096
    v_mfma_f32_16x16x32_bf16 v[64:67], a[120:123], a[24:27], v[64:67]
    v_mfma_f32_16x16x32_bf16 v[64:67], a[124:127], a[28:31], v[64:67]
    v_mfma_f32_16x16x32_bf16 v[68:71], a[128:131], a[16:19], v[44:47]
    s_add_u32 s76, s93, 6144
    v_mfma_f32_16x16x32_bf16 v[68:71], a[132:135], a[20:23], v[68:71]
    buffer_load_dwordx4 a[216:219], v90, s[32:35], s76 offen
    v_mfma_f32_16x16x32_bf16 v[68:71], a[136:139], a[24:27], v[68:71]
    v_mfma_f32_16x16x32_bf16 v[68:71], a[140:143], a[28:31], v[68:71]
    s_waitcnt lgkmcnt(0)
    v_exp_f32 v77, v77
    v_exp_f32 v78, v78
    v_exp_f32 v79, v79
    v_cvt_pk_bf16_f32 v86, v76, v77
    v_cvt_pk_bf16_f32 v87, v78, v79
    v_exp_f32 v64, v64
    s_nop 0
    v_mfma_f32_16x16x32_bf16 v[96:99], a[176:179], v[84:87], v[96:99]
    v_mfma_f32_16x16x32_bf16 v[100:103], a[180:183], v[84:87], v[100:103]
    s_add_u32 s75, s101, 98304
    v_mfma_f32_16x16x32_bf16 v[104:107], a[184:187], v[84:87], v[104:107]
    s_and_b32 s75, s75, s79
    v_mfma_f32_16x16x32_bf16 v[108:111], a[188:191], v[84:87], v[108:111]
    s_add_u32 s75, s75, 131072
    v_mfma_f32_16x16x32_bf16 v[112:115], a[192:195], v[84:87], v[112:115]
    s_add_u32 m0, s74, 122880
    v_mfma_f32_16x16x32_bf16 v[116:119], a[196:199], v[84:87], v[116:119]
    buffer_load_dwordx4 v18, s[84:87], s75 offen offset:0 nt lds
    v_mfma_f32_16x16x32_bf16 v[120:123], a[200:203], v[84:87], v[120:123]
    v_mfma_f32_16x16x32_bf16 v[124:127], a[204:207], v[84:87], v[124:127]
    v_exp_f32 v65, v65
    v_exp_f32 v66, v66
    v_exp_f32 v67, v67
    v_exp_f32 v68, v68
    v_cvt_pk_bf16_f32 v80, v64, v65
    v_cvt_pk_bf16_f32 v81, v66, v67
    v_mfma_f32_16x16x32_bf16 v[32:35], a[228:231], v[84:87], v[32:35]
    v_mfma_f32_16x16x32_bf16 v[72:75], a[112:115], a[32:35], v[48:51]
    v_mfma_f32_16x16x32_bf16 v[72:75], a[116:119], a[36:39], v[72:75]
    v_mfma_f32_16x16x32_bf16 v[72:75], a[120:123], a[40:43], v[72:75]
    v_mfma_f32_16x16x32_bf16 v[72:75], a[124:127], a[44:47], v[72:75]
    v_mfma_f32_16x16x32_bf16 v[76:79], a[128:131], a[32:35], v[48:51]
    buffer_load_dwordx4 v19, s[84:87], s75 offen offset:1024 nt lds
    v_mfma_f32_16x16x32_bf16 v[76:79], a[132:135], a[36:39], v[76:79]
    v_mfma_f32_16x16x32_bf16 v[76:79], a[136:139], a[40:43], v[76:79]
    v_mfma_f32_16x16x32_bf16 v[76:79], a[140:143], a[44:47], v[76:79]
    v_exp_f32 v69, v69
    v_exp_f32 v70, v70
    v_exp_f32 v71, v71
    v_cvt_pk_bf16_f32 v82, v68, v69
    v_cvt_pk_bf16_f32 v83, v70, v71
    v_exp_f32 v72, v72
    s_nop 0
    v_mfma_f32_16x16x32_bf16 v[128:131], a[176:179], v[80:83], v[128:131]
    v_mfma_f32_16x16x32_bf16 v[132:135], a[180:183], v[80:83], v[132:135]
    v_mfma_f32_16x16x32_bf16 v[136:139], a[184:187], v[80:83], v[136:139]
    v_mfma_f32_16x16x32_bf16 v[140:143], a[188:191], v[80:83], v[140:143]
    v_mfma_f32_16x16x32_bf16 v[144:147], a[192:195], v[80:83], v[144:147]
    v_mfma_f32_16x16x32_bf16 v[148:151], a[196:199], v[80:83], v[148:151]
    v_mfma_f32_16x16x32_bf16 v[152:155], a[200:203], v[80:83], v[152:155]
    v_mfma_f32_16x16x32_bf16 v[156:159], a[204:207], v[80:83], v[156:159]
    v_exp_f32 v73, v73
    v_exp_f32 v74, v74
    v_exp_f32 v75, v75
    v_exp_f32 v76, v76
    v_cvt_pk_bf16_f32 v84, v72, v73
    v_cvt_pk_bf16_f32 v85, v74, v75
    v_mfma_f32_16x16x32_bf16 v[20:23], a[228:231], v[80:83], v[20:23]
    s_waitcnt vmcnt(27) lgkmcnt(0)
    v_mfma_f32_16x16x32_bf16 v[64:67], a[112:115], a[48:51], v[52:55]
    s_barrier
    v_mfma_f32_16x16x32_bf16 v[64:67], a[116:119], a[52:55], v[64:67]
    ds_read_b128 a[80:83], v4 offset:49152
    v_mfma_f32_16x16x32_bf16 v[64:67], a[120:123], a[56:59], v[64:67]
    v_mfma_f32_16x16x32_bf16 v[64:67], a[124:127], a[60:63], v[64:67]
    ds_read_b128 a[84:87], v5 offset:49152
    v_mfma_f32_16x16x32_bf16 v[68:71], a[128:131], a[48:51], v[52:55]
    s_add_u32 s76, s93, 7168
    v_mfma_f32_16x16x32_bf16 v[68:71], a[132:135], a[52:55], v[68:71]
    buffer_load_dwordx4 a[220:223], v90, s[32:35], s76 offen
    v_mfma_f32_16x16x32_bf16 v[68:71], a[136:139], a[56:59], v[68:71]
    v_mfma_f32_16x16x32_bf16 v[68:71], a[140:143], a[60:63], v[68:71]
    v_exp_f32 v77, v77
    v_exp_f32 v78, v78
    v_exp_f32 v79, v79
    v_cvt_pk_bf16_f32 v86, v76, v77
    v_cvt_pk_bf16_f32 v87, v78, v79
    v_exp_f32 v64, v64
    s_nop 0
    v_mfma_f32_16x16x32_bf16 v[160:163], a[176:179], v[84:87], v[160:163]
    ds_read_b128 a[88:91], v6 offset:49152
    v_mfma_f32_16x16x32_bf16 v[164:167], a[180:183], v[84:87], v[164:167]
    v_mfma_f32_16x16x32_bf16 v[168:171], a[184:187], v[84:87], v[168:171]
    s_add_u32 s75, s100, 106496
    ds_read_b128 a[92:95], v7 offset:49152
    v_mfma_f32_16x16x32_bf16 v[172:175], a[188:191], v[84:87], v[172:175]
    s_and_b32 s75, s75, s79
    v_mfma_f32_16x16x32_bf16 v[176:179], a[192:195], v[84:87], v[176:179]
    s_add_u32 m0, s74, 32768
    v_mfma_f32_16x16x32_bf16 v[180:183], a[196:199], v[84:87], v[180:183]
    buffer_load_dwordx4 v16, s[80:83], s75 offen offset:0 nt lds
    v_mfma_f32_16x16x32_bf16 v[184:187], a[200:203], v[84:87], v[184:187]
    ds_read_b128 a[96:99], v4 offset:53248
    v_mfma_f32_16x16x32_bf16 v[188:191], a[204:207], v[84:87], v[188:191]
    v_exp_f32 v65, v65
    v_exp_f32 v66, v66
    v_exp_f32 v67, v67
    v_exp_f32 v68, v68
    v_cvt_pk_bf16_f32 v80, v64, v65
    v_cvt_pk_bf16_f32 v81, v66, v67
    v_mfma_f32_16x16x32_bf16 v[36:39], a[228:231], v[84:87], v[36:39]
    s_waitcnt vmcnt(24) lgkmcnt(0)
    v_mfma_f32_16x16x32_bf16 v[72:75], a[112:115], a[64:67], v[56:59]
    s_barrier
    v_mfma_f32_16x16x32_bf16 v[72:75], a[116:119], a[68:71], v[72:75]
    ds_read_b128 a[100:103], v5 offset:53248
    v_mfma_f32_16x16x32_bf16 v[72:75], a[120:123], a[72:75], v[72:75]
    ds_read_b64_tr_b16 a[144:145], v8 offset:16384
    v_mfma_f32_16x16x32_bf16 v[72:75], a[124:127], a[76:79], v[72:75]
    ds_read_b128 a[104:107], v6 offset:53248
    v_mfma_f32_16x16x32_bf16 v[76:79], a[128:131], a[64:67], v[56:59]
    buffer_load_dwordx4 v17, s[80:83], s75 offen offset:1024 nt lds
    v_mfma_f32_16x16x32_bf16 v[76:79], a[132:135], a[68:71], v[76:79]
    ds_read_b64_tr_b16 a[146:147], v8 offset:20480
    v_mfma_f32_16x16x32_bf16 v[76:79], a[136:139], a[72:75], v[76:79]
    v_mfma_f32_16x16x32_bf16 v[76:79], a[140:143], a[76:79], v[76:79]
    v_exp_f32 v69, v69
    v_exp_f32 v70, v70
    v_exp_f32 v71, v71
    v_cvt_pk_bf16_f32 v82, v68, v69
    v_cvt_pk_bf16_f32 v83, v70, v71
    v_exp_f32 v72, v72
    s_nop 0
    v_mfma_f32_16x16x32_bf16 v[192:195], a[176:179], v[80:83], v[192:195]
    ds_read_b128 a[108:111], v7 offset:53248
    v_mfma_f32_16x16x32_bf16 v[196:199], a[180:183], v[80:83], v[196:199]
    ds_read_b64_tr_b16 a[148:149], v9 offset:16384
    v_mfma_f32_16x16x32_bf16 v[200:203], a[184:187], v[80:83], v[200:203]
    ds_read_b64_tr_b16 a[150:151], v9 offset:20480
    v_mfma_f32_16x16x32_bf16 v[204:207], a[188:191], v[80:83], v[204:207]
    v_mfma_f32_16x16x32_bf16 v[208:211], a[192:195], v[80:83], v[208:211]
    ds_read_b64_tr_b16 a[152:153], v10 offset:16384
    v_mfma_f32_16x16x32_bf16 v[212:215], a[196:199], v[80:83], v[212:215]
    v_mfma_f32_16x16x32_bf16 v[216:219], a[200:203], v[80:83], v[216:219]
    s_add_u32 s75, s101, 106496
    ds_read_b64_tr_b16 a[154:155], v10 offset:20480
    v_mfma_f32_16x16x32_bf16 v[220:223], a[204:207], v[80:83], v[220:223]
    s_and_b32 s75, s75, s79
    v_exp_f32 v73, v73
    v_exp_f32 v74, v74
    v_exp_f32 v75, v75
    v_exp_f32 v76, v76
    v_cvt_pk_bf16_f32 v84, v72, v73
    v_cvt_pk_bf16_f32 v85, v74, v75
    v_mfma_f32_16x16x32_bf16 v[24:27], a[228:231], v[80:83], v[24:27]
    s_add_u32 s75, s75, 131072
    s_waitcnt lgkmcnt(0)
    ds_read_b64_tr_b16 a[156:157], v11 offset:16384
    v_mfma_f32_16x16x32_bf16 v[64:67], a[80:83], a[0:3], v[40:43]
    s_add_u32 m0, s74, 40960
    v_mfma_f32_16x16x32_bf16 v[64:67], a[84:87], a[4:7], v[64:67]
    buffer_load_dwordx4 v16, s[80:83], s75 offen offset:0 nt lds
    v_mfma_f32_16x16x32_bf16 v[64:67], a[88:91], a[8:11], v[64:67]
    ds_read_b64_tr_b16 a[158:159], v11 offset:20480
    v_mfma_f32_16x16x32_bf16 v[64:67], a[92:95], a[12:15], v[64:67]
    v_mfma_f32_16x16x32_bf16 v[68:71], a[96:99], a[0:3], v[40:43]
    ds_read_b64_tr_b16 a[160:161], v12 offset:16384
    v_mfma_f32_16x16x32_bf16 v[68:71], a[100:103], a[4:7], v[68:71]
    ds_read_b64_tr_b16 a[162:163], v12 offset:20480
    v_mfma_f32_16x16x32_bf16 v[68:71], a[104:107], a[8:11], v[68:71]
    v_mfma_f32_16x16x32_bf16 v[68:71], a[108:111], a[12:15], v[68:71]
    v_exp_f32 v77, v77
    v_exp_f32 v78, v78
    v_exp_f32 v79, v79
    v_cvt_pk_bf16_f32 v86, v76, v77
    v_cvt_pk_bf16_f32 v87, v78, v79
    v_exp_f32 v64, v64
    s_nop 0
    v_mfma_f32_16x16x32_bf16 v[224:227], a[176:179], v[84:87], v[224:227]
    ds_read_b64_tr_b16 a[164:165], v13 offset:16384
    v_mfma_f32_16x16x32_bf16 v[228:231], a[180:183], v[84:87], v[228:231]
    buffer_load_dwordx4 v17, s[80:83], s75 offen offset:1024 nt lds
    v_mfma_f32_16x16x32_bf16 v[232:235], a[184:187], v[84:87], v[232:235]
    ds_read_b64_tr_b16 a[166:167], v13 offset:20480
    v_mfma_f32_16x16x32_bf16 v[236:239], a[188:191], v[84:87], v[236:239]
    v_mfma_f32_16x16x32_bf16 v[240:243], a[192:195], v[84:87], v[240:243]
    ds_read_b64_tr_b16 a[168:169], v14 offset:16384
    v_mfma_f32_16x16x32_bf16 v[244:247], a[196:199], v[84:87], v[244:247]
    v_mfma_f32_16x16x32_bf16 v[248:251], a[200:203], v[84:87], v[248:251]
    ds_read_b64_tr_b16 a[170:171], v14 offset:20480
    v_mfma_f32_16x16x32_bf16 v[252:255], a[204:207], v[84:87], v[252:255]
    v_exp_f32 v65, v65
    v_exp_f32 v66, v66
    v_exp_f32 v67, v67
    v_exp_f32 v68, v68
    v_cvt_pk_bf16_f32 v80, v64, v65
    v_cvt_pk_bf16_f32 v81, v66, v67
    v_mfma_f32_16x16x32_bf16 v[60:63], a[228:231], v[84:87], v[60:63]
    ds_read_b64_tr_b16 a[172:173], v15 offset:16384
    v_mfma_f32_16x16x32_bf16 v[72:75], a[80:83], a[16:19], v[44:47]
    v_mfma_f32_16x16x32_bf16 v[72:75], a[84:87], a[20:23], v[72:75]
    ds_read_b64_tr_b16 a[174:175], v15 offset:20480
    v_mfma_f32_16x16x32_bf16 v[72:75], a[88:91], a[24:27], v[72:75]
    v_mfma_f32_16x16x32_bf16 v[72:75], a[92:95], a[28:31], v[72:75]
    v_mfma_f32_16x16x32_bf16 v[76:79], a[96:99], a[16:19], v[44:47]
    s_add_u32 s76, s93, 8192
    v_mfma_f32_16x16x32_bf16 v[76:79], a[100:103], a[20:23], v[76:79]
    buffer_load_dwordx4 a[208:211], v90, s[32:35], s76 offen
    v_mfma_f32_16x16x32_bf16 v[76:79], a[104:107], a[24:27], v[76:79]
    v_mfma_f32_16x16x32_bf16 v[76:79], a[108:111], a[28:31], v[76:79]
    s_waitcnt lgkmcnt(0)
    v_exp_f32 v69, v69
    v_exp_f32 v70, v70
    v_exp_f32 v71, v71
    v_cvt_pk_bf16_f32 v82, v68, v69
    v_cvt_pk_bf16_f32 v83, v70, v71
    v_exp_f32 v72, v72
    s_nop 0
    v_mfma_f32_16x16x32_bf16 v[96:99], a[144:147], v[80:83], v[96:99]
    v_mfma_f32_16x16x32_bf16 v[100:103], a[148:151], v[80:83], v[100:103]
    v_mfma_f32_16x16x32_bf16 v[104:107], a[152:155], v[80:83], v[104:107]
    s_add_u32 s75, s100, 106496
    v_mfma_f32_16x16x32_bf16 v[108:111], a[156:159], v[80:83], v[108:111]
    s_and_b32 s75, s75, s79
    v_mfma_f32_16x16x32_bf16 v[112:115], a[160:163], v[80:83], v[112:115]
    s_add_u32 m0, s74, 65536
    v_mfma_f32_16x16x32_bf16 v[116:119], a[164:167], v[80:83], v[116:119]
    buffer_load_dwordx4 v18, s[84:87], s75 offen offset:0 nt lds
    v_mfma_f32_16x16x32_bf16 v[120:123], a[168:171], v[80:83], v[120:123]
    v_mfma_f32_16x16x32_bf16 v[124:127], a[172:175], v[80:83], v[124:127]
    v_exp_f32 v73, v73
    v_exp_f32 v74, v74
    v_exp_f32 v75, v75
    v_exp_f32 v76, v76
    v_cvt_pk_bf16_f32 v84, v72, v73
    v_cvt_pk_bf16_f32 v85, v74, v75
    v_mfma_f32_16x16x32_bf16 v[32:35], a[228:231], v[80:83], v[32:35]
    v_mfma_f32_16x16x32_bf16 v[64:67], a[80:83], a[32:35], v[48:51]
    v_mfma_f32_16x16x32_bf16 v[64:67], a[84:87], a[36:39], v[64:67]
    v_mfma_f32_16x16x32_bf16 v[64:67], a[88:91], a[40:43], v[64:67]
    v_mfma_f32_16x16x32_bf16 v[64:67], a[92:95], a[44:47], v[64:67]
    v_mfma_f32_16x16x32_bf16 v[68:71], a[96:99], a[32:35], v[48:51]
    buffer_load_dwordx4 v19, s[84:87], s75 offen offset:1024 nt lds
    v_mfma_f32_16x16x32_bf16 v[68:71], a[100:103], a[36:39], v[68:71]
    v_mfma_f32_16x16x32_bf16 v[68:71], a[104:107], a[40:43], v[68:71]
    v_mfma_f32_16x16x32_bf16 v[68:71], a[108:111], a[44:47], v[68:71]
    v_exp_f32 v77, v77
    v_exp_f32 v78, v78
    v_exp_f32 v79, v79
    v_cvt_pk_bf16_f32 v86, v76, v77
    v_cvt_pk_bf16_f32 v87, v78, v79
    v_exp_f32 v64, v64
    s_nop 0
    v_mfma_f32_16x16x32_bf16 v[128:131], a[144:147], v[84:87], v[128:131]
    v_mfma_f32_16x16x32_bf16 v[132:135], a[148:151], v[84:87], v[132:135]
    v_mfma_f32_16x16x32_bf16 v[136:139], a[152:155], v[84:87], v[136:139]
    v_mfma_f32_16x16x32_bf16 v[140:143], a[156:159], v[84:87], v[140:143]
    v_mfma_f32_16x16x32_bf16 v[144:147], a[160:163], v[84:87], v[144:147]
    v_mfma_f32_16x16x32_bf16 v[148:151], a[164:167], v[84:87], v[148:151]
    v_mfma_f32_16x16x32_bf16 v[152:155], a[168:171], v[84:87], v[152:155]
    v_mfma_f32_16x16x32_bf16 v[156:159], a[172:175], v[84:87], v[156:159]
    v_exp_f32 v65, v65
    v_exp_f32 v66, v66
    v_exp_f32 v67, v67
    v_exp_f32 v68, v68
    v_cvt_pk_bf16_f32 v80, v64, v65
    v_cvt_pk_bf16_f32 v81, v66, v67
    v_mfma_f32_16x16x32_bf16 v[20:23], a[228:231], v[84:87], v[20:23]
    s_waitcnt vmcnt(24) lgkmcnt(0)
    v_mfma_f32_16x16x32_bf16 v[72:75], a[80:83], a[48:51], v[52:55]
    s_barrier
    v_mfma_f32_16x16x32_bf16 v[72:75], a[84:87], a[52:55], v[72:75]
    ds_read_b128 a[112:115], v4 offset:0
    v_mfma_f32_16x16x32_bf16 v[72:75], a[88:91], a[56:59], v[72:75]
    v_mfma_f32_16x16x32_bf16 v[72:75], a[92:95], a[60:63], v[72:75]
    ds_read_b128 a[116:119], v5 offset:0
    v_mfma_f32_16x16x32_bf16 v[76:79], a[96:99], a[48:51], v[52:55]
    s_add_u32 s76, s93, 9216
    v_mfma_f32_16x16x32_bf16 v[76:79], a[100:103], a[52:55], v[76:79]
    buffer_load_dwordx4 a[212:215], v90, s[32:35], s76 offen
    v_mfma_f32_16x16x32_bf16 v[76:79], a[104:107], a[56:59], v[76:79]
    v_mfma_f32_16x16x32_bf16 v[76:79], a[108:111], a[60:63], v[76:79]
    v_exp_f32 v69, v69
    v_exp_f32 v70, v70
    v_exp_f32 v71, v71
    v_cvt_pk_bf16_f32 v82, v68, v69
    v_cvt_pk_bf16_f32 v83, v70, v71
    v_exp_f32 v72, v72
    s_nop 0
    v_mfma_f32_16x16x32_bf16 v[160:163], a[144:147], v[80:83], v[160:163]
    ds_read_b128 a[120:123], v6 offset:0
    v_mfma_f32_16x16x32_bf16 v[164:167], a[148:151], v[80:83], v[164:167]
    s_add_u32 s75, s101, 106496
    v_mfma_f32_16x16x32_bf16 v[168:171], a[152:155], v[80:83], v[168:171]
    s_and_b32 s75, s75, s79
    ds_read_b128 a[124:127], v7 offset:0
    v_mfma_f32_16x16x32_bf16 v[172:175], a[156:159], v[80:83], v[172:175]
    s_add_u32 s75, s75, 131072
    v_mfma_f32_16x16x32_bf16 v[176:179], a[160:163], v[80:83], v[176:179]
    s_add_u32 m0, s74, 73728
    v_mfma_f32_16x16x32_bf16 v[180:183], a[164:167], v[80:83], v[180:183]
    buffer_load_dwordx4 v18, s[84:87], s75 offen offset:0 nt lds
    v_mfma_f32_16x16x32_bf16 v[184:187], a[168:171], v[80:83], v[184:187]
    ds_read_b128 a[128:131], v4 offset:4096
    v_mfma_f32_16x16x32_bf16 v[188:191], a[172:175], v[80:83], v[188:191]
    v_exp_f32 v73, v73
    v_exp_f32 v74, v74
    v_exp_f32 v75, v75
    v_exp_f32 v76, v76
    v_cvt_pk_bf16_f32 v84, v72, v73
    v_cvt_pk_bf16_f32 v85, v74, v75
    v_mfma_f32_16x16x32_bf16 v[36:39], a[228:231], v[80:83], v[36:39]
    s_waitcnt vmcnt(21) lgkmcnt(0)
    v_mfma_f32_16x16x32_bf16 v[64:67], a[80:83], a[64:67], v[56:59]
    s_barrier
    v_mfma_f32_16x16x32_bf16 v[64:67], a[84:87], a[68:71], v[64:67]
    ds_read_b128 a[132:135], v5 offset:4096
    v_mfma_f32_16x16x32_bf16 v[64:67], a[88:91], a[72:75], v[64:67]
    ds_read_b64_tr_b16 a[176:177], v8 offset:32768
    v_mfma_f32_16x16x32_bf16 v[64:67], a[92:95], a[76:79], v[64:67]
    ds_read_b128 a[136:139], v6 offset:4096
    v_mfma_f32_16x16x32_bf16 v[68:71], a[96:99], a[64:67], v[56:59]
    buffer_load_dwordx4 v19, s[84:87], s75 offen offset:1024 nt lds
    v_mfma_f32_16x16x32_bf16 v[68:71], a[100:103], a[68:71], v[68:71]
    ds_read_b64_tr_b16 a[178:179], v8 offset:36864
    v_mfma_f32_16x16x32_bf16 v[68:71], a[104:107], a[72:75], v[68:71]
    v_mfma_f32_16x16x32_bf16 v[68:71], a[108:111], a[76:79], v[68:71]
    v_exp_f32 v77, v77
    v_exp_f32 v78, v78
    v_exp_f32 v79, v79
    v_cvt_pk_bf16_f32 v86, v76, v77
    v_cvt_pk_bf16_f32 v87, v78, v79
    v_exp_f32 v64, v64
    s_nop 0
    v_mfma_f32_16x16x32_bf16 v[192:195], a[144:147], v[84:87], v[192:195]
    ds_read_b128 a[140:143], v7 offset:4096
    v_mfma_f32_16x16x32_bf16 v[196:199], a[148:151], v[84:87], v[196:199]
    ds_read_b64_tr_b16 a[180:181], v9 offset:32768
    v_mfma_f32_16x16x32_bf16 v[200:203], a[152:155], v[84:87], v[200:203]
    ds_read_b64_tr_b16 a[182:183], v9 offset:36864
    v_mfma_f32_16x16x32_bf16 v[204:207], a[156:159], v[84:87], v[204:207]
    v_mfma_f32_16x16x32_bf16 v[208:211], a[160:163], v[84:87], v[208:211]
    ds_read_b64_tr_b16 a[184:185], v10 offset:32768
    v_mfma_f32_16x16x32_bf16 v[212:215], a[164:167], v[84:87], v[212:215]
    v_mfma_f32_16x16x32_bf16 v[216:219], a[168:171], v[84:87], v[216:219]
    ds_read_b64_tr_b16 a[186:187], v10 offset:36864
    v_mfma_f32_16x16x32_bf16 v[220:223], a[172:175], v[84:87], v[220:223]
    v_exp_f32 v65, v65
    v_exp_f32 v66, v66
    v_exp_f32 v67, v67
    v_exp_f32 v68, v68
    v_cvt_pk_bf16_f32 v80, v64, v65
    v_cvt_pk_bf16_f32 v81, v66, v67
    v_mfma_f32_16x16x32_bf16 v[24:27], a[228:231], v[84:87], v[24:27]
    s_add_u32 s75, s100, 114688
    s_waitcnt lgkmcnt(0)
    ds_read_b64_tr_b16 a[188:189], v11 offset:32768
    v_mfma_f32_16x16x32_bf16 v[72:75], a[112:115], a[0:3], v[40:43]
    s_and_b32 s75, s75, s79
    v_mfma_f32_16x16x32_bf16 v[72:75], a[116:119], a[4:7], v[72:75]
    s_add_u32 m0, s74, 49152
    ds_read_b64_tr_b16 a[190:191], v11 offset:36864
    v_mfma_f32_16x16x32_bf16 v[72:75], a[120:123], a[8:11], v[72:75]
    buffer_load_dwordx4 v16, s[80:83], s75 offen offset:0 nt lds
    v_mfma_f32_16x16x32_bf16 v[72:75], a[124:127], a[12:15], v[72:75]
    v_mfma_f32_16x16x32_bf16 v[76:79], a[128:131], a[0:3], v[40:43]
    ds_read_b64_tr_b16 a[192:193], v12 offset:32768
    v_mfma_f32_16x16x32_bf16 v[76:79], a[132:135], a[4:7], v[76:79]
    ds_read_b64_tr_b16 a[194:195], v12 offset:36864
    v_mfma_f32_16x16x32_bf16 v[76:79], a[136:139], a[8:11], v[76:79]
    v_mfma_f32_16x16x32_bf16 v[76:79], a[140:143], a[12:15], v[76:79]
    v_exp_f32 v69, v69
    v_exp_f32 v70, v70
    v_exp_f32 v71, v71
    v_cvt_pk_bf16_f32 v82, v68, v69
    v_cvt_pk_bf16_f32 v83, v70, v71
    v_exp_f32 v72, v72
    s_nop 0
    v_mfma_f32_16x16x32_bf16 v[224:227], a[144:147], v[80:83], v[224:227]
    ds_read_b64_tr_b16 a[196:197], v13 offset:32768
    v_mfma_f32_16x16x32_bf16 v[228:231], a[148:151], v[80:83], v[228:231]
    ds_read_b64_tr_b16 a[198:199], v13 offset:36864
    v_mfma_f32_16x16x32_bf16 v[232:235], a[152:155], v[80:83], v[232:235]
    buffer_load_dwordx4 v17, s[80:83], s75 offen offset:1024 nt lds
    v_mfma_f32_16x16x32_bf16 v[236:239], a[156:159], v[80:83], v[236:239]
    v_mfma_f32_16x16x32_bf16 v[240:243], a[160:163], v[80:83], v[240:243]
    ds_read_b64_tr_b16 a[200:201], v14 offset:32768
    v_mfma_f32_16x16x32_bf16 v[244:247], a[164:167], v[80:83], v[244:247]
    v_mfma_f32_16x16x32_bf16 v[248:251], a[168:171], v[80:83], v[248:251]
    ds_read_b64_tr_b16 a[202:203], v14 offset:36864
    v_mfma_f32_16x16x32_bf16 v[252:255], a[172:175], v[80:83], v[252:255]
    v_exp_f32 v73, v73
    v_exp_f32 v74, v74
    v_exp_f32 v75, v75
    v_exp_f32 v76, v76
    v_cvt_pk_bf16_f32 v84, v72, v73
    v_cvt_pk_bf16_f32 v85, v74, v75
    v_mfma_f32_16x16x32_bf16 v[60:63], a[228:231], v[80:83], v[60:63]
    ds_read_b64_tr_b16 a[204:205], v15 offset:32768
    v_mfma_f32_16x16x32_bf16 v[64:67], a[112:115], a[16:19], v[44:47]
    v_mfma_f32_16x16x32_bf16 v[64:67], a[116:119], a[20:23], v[64:67]
    ds_read_b64_tr_b16 a[206:207], v15 offset:36864
    v_mfma_f32_16x16x32_bf16 v[64:67], a[120:123], a[24:27], v[64:67]
    v_mfma_f32_16x16x32_bf16 v[64:67], a[124:127], a[28:31], v[64:67]
    v_mfma_f32_16x16x32_bf16 v[68:71], a[128:131], a[16:19], v[44:47]
    v_mfma_f32_16x16x32_bf16 v[68:71], a[132:135], a[20:23], v[68:71]
    v_mfma_f32_16x16x32_bf16 v[68:71], a[136:139], a[24:27], v[68:71]
    v_mfma_f32_16x16x32_bf16 v[68:71], a[140:143], a[28:31], v[68:71]
    s_waitcnt lgkmcnt(0)
    v_exp_f32 v77, v77
    v_exp_f32 v78, v78
    v_exp_f32 v79, v79
    v_cvt_pk_bf16_f32 v86, v76, v77
    v_cvt_pk_bf16_f32 v87, v78, v79
    v_exp_f32 v64, v64
    s_nop 0
    v_mfma_f32_16x16x32_bf16 v[96:99], a[176:179], v[84:87], v[96:99]
    v_mfma_f32_16x16x32_bf16 v[100:103], a[180:183], v[84:87], v[100:103]
    v_mfma_f32_16x16x32_bf16 v[104:107], a[184:187], v[84:87], v[104:107]
    s_add_u32 s75, s101, 114688
    v_mfma_f32_16x16x32_bf16 v[108:111], a[188:191], v[84:87], v[108:111]
    s_and_b32 s75, s75, s79
    v_mfma_f32_16x16x32_bf16 v[112:115], a[192:195], v[84:87], v[112:115]
    s_add_u32 s75, s75, 131072
    v_mfma_f32_16x16x32_bf16 v[116:119], a[196:199], v[84:87], v[116:119]
    s_add_u32 m0, s74, 57344
    v_mfma_f32_16x16x32_bf16 v[120:123], a[200:203], v[84:87], v[120:123]
    buffer_load_dwordx4 v16, s[80:83], s75 offen offset:0 nt lds
    v_mfma_f32_16x16x32_bf16 v[124:127], a[204:207], v[84:87], v[124:127]
    v_exp_f32 v65, v65
    v_exp_f32 v66, v66
    v_exp_f32 v67, v67
    v_exp_f32 v68, v68
    v_cvt_pk_bf16_f32 v80, v64, v65
    v_cvt_pk_bf16_f32 v81, v66, v67
    v_mfma_f32_16x16x32_bf16 v[32:35], a[228:231], v[84:87], v[32:35]
    v_mfma_f32_16x16x32_bf16 v[72:75], a[112:115], a[32:35], v[48:51]
    v_mfma_f32_16x16x32_bf16 v[72:75], a[116:119], a[36:39], v[72:75]
    v_mfma_f32_16x16x32_bf16 v[72:75], a[120:123], a[40:43], v[72:75]
    v_mfma_f32_16x16x32_bf16 v[72:75], a[124:127], a[44:47], v[72:75]
    v_mfma_f32_16x16x32_bf16 v[76:79], a[128:131], a[32:35], v[48:51]
    v_mfma_f32_16x16x32_bf16 v[76:79], a[132:135], a[36:39], v[76:79]
    buffer_load_dwordx4 v17, s[80:83], s75 offen offset:1024 nt lds
    v_mfma_f32_16x16x32_bf16 v[76:79], a[136:139], a[40:43], v[76:79]
    v_mfma_f32_16x16x32_bf16 v[76:79], a[140:143], a[44:47], v[76:79]
    v_exp_f32 v69, v69
    v_exp_f32 v70, v70
    v_exp_f32 v71, v71
    v_cvt_pk_bf16_f32 v82, v68, v69
    v_cvt_pk_bf16_f32 v83, v70, v71
    v_exp_f32 v72, v72
    s_nop 0
    v_mfma_f32_16x16x32_bf16 v[128:131], a[176:179], v[80:83], v[128:131]
    v_mfma_f32_16x16x32_bf16 v[132:135], a[180:183], v[80:83], v[132:135]
    v_mfma_f32_16x16x32_bf16 v[136:139], a[184:187], v[80:83], v[136:139]
    v_mfma_f32_16x16x32_bf16 v[140:143], a[188:191], v[80:83], v[140:143]
    v_mfma_f32_16x16x32_bf16 v[144:147], a[192:195], v[80:83], v[144:147]
    v_mfma_f32_16x16x32_bf16 v[148:151], a[196:199], v[80:83], v[148:151]
    v_mfma_f32_16x16x32_bf16 v[152:155], a[200:203], v[80:83], v[152:155]
    v_mfma_f32_16x16x32_bf16 v[156:159], a[204:207], v[80:83], v[156:159]
    v_exp_f32 v73, v73
    v_exp_f32 v74, v74
    v_exp_f32 v75, v75
    v_exp_f32 v76, v76
    v_cvt_pk_bf16_f32 v84, v72, v73
    v_cvt_pk_bf16_f32 v85, v74, v75
    v_mfma_f32_16x16x32_bf16 v[20:23], a[228:231], v[80:83], v[20:23]
    s_waitcnt vmcnt(21) lgkmcnt(0)
    v_mfma_f32_16x16x32_bf16 v[64:67], a[112:115], a[48:51], v[52:55]
    s_barrier
    v_mfma_f32_16x16x32_bf16 v[64:67], a[116:119], a[52:55], v[64:67]
    ds_read_b128 a[80:83], v4 offset:16384
    v_mfma_f32_16x16x32_bf16 v[64:67], a[120:123], a[56:59], v[64:67]
    v_mfma_f32_16x16x32_bf16 v[64:67], a[124:127], a[60:63], v[64:67]
    ds_read_b128 a[84:87], v5 offset:16384
    v_mfma_f32_16x16x32_bf16 v[68:71], a[128:131], a[48:51], v[52:55]
    v_mfma_f32_16x16x32_bf16 v[68:71], a[132:135], a[52:55], v[68:71]
    v_mfma_f32_16x16x32_bf16 v[68:71], a[136:139], a[56:59], v[68:71]
    s_add_u32 s75, s100, 114688
    ds_read_b128 a[88:91], v6 offset:16384
    v_mfma_f32_16x16x32_bf16 v[68:71], a[140:143], a[60:63], v[68:71]
    s_and_b32 s75, s75, s79
    v_exp_f32 v77, v77
    v_exp_f32 v78, v78
    v_exp_f32 v79, v79
    v_cvt_pk_bf16_f32 v86, v76, v77
    v_cvt_pk_bf16_f32 v87, v78, v79
    v_exp_f32 v64, v64
    s_nop 0
    v_mfma_f32_16x16x32_bf16 v[160:163], a[176:179], v[84:87], v[160:163]
    s_add_u32 m0, s74, 81920
    v_mfma_f32_16x16x32_bf16 v[164:167], a[180:183], v[84:87], v[164:167]
    buffer_load_dwordx4 v18, s[84:87], s75 offen offset:0 nt lds
    v_mfma_f32_16x16x32_bf16 v[168:171], a[184:187], v[84:87], v[168:171]
    ds_read_b128 a[92:95], v7 offset:16384
    v_mfma_f32_16x16x32_bf16 v[172:175], a[188:191], v[84:87], v[172:175]
    v_mfma_f32_16x16x32_bf16 v[176:179], a[192:195], v[84:87], v[176:179]
    v_mfma_f32_16x16x32_bf16 v[180:183], a[196:199], v[84:87], v[180:183]
    ds_read_b128 a[96:99], v4 offset:20480
    v_mfma_f32_16x16x32_bf16 v[184:187], a[200:203], v[84:87], v[184:187]
    v_mfma_f32_16x16x32_bf16 v[188:191], a[204:207], v[84:87], v[188:191]
    v_exp_f32 v65, v65
    v_exp_f32 v66, v66
    v_exp_f32 v67, v67
    v_exp_f32 v68, v68
    v_cvt_pk_bf16_f32 v80, v64, v65
    v_cvt_pk_bf16_f32 v81, v66, v67
    v_mfma_f32_16x16x32_bf16 v[36:39], a[228:231], v[84:87], v[36:39]
    s_waitcnt vmcnt(16) lgkmcnt(0)
    ds_read_b128 a[100:103], v5 offset:20480
    v_mfma_f32_16x16x32_bf16 v[72:75], a[112:115], a[64:67], v[56:59]
    s_barrier
    buffer_load_dwordx4 v19, s[84:87], s75 offen offset:1024 nt lds
    v_mfma_f32_16x16x32_bf16 v[72:75], a[116:119], a[68:71], v[72:75]
    ds_read_b64_tr_b16 a[144:145], v8 offset:49152
    v_mfma_f32_16x16x32_bf16 v[72:75], a[120:123], a[72:75], v[72:75]
    s_add_u32 s75, s60, 0
    ds_read_b64_tr_b16 a[146:147], v8 offset:53248
    v_mfma_f32_16x16x32_bf16 v[72:75], a[124:127], a[76:79], v[72:75]
    s_add_u32 m0, s92, 0
    ds_read_b128 a[104:107], v6 offset:20480
    v_mfma_f32_16x16x32_bf16 v[76:79], a[128:131], a[64:67], v[56:59]
    buffer_load_dwordx4 v28, s[32:35], s75 offen offset:0 lds
    v_mfma_f32_16x16x32_bf16 v[76:79], a[132:135], a[68:71], v[76:79]
    ds_read_b64_tr_b16 a[148:149], v9 offset:49152
    v_mfma_f32_16x16x32_bf16 v[76:79], a[136:139], a[72:75], v[76:79]
    ds_read_b128 a[108:111], v7 offset:20480
    v_mfma_f32_16x16x32_bf16 v[76:79], a[140:143], a[76:79], v[76:79]
    v_exp_f32 v69, v69
    v_exp_f32 v70, v70
    v_exp_f32 v71, v71
    v_cvt_pk_bf16_f32 v82, v68, v69
    v_cvt_pk_bf16_f32 v83, v70, v71
    v_exp_f32 v72, v72
    s_nop 0
    v_mfma_f32_16x16x32_bf16 v[192:195], a[176:179], v[80:83], v[192:195]
    buffer_load_dwordx4 v29, s[32:35], s75 offen offset:1024 lds
    v_mfma_f32_16x16x32_bf16 v[196:199], a[180:183], v[80:83], v[196:199]
    v_mfma_f32_16x16x32_bf16 v[200:203], a[184:187], v[80:83], v[200:203]
    ds_read_b64_tr_b16 a[150:151], v9 offset:53248
    v_mfma_f32_16x16x32_bf16 v[204:207], a[188:191], v[80:83], v[204:207]
    ds_read_b64_tr_b16 a[152:153], v10 offset:49152
    v_mfma_f32_16x16x32_bf16 v[208:211], a[192:195], v[80:83], v[208:211]
    buffer_load_dwordx4 v30, s[32:35], s75 offen offset:2048 lds
    v_mfma_f32_16x16x32_bf16 v[212:215], a[196:199], v[80:83], v[212:215]
    v_mfma_f32_16x16x32_bf16 v[216:219], a[200:203], v[80:83], v[216:219]
    ds_read_b64_tr_b16 a[154:155], v10 offset:53248
    v_mfma_f32_16x16x32_bf16 v[220:223], a[204:207], v[80:83], v[220:223]
    v_exp_f32 v73, v73
    v_exp_f32 v74, v74
    v_exp_f32 v75, v75
    v_exp_f32 v76, v76
    v_cvt_pk_bf16_f32 v84, v72, v73
    v_cvt_pk_bf16_f32 v85, v74, v75
    v_mfma_f32_16x16x32_bf16 v[24:27], a[228:231], v[80:83], v[24:27]
    s_waitcnt lgkmcnt(0)
    buffer_load_dwordx4 v31, s[32:35], s75 offen offset:3072 lds
    v_mfma_f32_16x16x32_bf16 v[64:67], a[80:83], a[0:3], v[40:43]
    ds_read_b64_tr_b16 a[156:157], v11 offset:49152
    v_mfma_f32_16x16x32_bf16 v[64:67], a[84:87], a[4:7], v[64:67]
    v_mfma_f32_16x16x32_bf16 v[64:67], a[88:91], a[8:11], v[64:67]
    s_add_u32 m0, s92, 4096
    ds_read_b64_tr_b16 a[158:159], v11 offset:53248
    v_mfma_f32_16x16x32_bf16 v[64:67], a[92:95], a[12:15], v[64:67]
    buffer_load_dwordx4 v88, s[32:35], s75 offen lds
    v_mfma_f32_16x16x32_bf16 v[68:71], a[96:99], a[0:3], v[40:43]
    ds_read_b64_tr_b16 a[160:161], v12 offset:49152
    v_mfma_f32_16x16x32_bf16 v[68:71], a[100:103], a[4:7], v[68:71]
    ds_read_b64_tr_b16 a[162:163], v12 offset:53248
    v_mfma_f32_16x16x32_bf16 v[68:71], a[104:107], a[8:11], v[68:71]
    v_mfma_f32_16x16x32_bf16 v[68:71], a[108:111], a[12:15], v[68:71]
    s_add_u32 s75, s101, 114688
    v_exp_f32 v77, v77
    v_exp_f32 v78, v78
    v_exp_f32 v79, v79
    v_cvt_pk_bf16_f32 v86, v76, v77
    v_cvt_pk_bf16_f32 v87, v78, v79
    v_exp_f32 v64, v64
    s_nop 0
    v_mfma_f32_16x16x32_bf16 v[224:227], a[176:179], v[84:87], v[224:227]
    s_and_b32 s75, s75, s79
    ds_read_b64_tr_b16 a[164:165], v13 offset:49152
    v_mfma_f32_16x16x32_bf16 v[228:231], a[180:183], v[84:87], v[228:231]
    s_add_u32 s75, s75, 131072
    ds_read_b64_tr_b16 a[166:167], v13 offset:53248
    v_mfma_f32_16x16x32_bf16 v[232:235], a[184:187], v[84:87], v[232:235]
    s_add_u32 m0, s74, 90112
    v_mfma_f32_16x16x32_bf16 v[236:239], a[188:191], v[84:87], v[236:239]
    buffer_load_dwordx4 v18, s[84:87], s75 offen offset:0 nt lds
    v_mfma_f32_16x16x32_bf16 v[240:243], a[192:195], v[84:87], v[240:243]
    ds_read_b64_tr_b16 a[168:169], v14 offset:49152
    v_mfma_f32_16x16x32_bf16 v[244:247], a[196:199], v[84:87], v[244:247]
    ds_read_b64_tr_b16 a[170:171], v14 offset:53248
    v_mfma_f32_16x16x32_bf16 v[248:251], a[200:203], v[84:87], v[248:251]
    v_mfma_f32_16x16x32_bf16 v[252:255], a[204:207], v[84:87], v[252:255]
    v_exp_f32 v65, v65
    v_exp_f32 v66, v66
    v_exp_f32 v67, v67
    v_exp_f32 v68, v68
    v_cvt_pk_bf16_f32 v80, v64, v65
    v_cvt_pk_bf16_f32 v81, v66, v67
    v_mfma_f32_16x16x32_bf16 v[60:63], a[228:231], v[84:87], v[60:63]
    ds_read_b64_tr_b16 a[172:173], v15 offset:49152
    v_mfma_f32_16x16x32_bf16 v[72:75], a[80:83], a[16:19], v[44:47]
    ds_read_b64_tr_b16 a[174:175], v15 offset:53248
    v_mfma_f32_16x16x32_bf16 v[72:75], a[84:87], a[20:23], v[72:75]
    v_mfma_f32_16x16x32_bf16 v[72:75], a[88:91], a[24:27], v[72:75]
    buffer_load_dwordx4 v19, s[84:87], s75 offen offset:1024 nt lds
    v_mfma_f32_16x16x32_bf16 v[72:75], a[92:95], a[28:31], v[72:75]
    v_mfma_f32_16x16x32_bf16 v[76:79], a[96:99], a[16:19], v[44:47]
    v_mfma_f32_16x16x32_bf16 v[76:79], a[100:103], a[20:23], v[76:79]
    v_mfma_f32_16x16x32_bf16 v[76:79], a[104:107], a[24:27], v[76:79]
    v_mfma_f32_16x16x32_bf16 v[76:79], a[108:111], a[28:31], v[76:79]
    s_waitcnt lgkmcnt(0)
    v_exp_f32 v69, v69
    v_exp_f32 v70, v70
    v_exp_f32 v71, v71
    v_cvt_pk_bf16_f32 v82, v68, v69
    v_cvt_pk_bf16_f32 v83, v70, v71
    v_exp_f32 v72, v72
    s_nop 0
    v_mfma_f32_16x16x32_bf16 v[96:99], a[144:147], v[80:83], v[96:99]
    v_mfma_f32_16x16x32_bf16 v[100:103], a[148:151], v[80:83], v[100:103]
    v_mfma_f32_16x16x32_bf16 v[104:107], a[152:155], v[80:83], v[104:107]
    v_mfma_f32_16x16x32_bf16 v[108:111], a[156:159], v[80:83], v[108:111]
    v_mfma_f32_16x16x32_bf16 v[112:115], a[160:163], v[80:83], v[112:115]
    v_mfma_f32_16x16x32_bf16 v[116:119], a[164:167], v[80:83], v[116:119]
    v_mfma_f32_16x16x32_bf16 v[120:123], a[168:171], v[80:83], v[120:123]
    v_mfma_f32_16x16x32_bf16 v[124:127], a[172:175], v[80:83], v[124:127]
    v_exp_f32 v73, v73
    v_exp_f32 v74, v74
    v_exp_f32 v75, v75
    v_exp_f32 v76, v76
    v_cvt_pk_bf16_f32 v84, v72, v73
    v_cvt_pk_bf16_f32 v85, v74, v75
    v_mfma_f32_16x16x32_bf16 v[32:35], a[228:231], v[80:83], v[32:35]
    v_mfma_f32_16x16x32_bf16 v[64:67], a[80:83], a[32:35], v[48:51]
    v_mfma_f32_16x16x32_bf16 v[64:67], a[84:87], a[36:39], v[64:67]
    v_mfma_f32_16x16x32_bf16 v[64:67], a[88:91], a[40:43], v[64:67]
    v_mfma_f32_16x16x32_bf16 v[64:67], a[92:95], a[44:47], v[64:67]
    v_mfma_f32_16x16x32_bf16 v[68:71], a[96:99], a[32:35], v[48:51]
    v_mfma_f32_16x16x32_bf16 v[68:71], a[100:103], a[36:39], v[68:71]
    v_mfma_f32_16x16x32_bf16 v[68:71], a[104:107], a[40:43], v[68:71]
    v_mfma_f32_16x16x32_bf16 v[68:71], a[108:111], a[44:47], v[68:71]
    v_exp_f32 v77, v77
    v_exp_f32 v78, v78
    v_exp_f32 v79, v79
    v_cvt_pk_bf16_f32 v86, v76, v77
    v_cvt_pk_bf16_f32 v87, v78, v79
    v_exp_f32 v64, v64
    s_nop 0
    v_mfma_f32_16x16x32_bf16 v[128:131], a[144:147], v[84:87], v[128:131]
    v_mfma_f32_16x16x32_bf16 v[132:135], a[148:151], v[84:87], v[132:135]
    v_mfma_f32_16x16x32_bf16 v[136:139], a[152:155], v[84:87], v[136:139]
    v_mfma_f32_16x16x32_bf16 v[140:143], a[156:159], v[84:87], v[140:143]
    v_mfma_f32_16x16x32_bf16 v[144:147], a[160:163], v[84:87], v[144:147]
    v_mfma_f32_16x16x32_bf16 v[148:151], a[164:167], v[84:87], v[148:151]
    v_mfma_f32_16x16x32_bf16 v[152:155], a[168:171], v[84:87], v[152:155]
    v_mfma_f32_16x16x32_bf16 v[156:159], a[172:175], v[84:87], v[156:159]
    s_add_u32 s75, s100, 122880
    v_exp_f32 v65, v65
    v_exp_f32 v66, v66
    v_exp_f32 v67, v67
    v_exp_f32 v68, v68
    v_cvt_pk_bf16_f32 v80, v64, v65
    v_cvt_pk_bf16_f32 v81, v66, v67
    v_mfma_f32_16x16x32_bf16 v[20:23], a[228:231], v[84:87], v[20:23]
    s_waitcnt vmcnt(19) lgkmcnt(0)
    s_and_b32 s75, s75, s79
    v_mfma_f32_16x16x32_bf16 v[72:75], a[80:83], a[48:51], v[52:55]
    s_barrier
    s_add_u32 m0, s74, 16384
    v_mfma_f32_16x16x32_bf16 v[72:75], a[84:87], a[52:55], v[72:75]
    buffer_load_dwordx4 v16, s[80:83], s75 offen offset:0 nt lds
    v_mfma_f32_16x16x32_bf16 v[72:75], a[88:91], a[56:59], v[72:75]
    ds_read_b128 a[112:115], v4 offset:32768
    v_mfma_f32_16x16x32_bf16 v[72:75], a[92:95], a[60:63], v[72:75]
    v_mfma_f32_16x16x32_bf16 v[76:79], a[96:99], a[48:51], v[52:55]
    ds_read_b128 a[116:119], v5 offset:32768
    v_mfma_f32_16x16x32_bf16 v[76:79], a[100:103], a[52:55], v[76:79]
    v_mfma_f32_16x16x32_bf16 v[76:79], a[104:107], a[56:59], v[76:79]
    v_mfma_f32_16x16x32_bf16 v[76:79], a[108:111], a[60:63], v[76:79]
    v_exp_f32 v69, v69
    v_exp_f32 v70, v70
    v_exp_f32 v71, v71
    v_cvt_pk_bf16_f32 v82, v68, v69
    v_cvt_pk_bf16_f32 v83, v70, v71
    v_exp_f32 v72, v72
    s_nop 0
    v_mfma_f32_16x16x32_bf16 v[160:163], a[144:147], v[80:83], v[160:163]
    ds_read_b128 a[120:123], v6 offset:32768
    v_mfma_f32_16x16x32_bf16 v[164:167], a[148:151], v[80:83], v[164:167]
    buffer_load_dwordx4 v17, s[80:83], s75 offen offset:1024 nt lds
    v_mfma_f32_16x16x32_bf16 v[168:171], a[152:155], v[80:83], v[168:171]
    v_mfma_f32_16x16x32_bf16 v[172:175], a[156:159], v[80:83], v[172:175]
    ds_read_b128 a[124:127], v7 offset:32768
    v_mfma_f32_16x16x32_bf16 v[176:179], a[160:163], v[80:83], v[176:179]
    v_mfma_f32_16x16x32_bf16 v[180:183], a[164:167], v[80:83], v[180:183]
    s_add_u32 s75, s101, 122880
    v_mfma_f32_16x16x32_bf16 v[184:187], a[168:171], v[80:83], v[184:187]
    s_and_b32 s75, s75, s79
    ds_read_b128 a[128:131], v4 offset:36864
    v_mfma_f32_16x16x32_bf16 v[188:191], a[172:175], v[80:83], v[188:191]
    s_add_u32 s75, s75, 131072
    v_exp_f32 v73, v73
    v_exp_f32 v74, v74
    v_exp_f32 v75, v75
    v_exp_f32 v76, v76
    v_cvt_pk_bf16_f32 v84, v72, v73
    v_cvt_pk_bf16_f32 v85, v74, v75
    v_mfma_f32_16x16x32_bf16 v[36:39], a[228:231], v[80:83], v[36:39]
    s_waitcnt vmcnt(15) lgkmcnt(0)
    s_add_u32 m0, s74, 24576
    v_mfma_f32_16x16x32_bf16 v[64:67], a[80:83], a[64:67], v[56:59]
    s_barrier
    buffer_load_dwordx4 v16, s[80:83], s75 offen offset:0 nt lds
    v_mfma_f32_16x16x32_bf16 v[64:67], a[84:87], a[68:71], v[64:67]
    ds_read_b128 a[132:135], v5 offset:36864
    v_mfma_f32_16x16x32_bf16 v[64:67], a[88:91], a[72:75], v[64:67]
    ds_read_b64_tr_b16 a[176:177], v8 offset:0
    v_mfma_f32_16x16x32_bf16 v[64:67], a[92:95], a[76:79], v[64:67]
    ds_read_b64_tr_b16 a[178:179], v8 offset:4096
    v_mfma_f32_16x16x32_bf16 v[68:71], a[96:99], a[64:67], v[56:59]
    ds_read_b128 a[136:139], v6 offset:36864
    v_mfma_f32_16x16x32_bf16 v[68:71], a[100:103], a[68:71], v[68:71]
    ds_read_b64_tr_b16 a[180:181], v9 offset:0
    v_mfma_f32_16x16x32_bf16 v[68:71], a[104:107], a[72:75], v[68:71]
    ds_read_b128 a[140:143], v7 offset:36864
    v_mfma_f32_16x16x32_bf16 v[68:71], a[108:111], a[76:79], v[68:71]
    v_exp_f32 v77, v77
    v_exp_f32 v78, v78
    v_exp_f32 v79, v79
    v_cvt_pk_bf16_f32 v86, v76, v77
    v_cvt_pk_bf16_f32 v87, v78, v79
    v_exp_f32 v64, v64
    s_nop 0
    v_mfma_f32_16x16x32_bf16 v[192:195], a[144:147], v[84:87], v[192:195]
    buffer_load_dwordx4 v17, s[80:83], s75 offen offset:1024 nt lds
    v_mfma_f32_16x16x32_bf16 v[196:199], a[148:151], v[84:87], v[196:199]
    v_mfma_f32_16x16x32_bf16 v[200:203], a[152:155], v[84:87], v[200:203]
    s_add_u32 s75, s60, 40960
    ds_read_b64_tr_b16 a[182:183], v9 offset:4096
    v_mfma_f32_16x16x32_bf16 v[204:207], a[156:159], v[84:87], v[204:207]
    s_add_u32 m0, s62, 0
    ds_read_b64_tr_b16 a[184:185], v10 offset:0
    v_mfma_f32_16x16x32_bf16 v[208:211], a[160:163], v[84:87], v[208:211]
    buffer_load_dwordx4 v28, s[32:35], s75 offen offset:0 lds
    v_mfma_f32_16x16x32_bf16 v[212:215], a[164:167], v[84:87], v[212:215]
    v_mfma_f32_16x16x32_bf16 v[216:219], a[168:171], v[84:87], v[216:219]
    ds_read_b64_tr_b16 a[186:187], v10 offset:4096
    v_mfma_f32_16x16x32_bf16 v[220:223], a[172:175], v[84:87], v[220:223]
    v_exp_f32 v65, v65
    v_exp_f32 v66, v66
    v_exp_f32 v67, v67
    v_exp_f32 v68, v68
    v_cvt_pk_bf16_f32 v80, v64, v65
    v_cvt_pk_bf16_f32 v81, v66, v67
    v_mfma_f32_16x16x32_bf16 v[24:27], a[228:231], v[84:87], v[24:27]
    s_waitcnt lgkmcnt(0)
    buffer_load_dwordx4 v29, s[32:35], s75 offen offset:1024 lds
    v_mfma_f32_16x16x32_bf16 v[72:75], a[112:115], a[0:3], v[40:43]
    ds_read_b64_tr_b16 a[188:189], v11 offset:0
    v_mfma_f32_16x16x32_bf16 v[72:75], a[116:119], a[4:7], v[72:75]
    v_mfma_f32_16x16x32_bf16 v[72:75], a[120:123], a[8:11], v[72:75]
    ds_read_b64_tr_b16 a[190:191], v11 offset:4096
    v_mfma_f32_16x16x32_bf16 v[72:75], a[124:127], a[12:15], v[72:75]
    buffer_load_dwordx4 v30, s[32:35], s75 offen offset:2048 lds
    v_mfma_f32_16x16x32_bf16 v[76:79], a[128:131], a[0:3], v[40:43]
    ds_read_b64_tr_b16 a[192:193], v12 offset:0
    v_mfma_f32_16x16x32_bf16 v[76:79], a[132:135], a[4:7], v[76:79]
    ds_read_b64_tr_b16 a[194:195], v12 offset:4096
    v_mfma_f32_16x16x32_bf16 v[76:79], a[136:139], a[8:11], v[76:79]
    v_mfma_f32_16x16x32_bf16 v[76:79], a[140:143], a[12:15], v[76:79]
    v_exp_f32 v69, v69
    v_exp_f32 v70, v70
    v_exp_f32 v71, v71
    v_cvt_pk_bf16_f32 v82, v68, v69
    v_cvt_pk_bf16_f32 v83, v70, v71
    v_exp_f32 v72, v72
    s_nop 0
    v_mfma_f32_16x16x32_bf16 v[224:227], a[144:147], v[80:83], v[224:227]
    buffer_load_dwordx4 v31, s[32:35], s75 offen offset:3072 lds
    v_mfma_f32_16x16x32_bf16 v[228:231], a[148:151], v[80:83], v[228:231]
    ds_read_b64_tr_b16 a[196:197], v13 offset:0
    v_mfma_f32_16x16x32_bf16 v[232:235], a[152:155], v[80:83], v[232:235]
    ds_read_b64_tr_b16 a[198:199], v13 offset:4096
    v_mfma_f32_16x16x32_bf16 v[236:239], a[156:159], v[80:83], v[236:239]
    s_add_u32 m0, s62, 4096
    v_mfma_f32_16x16x32_bf16 v[240:243], a[160:163], v[80:83], v[240:243]
    buffer_load_dwordx4 v88, s[32:35], s75 offen lds
    v_mfma_f32_16x16x32_bf16 v[244:247], a[164:167], v[80:83], v[244:247]
    ds_read_b64_tr_b16 a[200:201], v14 offset:0
    v_mfma_f32_16x16x32_bf16 v[248:251], a[168:171], v[80:83], v[248:251]
    ds_read_b64_tr_b16 a[202:203], v14 offset:4096
    v_mfma_f32_16x16x32_bf16 v[252:255], a[172:175], v[80:83], v[252:255]
    v_exp_f32 v73, v73
    v_exp_f32 v74, v74
    v_exp_f32 v75, v75
    v_exp_f32 v76, v76
    v_cvt_pk_bf16_f32 v84, v72, v73
    v_cvt_pk_bf16_f32 v85, v74, v75
    v_mfma_f32_16x16x32_bf16 v[60:63], a[228:231], v[80:83], v[60:63]
    v_mfma_f32_16x16x32_bf16 v[64:67], a[112:115], a[16:19], v[44:47]
    s_add_u32 s75, s100, 122880
    ds_read_b64_tr_b16 a[204:205], v15 offset:0
    v_mfma_f32_16x16x32_bf16 v[64:67], a[116:119], a[20:23], v[64:67]
    s_and_b32 s75, s75, s79
    ds_read_b64_tr_b16 a[206:207], v15 offset:4096
    v_mfma_f32_16x16x32_bf16 v[64:67], a[120:123], a[24:27], v[64:67]
    s_add_u32 m0, s74, 114688
    v_mfma_f32_16x16x32_bf16 v[64:67], a[124:127], a[28:31], v[64:67]
    buffer_load_dwordx4 v18, s[84:87], s75 offen offset:0 nt lds
    v_mfma_f32_16x16x32_bf16 v[68:71], a[128:131], a[16:19], v[44:47]
    v_mfma_f32_16x16x32_bf16 v[68:71], a[132:135], a[20:23], v[68:71]
    v_mfma_f32_16x16x32_bf16 v[68:71], a[136:139], a[24:27], v[68:71]
    v_mfma_f32_16x16x32_bf16 v[68:71], a[140:143], a[28:31], v[68:71]
    s_waitcnt lgkmcnt(0)
    v_exp_f32 v77, v77
    v_exp_f32 v78, v78
    v_exp_f32 v79, v79
    v_cvt_pk_bf16_f32 v86, v76, v77
    v_cvt_pk_bf16_f32 v87, v78, v79
    v_exp_f32 v64, v64
    s_nop 0
    v_mfma_f32_16x16x32_bf16 v[96:99], a[176:179], v[84:87], v[96:99]
    v_mfma_f32_16x16x32_bf16 v[100:103], a[180:183], v[84:87], v[100:103]
    v_mfma_f32_16x16x32_bf16 v[104:107], a[184:187], v[84:87], v[104:107]
    v_mfma_f32_16x16x32_bf16 v[108:111], a[188:191], v[84:87], v[108:111]
    buffer_load_dwordx4 v19, s[84:87], s75 offen offset:1024 nt lds
    v_mfma_f32_16x16x32_bf16 v[112:115], a[192:195], v[84:87], v[112:115]
    v_mfma_f32_16x16x32_bf16 v[116:119], a[196:199], v[84:87], v[116:119]
    v_mfma_f32_16x16x32_bf16 v[120:123], a[200:203], v[84:87], v[120:123]
    v_mfma_f32_16x16x32_bf16 v[124:127], a[204:207], v[84:87], v[124:127]
    s_add_u32 s75, s101, 122880
    v_exp_f32 v65, v65
    v_exp_f32 v66, v66
    v_exp_f32 v67, v67
    v_exp_f32 v68, v68
    v_cvt_pk_bf16_f32 v80, v64, v65
    v_cvt_pk_bf16_f32 v81, v66, v67
    v_mfma_f32_16x16x32_bf16 v[32:35], a[228:231], v[84:87], v[32:35]
    s_and_b32 s75, s75, s79
    v_mfma_f32_16x16x32_bf16 v[72:75], a[112:115], a[32:35], v[48:51]
    s_add_u32 s75, s75, 131072
    v_mfma_f32_16x16x32_bf16 v[72:75], a[116:119], a[36:39], v[72:75]
    s_add_u32 m0, s74, 122880
    v_mfma_f32_16x16x32_bf16 v[72:75], a[120:123], a[40:43], v[72:75]
    buffer_load_dwordx4 v18, s[84:87], s75 offen offset:0 nt lds
    v_mfma_f32_16x16x32_bf16 v[72:75], a[124:127], a[44:47], v[72:75]
    v_mfma_f32_16x16x32_bf16 v[76:79], a[128:131], a[32:35], v[48:51]
    v_mfma_f32_16x16x32_bf16 v[76:79], a[132:135], a[36:39], v[76:79]
    v_mfma_f32_16x16x32_bf16 v[76:79], a[136:139], a[40:43], v[76:79]
    v_mfma_f32_16x16x32_bf16 v[76:79], a[140:143], a[44:47], v[76:79]
    v_exp_f32 v69, v69
    v_exp_f32 v70, v70
    v_exp_f32 v71, v71
    v_cvt_pk_bf16_f32 v82, v68, v69
    v_cvt_pk_bf16_f32 v83, v70, v71
    v_exp_f32 v72, v72
    s_nop 0
    v_mfma_f32_16x16x32_bf16 v[128:131], a[176:179], v[80:83], v[128:131]
    v_mfma_f32_16x16x32_bf16 v[132:135], a[180:183], v[80:83], v[132:135]
    v_mfma_f32_16x16x32_bf16 v[136:139], a[184:187], v[80:83], v[136:139]
    buffer_load_dwordx4 v19, s[84:87], s75 offen offset:1024 nt lds
    v_mfma_f32_16x16x32_bf16 v[140:143], a[188:191], v[80:83], v[140:143]
    v_mfma_f32_16x16x32_bf16 v[144:147], a[192:195], v[80:83], v[144:147]
    v_mfma_f32_16x16x32_bf16 v[148:151], a[196:199], v[80:83], v[148:151]
    v_mfma_f32_16x16x32_bf16 v[152:155], a[200:203], v[80:83], v[152:155]
    v_mfma_f32_16x16x32_bf16 v[156:159], a[204:207], v[80:83], v[156:159]
    v_exp_f32 v73, v73
    v_exp_f32 v74, v74
    v_exp_f32 v75, v75
    v_exp_f32 v76, v76
    v_cvt_pk_bf16_f32 v84, v72, v73
    v_cvt_pk_bf16_f32 v85, v74, v75
    v_mfma_f32_16x16x32_bf16 v[20:23], a[228:231], v[80:83], v[20:23]
    s_waitcnt vmcnt(22) lgkmcnt(0)
    v_mfma_f32_16x16x32_bf16 v[64:67], a[112:115], a[48:51], v[52:55]
    s_barrier
    v_mfma_f32_16x16x32_bf16 v[64:67], a[116:119], a[52:55], v[64:67]
    ds_read_b128 a[80:83], v4 offset:49152
    v_mfma_f32_16x16x32_bf16 v[64:67], a[120:123], a[56:59], v[64:67]
    v_mfma_f32_16x16x32_bf16 v[64:67], a[124:127], a[60:63], v[64:67]
    ds_read_b128 a[84:87], v5 offset:49152
    v_mfma_f32_16x16x32_bf16 v[68:71], a[128:131], a[48:51], v[52:55]
    v_mfma_f32_16x16x32_bf16 v[68:71], a[132:135], a[52:55], v[68:71]
    v_mfma_f32_16x16x32_bf16 v[68:71], a[136:139], a[56:59], v[68:71]
    ds_read_b128 a[88:91], v6 offset:49152
    v_mfma_f32_16x16x32_bf16 v[68:71], a[140:143], a[60:63], v[68:71]
    v_exp_f32 v77, v77
    v_exp_f32 v78, v78
    v_exp_f32 v79, v79
    v_cvt_pk_bf16_f32 v86, v76, v77
    v_cvt_pk_bf16_f32 v87, v78, v79
    v_exp_f32 v64, v64
    s_nop 0
    v_mfma_f32_16x16x32_bf16 v[160:163], a[176:179], v[84:87], v[160:163]
    v_mfma_f32_16x16x32_bf16 v[164:167], a[180:183], v[84:87], v[164:167]
    ds_read_b128 a[92:95], v7 offset:49152
    v_mfma_f32_16x16x32_bf16 v[168:171], a[184:187], v[84:87], v[168:171]
    v_mfma_f32_16x16x32_bf16 v[172:175], a[188:191], v[84:87], v[172:175]
    v_mfma_f32_16x16x32_bf16 v[176:179], a[192:195], v[84:87], v[176:179]
    ds_read_b128 a[96:99], v4 offset:53248
    v_mfma_f32_16x16x32_bf16 v[180:183], a[196:199], v[84:87], v[180:183]
    v_mfma_f32_16x16x32_bf16 v[184:187], a[200:203], v[84:87], v[184:187]
    v_mfma_f32_16x16x32_bf16 v[188:191], a[204:207], v[84:87], v[188:191]
    s_add_u32 s75, s60, 81920
    v_exp_f32 v65, v65
    v_exp_f32 v66, v66
    v_exp_f32 v67, v67
    v_exp_f32 v68, v68
    v_cvt_pk_bf16_f32 v80, v64, v65
    v_cvt_pk_bf16_f32 v81, v66, v67
    v_mfma_f32_16x16x32_bf16 v[36:39], a[228:231], v[84:87], v[36:39]
    s_waitcnt vmcnt(13) lgkmcnt(0)
    s_add_u32 m0, s63, 0
    ds_read_b128 a[100:103], v5 offset:53248
    v_mfma_f32_16x16x32_bf16 v[72:75], a[112:115], a[64:67], v[56:59]
    s_barrier
    buffer_load_dwordx4 v28, s[32:35], s75 offen offset:0 lds
    v_mfma_f32_16x16x32_bf16 v[72:75], a[116:119], a[68:71], v[72:75]
    ds_read_b64_tr_b16 a[144:145], v8 offset:16384
    v_mfma_f32_16x16x32_bf16 v[72:75], a[120:123], a[72:75], v[72:75]
    ds_read_b128 a[104:107], v6 offset:53248
    v_mfma_f32_16x16x32_bf16 v[72:75], a[124:127], a[76:79], v[72:75]
    ds_read_b64_tr_b16 a[146:147], v8 offset:20480
    v_mfma_f32_16x16x32_bf16 v[76:79], a[128:131], a[64:67], v[56:59]
    buffer_load_dwordx4 v29, s[32:35], s75 offen offset:1024 lds
    v_mfma_f32_16x16x32_bf16 v[76:79], a[132:135], a[68:71], v[76:79]
    v_mfma_f32_16x16x32_bf16 v[76:79], a[136:139], a[72:75], v[76:79]
    ds_read_b128 a[108:111], v7 offset:53248
    v_mfma_f32_16x16x32_bf16 v[76:79], a[140:143], a[76:79], v[76:79]
    v_exp_f32 v69, v69
    v_exp_f32 v70, v70
    v_exp_f32 v71, v71
    v_cvt_pk_bf16_f32 v82, v68, v69
    v_cvt_pk_bf16_f32 v83, v70, v71
    v_exp_f32 v72, v72
    s_nop 0
    v_mfma_f32_16x16x32_bf16 v[192:195], a[176:179], v[80:83], v[192:195]
    buffer_load_dwordx4 v30, s[32:35], s75 offen offset:2048 lds
    v_mfma_f32_16x16x32_bf16 v[196:199], a[180:183], v[80:83], v[196:199]
    ds_read_b64_tr_b16 a[148:149], v9 offset:16384
    v_mfma_f32_16x16x32_bf16 v[200:203], a[184:187], v[80:83], v[200:203]
    ds_read_b64_tr_b16 a[150:151], v9 offset:20480
    v_mfma_f32_16x16x32_bf16 v[204:207], a[188:191], v[80:83], v[204:207]
    v_mfma_f32_16x16x32_bf16 v[208:211], a[192:195], v[80:83], v[208:211]
    buffer_load_dwordx4 v31, s[32:35], s75 offen offset:3072 lds
    v_mfma_f32_16x16x32_bf16 v[212:215], a[196:199], v[80:83], v[212:215]
    ds_read_b64_tr_b16 a[152:153], v10 offset:16384
    v_mfma_f32_16x16x32_bf16 v[216:219], a[200:203], v[80:83], v[216:219]
    v_mfma_f32_16x16x32_bf16 v[220:223], a[204:207], v[80:83], v[220:223]
    s_add_u32 m0, s63, 4096
    v_exp_f32 v73, v73
    v_exp_f32 v74, v74
    v_exp_f32 v75, v75
    v_exp_f32 v76, v76
    v_cvt_pk_bf16_f32 v84, v72, v73
    v_cvt_pk_bf16_f32 v85, v74, v75
    v_mfma_f32_16x16x32_bf16 v[24:27], a[228:231], v[80:83], v[24:27]
    s_waitcnt lgkmcnt(0)
    buffer_load_dwordx4 v88, s[32:35], s75 offen lds
    v_mfma_f32_16x16x32_bf16 v[64:67], a[80:83], a[0:3], v[40:43]
    ds_read_b64_tr_b16 a[154:155], v10 offset:20480
    v_mfma_f32_16x16x32_bf16 v[64:67], a[84:87], a[4:7], v[64:67]
    ds_read_b64_tr_b16 a[156:157], v11 offset:16384
    v_mfma_f32_16x16x32_bf16 v[64:67], a[88:91], a[8:11], v[64:67]
    v_mfma_f32_16x16x32_bf16 v[64:67], a[92:95], a[12:15], v[64:67]
    ds_read_b64_tr_b16 a[158:159], v11 offset:20480
    v_mfma_f32_16x16x32_bf16 v[68:71], a[96:99], a[0:3], v[40:43]
    v_mfma_f32_16x16x32_bf16 v[68:71], a[100:103], a[4:7], v[68:71]
    ds_read_b64_tr_b16 a[160:161], v12 offset:16384
    v_mfma_f32_16x16x32_bf16 v[68:71], a[104:107], a[8:11], v[68:71]
    ds_read_b64_tr_b16 a[162:163], v12 offset:20480
    v_mfma_f32_16x16x32_bf16 v[68:71], a[108:111], a[12:15], v[68:71]
    v_exp_f32 v77, v77
    v_exp_f32 v78, v78
    v_exp_f32 v79, v79
    v_cvt_pk_bf16_f32 v86, v76, v77
    v_cvt_pk_bf16_f32 v87, v78, v79
    v_exp_f32 v64, v64
    s_nop 0
    v_mfma_f32_16x16x32_bf16 v[224:227], a[176:179], v[84:87], v[224:227]
    v_mfma_f32_16x16x32_bf16 v[228:231], a[180:183], v[84:87], v[228:231]
    ds_read_b64_tr_b16 a[164:165], v13 offset:16384
    v_mfma_f32_16x16x32_bf16 v[232:235], a[184:187], v[84:87], v[232:235]
    ds_read_b64_tr_b16 a[166:167], v13 offset:20480
    v_mfma_f32_16x16x32_bf16 v[236:239], a[188:191], v[84:87], v[236:239]
    v_mfma_f32_16x16x32_bf16 v[240:243], a[192:195], v[84:87], v[240:243]
    ds_read_b64_tr_b16 a[168:169], v14 offset:16384
    v_mfma_f32_16x16x32_bf16 v[244:247], a[196:199], v[84:87], v[244:247]
    v_mfma_f32_16x16x32_bf16 v[248:251], a[200:203], v[84:87], v[248:251]
    ds_read_b64_tr_b16 a[170:171], v14 offset:20480
    v_mfma_f32_16x16x32_bf16 v[252:255], a[204:207], v[84:87], v[252:255]
    v_exp_f32 v65, v65
    v_exp_f32 v66, v66
    v_exp_f32 v67, v67
    v_exp_f32 v68, v68
    v_cvt_pk_bf16_f32 v80, v64, v65
    v_cvt_pk_bf16_f32 v81, v66, v67
    v_mfma_f32_16x16x32_bf16 v[60:63], a[228:231], v[84:87], v[60:63]
    ds_read_b64_tr_b16 a[172:173], v15 offset:16384
    v_mfma_f32_16x16x32_bf16 v[72:75], a[80:83], a[16:19], v[44:47]
    v_mfma_f32_16x16x32_bf16 v[72:75], a[84:87], a[20:23], v[72:75]
    ds_read_b64_tr_b16 a[174:175], v15 offset:20480
    v_mfma_f32_16x16x32_bf16 v[72:75], a[88:91], a[24:27], v[72:75]
    v_mfma_f32_16x16x32_bf16 v[72:75], a[92:95], a[28:31], v[72:75]
    v_mfma_f32_16x16x32_bf16 v[76:79], a[96:99], a[16:19], v[44:47]
    v_mfma_f32_16x16x32_bf16 v[76:79], a[100:103], a[20:23], v[76:79]
    v_mfma_f32_16x16x32_bf16 v[76:79], a[104:107], a[24:27], v[76:79]
    v_mfma_f32_16x16x32_bf16 v[76:79], a[108:111], a[28:31], v[76:79]
    s_waitcnt lgkmcnt(0)
    v_exp_f32 v69, v69
    v_exp_f32 v70, v70
    v_exp_f32 v71, v71
    v_cvt_pk_bf16_f32 v82, v68, v69
    v_cvt_pk_bf16_f32 v83, v70, v71
    v_exp_f32 v72, v72
    s_nop 0
    v_mfma_f32_16x16x32_bf16 v[96:99], a[144:147], v[80:83], v[96:99]
    v_mfma_f32_16x16x32_bf16 v[100:103], a[148:151], v[80:83], v[100:103]
    v_mfma_f32_16x16x32_bf16 v[104:107], a[152:155], v[80:83], v[104:107]
    v_mfma_f32_16x16x32_bf16 v[108:111], a[156:159], v[80:83], v[108:111]
    v_mfma_f32_16x16x32_bf16 v[112:115], a[160:163], v[80:83], v[112:115]
    v_mfma_f32_16x16x32_bf16 v[116:119], a[164:167], v[80:83], v[116:119]
    v_mfma_f32_16x16x32_bf16 v[120:123], a[168:171], v[80:83], v[120:123]
    v_mfma_f32_16x16x32_bf16 v[124:127], a[172:175], v[80:83], v[124:127]
    v_exp_f32 v73, v73
    v_exp_f32 v74, v74
    v_exp_f32 v75, v75
    v_exp_f32 v76, v76
    v_cvt_pk_bf16_f32 v84, v72, v73
    v_cvt_pk_bf16_f32 v85, v74, v75
    v_mfma_f32_16x16x32_bf16 v[32:35], a[228:231], v[80:83], v[32:35]
    v_mfma_f32_16x16x32_bf16 v[64:67], a[80:83], a[32:35], v[48:51]
    v_mfma_f32_16x16x32_bf16 v[64:67], a[84:87], a[36:39], v[64:67]
    v_mfma_f32_16x16x32_bf16 v[64:67], a[88:91], a[40:43], v[64:67]
    v_mfma_f32_16x16x32_bf16 v[64:67], a[92:95], a[44:47], v[64:67]
    v_mfma_f32_16x16x32_bf16 v[68:71], a[96:99], a[32:35], v[48:51]
    v_mfma_f32_16x16x32_bf16 v[68:71], a[100:103], a[36:39], v[68:71]
    v_mfma_f32_16x16x32_bf16 v[68:71], a[104:107], a[40:43], v[68:71]
    v_mfma_f32_16x16x32_bf16 v[68:71], a[108:111], a[44:47], v[68:71]
    v_exp_f32 v77, v77
    v_exp_f32 v78, v78
    v_exp_f32 v79, v79
    v_cvt_pk_bf16_f32 v86, v76, v77
    v_cvt_pk_bf16_f32 v87, v78, v79
    v_exp_f32 v64, v64
    s_nop 0
    v_mfma_f32_16x16x32_bf16 v[128:131], a[144:147], v[84:87], v[128:131]
    v_mfma_f32_16x16x32_bf16 v[132:135], a[148:151], v[84:87], v[132:135]
    v_mfma_f32_16x16x32_bf16 v[136:139], a[152:155], v[84:87], v[136:139]
    v_mfma_f32_16x16x32_bf16 v[140:143], a[156:159], v[84:87], v[140:143]
    v_mfma_f32_16x16x32_bf16 v[144:147], a[160:163], v[84:87], v[144:147]
    v_mfma_f32_16x16x32_bf16 v[148:151], a[164:167], v[84:87], v[148:151]
    v_mfma_f32_16x16x32_bf16 v[152:155], a[168:171], v[84:87], v[152:155]
    v_mfma_f32_16x16x32_bf16 v[156:159], a[172:175], v[84:87], v[156:159]
    v_exp_f32 v65, v65
    v_exp_f32 v66, v66
    v_exp_f32 v67, v67
    v_exp_f32 v68, v68
    v_cvt_pk_bf16_f32 v80, v64, v65
    v_cvt_pk_bf16_f32 v81, v66, v67
    v_mfma_f32_16x16x32_bf16 v[20:23], a[228:231], v[84:87], v[20:23]
    s_waitcnt vmcnt(14) lgkmcnt(0)
    s_add_u32 s75, s60, 122880
    v_mfma_f32_16x16x32_bf16 v[72:75], a[80:83], a[48:51], v[52:55]
    s_barrier
    s_add_u32 m0, s63, 10240
    v_mfma_f32_16x16x32_bf16 v[72:75], a[84:87], a[52:55], v[72:75]
    buffer_load_dwordx4 v28, s[32:35], s75 offen offset:0 lds
    v_mfma_f32_16x16x32_bf16 v[72:75], a[88:91], a[56:59], v[72:75]
    ds_read_b128 a[112:115], v4 offset:16384
    v_mfma_f32_16x16x32_bf16 v[72:75], a[92:95], a[60:63], v[72:75]
    v_mfma_f32_16x16x32_bf16 v[76:79], a[96:99], a[48:51], v[52:55]
    ds_read_b128 a[116:119], v5 offset:16384
    v_mfma_f32_16x16x32_bf16 v[76:79], a[100:103], a[52:55], v[76:79]
    buffer_load_dwordx4 v29, s[32:35], s75 offen offset:1024 lds
    v_mfma_f32_16x16x32_bf16 v[76:79], a[104:107], a[56:59], v[76:79]
    v_mfma_f32_16x16x32_bf16 v[76:79], a[108:111], a[60:63], v[76:79]
    v_exp_f32 v69, v69
    v_exp_f32 v70, v70
    v_exp_f32 v71, v71
    v_cvt_pk_bf16_f32 v82, v68, v69
    v_cvt_pk_bf16_f32 v83, v70, v71
    v_exp_f32 v72, v72
    s_nop 0
    v_mfma_f32_16x16x32_bf16 v[160:163], a[144:147], v[80:83], v[160:163]
    ds_read_b128 a[120:123], v6 offset:16384
    v_mfma_f32_16x16x32_bf16 v[164:167], a[148:151], v[80:83], v[164:167]
    buffer_load_dwordx4 v30, s[32:35], s75 offen offset:2048 lds
    v_mfma_f32_16x16x32_bf16 v[168:171], a[152:155], v[80:83], v[168:171]
    v_mfma_f32_16x16x32_bf16 v[172:175], a[156:159], v[80:83], v[172:175]
    v_mfma_f32_16x16x32_bf16 v[176:179], a[160:163], v[80:83], v[176:179]
    ds_read_b128 a[124:127], v7 offset:16384
    v_mfma_f32_16x16x32_bf16 v[180:183], a[164:167], v[80:83], v[180:183]
    buffer_load_dwordx4 v31, s[32:35], s75 offen offset:3072 lds
    v_mfma_f32_16x16x32_bf16 v[184:187], a[168:171], v[80:83], v[184:187]
    v_mfma_f32_16x16x32_bf16 v[188:191], a[172:175], v[80:83], v[188:191]
    v_exp_f32 v73, v73
    v_exp_f32 v74, v74
    v_exp_f32 v75, v75
    v_exp_f32 v76, v76
    v_cvt_pk_bf16_f32 v84, v72, v73
    v_cvt_pk_bf16_f32 v85, v74, v75
    v_mfma_f32_16x16x32_bf16 v[36:39], a[228:231], v[80:83], v[36:39]
    s_waitcnt vmcnt(9) lgkmcnt(0)
    s_add_u32 m0, s63, 14336
    ds_read_b128 a[128:131], v4 offset:20480
    v_mfma_f32_16x16x32_bf16 v[64:67], a[80:83], a[64:67], v[56:59]
    s_barrier
    buffer_load_dwordx4 v88, s[32:35], s75 offen lds
    v_mfma_f32_16x16x32_bf16 v[64:67], a[84:87], a[68:71], v[64:67]
    ds_read_b64_tr_b16 a[176:177], v8 offset:49152
    v_mfma_f32_16x16x32_bf16 v[64:67], a[88:91], a[72:75], v[64:67]
    ds_read_b128 a[132:135], v5 offset:20480
    v_mfma_f32_16x16x32_bf16 v[64:67], a[92:95], a[76:79], v[64:67]
    ds_read_b64_tr_b16 a[178:179], v8 offset:53248
    v_mfma_f32_16x16x32_bf16 v[68:71], a[96:99], a[64:67], v[56:59]
    ds_read_b64_tr_b16 a[180:181], v9 offset:49152
    v_mfma_f32_16x16x32_bf16 v[68:71], a[100:103], a[68:71], v[68:71]
    ds_read_b128 a[136:139], v6 offset:20480
    v_mfma_f32_16x16x32_bf16 v[68:71], a[104:107], a[72:75], v[68:71]
    ds_read_b64_tr_b16 a[182:183], v9 offset:53248
    v_mfma_f32_16x16x32_bf16 v[68:71], a[108:111], a[76:79], v[68:71]
    v_exp_f32 v77, v77
    v_exp_f32 v78, v78
    v_exp_f32 v79, v79
    v_cvt_pk_bf16_f32 v86, v76, v77
    v_cvt_pk_bf16_f32 v87, v78, v79
    v_exp_f32 v64, v64
    s_nop 0
    v_mfma_f32_16x16x32_bf16 v[192:195], a[144:147], v[84:87], v[192:195]
    ds_read_b128 a[140:143], v7 offset:20480
    v_mfma_f32_16x16x32_bf16 v[196:199], a[148:151], v[84:87], v[196:199]
    ds_read_b64_tr_b16 a[184:185], v10 offset:49152
    v_mfma_f32_16x16x32_bf16 v[200:203], a[152:155], v[84:87], v[200:203]
    ds_read_b64_tr_b16 a[186:187], v10 offset:53248
    v_mfma_f32_16x16x32_bf16 v[204:207], a[156:159], v[84:87], v[204:207]
    ds_read_b64_tr_b16 a[188:189], v11 offset:49152
    v_mfma_f32_16x16x32_bf16 v[208:211], a[160:163], v[84:87], v[208:211]
    ds_read_b64_tr_b16 a[190:191], v11 offset:53248
    v_mfma_f32_16x16x32_bf16 v[212:215], a[164:167], v[84:87], v[212:215]
    ds_read_b64_tr_b16 a[192:193], v12 offset:49152
    v_mfma_f32_16x16x32_bf16 v[216:219], a[168:171], v[84:87], v[216:219]
    ds_read_b64_tr_b16 a[194:195], v12 offset:53248
    v_mfma_f32_16x16x32_bf16 v[220:223], a[172:175], v[84:87], v[220:223]
    v_exp_f32 v65, v65
    v_exp_f32 v66, v66
    v_exp_f32 v67, v67
    v_exp_f32 v68, v68
    v_cvt_pk_bf16_f32 v80, v64, v65
    v_cvt_pk_bf16_f32 v81, v66, v67
    v_mfma_f32_16x16x32_bf16 v[24:27], a[228:231], v[84:87], v[24:27]
    s_waitcnt lgkmcnt(0)
    ds_read_b64_tr_b16 a[196:197], v13 offset:49152
    v_mfma_f32_16x16x32_bf16 v[72:75], a[112:115], a[0:3], v[40:43]
    ds_read_b64_tr_b16 a[198:199], v13 offset:53248
    s_lshl_b32 s66, s41, 4
    s_add_u32 s66, s66, s42
    s_lshl_b32 s66, s66, 2
    s_add_u32 s66, s66, s40
    s_mul_i32 s66, s66, 20480
    s_add_u32 s67, s66, 5120
    s_add_u32 s68, s66, 10240
    s_add_u32 s69, s66, 15360
    v_mfma_f32_16x16x32_bf16 v[72:75], a[116:119], a[4:7], v[72:75]
    v_exp_f32 v69, v69
    v_mfma_f32_16x16x32_bf16 v[72:75], a[120:123], a[8:11], v[72:75]
    v_cvt_pk_bf16_f32 v82, v68, v69
    v_mfma_f32_16x16x32_bf16 v[72:75], a[124:127], a[12:15], v[72:75]
    v_exp_f32 v70, v70
    v_mfma_f32_16x16x32_bf16 v[76:79], a[128:131], a[0:3], v[40:43]
    ds_read_b64_tr_b16 a[200:201], v14 offset:49152
    v_mfma_f32_16x16x32_bf16 v[76:79], a[132:135], a[4:7], v[76:79]
    v_exp_f32 v71, v71
    v_mfma_f32_16x16x32_bf16 v[76:79], a[136:139], a[8:11], v[76:79]
    v_cvt_pk_bf16_f32 v83, v70, v71
    v_mfma_f32_16x16x32_bf16 v[76:79], a[140:143], a[12:15], v[76:79]
    v_exp_f32 v72, v72
    v_mfma_f32_16x16x32_bf16 v[224:227], a[144:147], v[80:83], v[224:227]
    ds_read_b64_tr_b16 a[202:203], v14 offset:53248
    v_mfma_f32_16x16x32_bf16 v[228:231], a[148:151], v[80:83], v[228:231]
    v_exp_f32 v73, v73
    v_mfma_f32_16x16x32_bf16 v[232:235], a[152:155], v[80:83], v[232:235]
    v_cvt_pk_bf16_f32 v84, v72, v73
    v_mfma_f32_16x16x32_bf16 v[236:239], a[156:159], v[80:83], v[236:239]
    v_exp_f32 v74, v74
    v_mfma_f32_16x16x32_bf16 v[240:243], a[160:163], v[80:83], v[240:243]
    ds_read_b64_tr_b16 a[204:205], v15 offset:49152
    v_mfma_f32_16x16x32_bf16 v[244:247], a[164:167], v[80:83], v[244:247]
    v_exp_f32 v75, v75
    v_mfma_f32_16x16x32_bf16 v[248:251], a[168:171], v[80:83], v[248:251]
    v_cvt_pk_bf16_f32 v85, v74, v75
    v_mfma_f32_16x16x32_bf16 v[252:255], a[172:175], v[80:83], v[252:255]
    v_exp_f32 v76, v76
    v_mfma_f32_16x16x32_bf16 v[60:63], a[228:231], v[80:83], v[60:63]
    ds_read_b64_tr_b16 a[206:207], v15 offset:53248
    v_mfma_f32_16x16x32_bf16 v[64:67], a[112:115], a[16:19], v[44:47]
    v_mfma_f32_16x16x32_bf16 v[64:67], a[116:119], a[20:23], v[64:67]
    v_exp_f32 v77, v77
    v_mfma_f32_16x16x32_bf16 v[64:67], a[120:123], a[24:27], v[64:67]
    v_cvt_pk_bf16_f32 v86, v76, v77
    v_mfma_f32_16x16x32_bf16 v[64:67], a[124:127], a[28:31], v[64:67]
    v_exp_f32 v78, v78
    v_mfma_f32_16x16x32_bf16 v[68:71], a[128:131], a[16:19], v[44:47]
    v_mfma_f32_16x16x32_bf16 v[68:71], a[132:135], a[20:23], v[68:71]
    v_exp_f32 v79, v79
    v_mfma_f32_16x16x32_bf16 v[68:71], a[136:139], a[24:27], v[68:71]
    v_cvt_pk_bf16_f32 v87, v78, v79
    v_mfma_f32_16x16x32_bf16 v[68:71], a[140:143], a[28:31], v[68:71]
    s_waitcnt lgkmcnt(0)
    v_exp_f32 v64, v64
    v_mfma_f32_16x16x32_bf16 v[32:35], a[228:231], v[84:87], v[32:35]
    v_mfma_f32_16x16x32_bf16 v[96:99], a[176:179], v[84:87], v[96:99]
    v_exp_f32 v65, v65
    v_mfma_f32_16x16x32_bf16 v[100:103], a[180:183], v[84:87], v[100:103]
    v_cvt_pk_bf16_f32 v80, v64, v65
    v_mfma_f32_16x16x32_bf16 v[104:107], a[184:187], v[84:87], v[104:107]
    v_exp_f32 v66, v66
    v_mfma_f32_16x16x32_bf16 v[108:111], a[188:191], v[84:87], v[108:111]
    v_mfma_f32_16x16x32_bf16 v[112:115], a[192:195], v[84:87], v[112:115]
    v_exp_f32 v67, v67
    v_mfma_f32_16x16x32_bf16 v[116:119], a[196:199], v[84:87], v[116:119]
    v_cvt_pk_bf16_f32 v81, v66, v67
    v_mfma_f32_16x16x32_bf16 v[120:123], a[200:203], v[84:87], v[120:123]
    s_add_u32 s75, s61, 0
    v_exp_f32 v68, v68
    v_mfma_f32_16x16x32_bf16 v[124:127], a[204:207], v[84:87], v[124:127]
    s_add_u32 m0, s63, 20480
    v_mfma_f32_16x16x32_bf16 v[72:75], a[112:115], a[32:35], v[48:51]
    buffer_load_dwordx4 v28, s[32:35], s75 offen offset:0 lds
    v_mfma_f32_16x16x32_bf16 v[72:75], a[116:119], a[36:39], v[72:75]
    v_exp_f32 v69, v69
    v_rcp_f32 v34, v32
    v_mfma_f32_16x16x32_bf16 v[72:75], a[120:123], a[40:43], v[72:75]
    v_cvt_pk_bf16_f32 v82, v68, v69
    v_mfma_f32_16x16x32_bf16 v[72:75], a[124:127], a[44:47], v[72:75]
    v_exp_f32 v70, v70
    v_pk_mul_f32 v[96:97], v[96:97], v[34:35] op_sel_hi:[1,0]
    v_pk_mul_f32 v[98:99], v[98:99], v[34:35] op_sel_hi:[1,0]
    v_pk_mul_f32 v[100:101], v[100:101], v[34:35] op_sel_hi:[1,0]
    v_pk_mul_f32 v[102:103], v[102:103], v[34:35] op_sel_hi:[1,0]
    v_cvt_pk_bf16_f32 v96, v96, v97
    v_cvt_pk_bf16_f32 v97, v98, v99
    v_cvt_pk_bf16_f32 v98, v100, v101
    v_cvt_pk_bf16_f32 v99, v102, v103
    buffer_store_dwordx4 v[96:99], v90, s[36:39], s66 offen offset:0 sc1
    v_mfma_f32_16x16x32_bf16 v[76:79], a[128:131], a[32:35], v[48:51]
    buffer_load_dwordx4 v29, s[32:35], s75 offen offset:1024 lds
    v_mfma_f32_16x16x32_bf16 v[76:79], a[132:135], a[36:39], v[76:79]
    v_exp_f32 v71, v71
    v_mfma_f32_16x16x32_bf16 v[76:79], a[136:139], a[40:43], v[76:79]
    v_cvt_pk_bf16_f32 v83, v70, v71
    v_mfma_f32_16x16x32_bf16 v[76:79], a[140:143], a[44:47], v[76:79]
    v_exp_f32 v72, v72
    v_pk_mul_f32 v[104:105], v[104:105], v[34:35] op_sel_hi:[1,0]
    v_pk_mul_f32 v[106:107], v[106:107], v[34:35] op_sel_hi:[1,0]
    v_pk_mul_f32 v[108:109], v[108:109], v[34:35] op_sel_hi:[1,0]
    v_pk_mul_f32 v[110:111], v[110:111], v[34:35] op_sel_hi:[1,0]
    v_cvt_pk_bf16_f32 v104, v104, v105
    v_cvt_pk_bf16_f32 v105, v106, v107
    v_cvt_pk_bf16_f32 v106, v108, v109
    v_cvt_pk_bf16_f32 v107, v110, v111
    buffer_store_dwordx4 v[104:107], v90, s[36:39], s67 offen offset:0 sc1
    v_mfma_f32_16x16x32_bf16 v[20:23], a[228:231], v[80:83], v[20:23]
    buffer_load_dwordx4 v30, s[32:35], s75 offen offset:2048 lds
    v_mfma_f32_16x16x32_bf16 v[128:131], a[176:179], v[80:83], v[128:131]
    v_exp_f32 v73, v73
    v_mfma_f32_16x16x32_bf16 v[132:135], a[180:183], v[80:83], v[132:135]
    v_cvt_pk_bf16_f32 v84, v72, v73
    v_mfma_f32_16x16x32_bf16 v[136:139], a[184:187], v[80:83], v[136:139]
    v_exp_f32 v74, v74
    v_pk_mul_f32 v[112:113], v[112:113], v[34:35] op_sel_hi:[1,0]
    v_pk_mul_f32 v[114:115], v[114:115], v[34:35] op_sel_hi:[1,0]
    v_pk_mul_f32 v[116:117], v[116:117], v[34:35] op_sel_hi:[1,0]
    v_pk_mul_f32 v[118:119], v[118:119], v[34:35] op_sel_hi:[1,0]
    v_cvt_pk_bf16_f32 v112, v112, v113
    v_cvt_pk_bf16_f32 v113, v114, v115
    v_cvt_pk_bf16_f32 v114, v116, v117
    v_cvt_pk_bf16_f32 v115, v118, v119
    buffer_store_dwordx4 v[112:115], v90, s[36:39], s68 offen offset:0 sc1
    v_mfma_f32_16x16x32_bf16 v[140:143], a[188:191], v[80:83], v[140:143]
    buffer_load_dwordx4 v31, s[32:35], s75 offen offset:3072 lds
    v_mfma_f32_16x16x32_bf16 v[144:147], a[192:195], v[80:83], v[144:147]
    v_exp_f32 v75, v75
    v_mfma_f32_16x16x32_bf16 v[148:151], a[196:199], v[80:83], v[148:151]
    v_cvt_pk_bf16_f32 v85, v74, v75
    v_mfma_f32_16x16x32_bf16 v[152:155], a[200:203], v[80:83], v[152:155]
    s_add_u32 m0, s63, 24576
    v_exp_f32 v76, v76
    v_mfma_f32_16x16x32_bf16 v[156:159], a[204:207], v[80:83], v[156:159]
    s_waitcnt lgkmcnt(0)
    buffer_load_dwordx4 v88, s[32:35], s75 offen lds
    v_pk_mul_f32 v[120:121], v[120:121], v[34:35] op_sel_hi:[1,0]
    v_pk_mul_f32 v[122:123], v[122:123], v[34:35] op_sel_hi:[1,0]
    v_pk_mul_f32 v[124:125], v[124:125], v[34:35] op_sel_hi:[1,0]
    v_pk_mul_f32 v[126:127], v[126:127], v[34:35] op_sel_hi:[1,0]
    v_cvt_pk_bf16_f32 v120, v120, v121
    v_cvt_pk_bf16_f32 v121, v122, v123
    v_cvt_pk_bf16_f32 v122, v124, v125
    v_cvt_pk_bf16_f32 v123, v126, v127
    buffer_store_dwordx4 v[120:123], v90, s[36:39], s69 offen offset:0 sc1
    v_mfma_f32_16x16x32_bf16 v[64:67], a[112:115], a[48:51], v[52:55]
    s_barrier
    v_mfma_f32_16x16x32_bf16 v[64:67], a[116:119], a[52:55], v[64:67]
    v_exp_f32 v77, v77
    v_rcp_f32 v22, v20
    v_mfma_f32_16x16x32_bf16 v[64:67], a[120:123], a[56:59], v[64:67]
    v_cvt_pk_bf16_f32 v86, v76, v77
    v_mfma_f32_16x16x32_bf16 v[64:67], a[124:127], a[60:63], v[64:67]
    v_exp_f32 v78, v78
    v_pk_mul_f32 v[128:129], v[128:129], v[22:23] op_sel_hi:[1,0]
    v_pk_mul_f32 v[130:131], v[130:131], v[22:23] op_sel_hi:[1,0]
    v_pk_mul_f32 v[132:133], v[132:133], v[22:23] op_sel_hi:[1,0]
    v_pk_mul_f32 v[134:135], v[134:135], v[22:23] op_sel_hi:[1,0]
    v_cvt_pk_bf16_f32 v128, v128, v129
    v_cvt_pk_bf16_f32 v129, v130, v131
    v_cvt_pk_bf16_f32 v130, v132, v133
    v_cvt_pk_bf16_f32 v131, v134, v135
    buffer_store_dwordx4 v[128:131], v90, s[36:39], s66 offen offset:1024 sc1
    v_mfma_f32_16x16x32_bf16 v[68:71], a[128:131], a[48:51], v[52:55]
    v_mfma_f32_16x16x32_bf16 v[68:71], a[132:135], a[52:55], v[68:71]
    v_exp_f32 v79, v79
    v_mfma_f32_16x16x32_bf16 v[68:71], a[136:139], a[56:59], v[68:71]
    v_cvt_pk_bf16_f32 v87, v78, v79
    v_mfma_f32_16x16x32_bf16 v[68:71], a[140:143], a[60:63], v[68:71]
    v_exp_f32 v64, v64
    v_pk_mul_f32 v[136:137], v[136:137], v[22:23] op_sel_hi:[1,0]
    v_pk_mul_f32 v[138:139], v[138:139], v[22:23] op_sel_hi:[1,0]
    v_pk_mul_f32 v[140:141], v[140:141], v[22:23] op_sel_hi:[1,0]
    v_pk_mul_f32 v[142:143], v[142:143], v[22:23] op_sel_hi:[1,0]
    v_cvt_pk_bf16_f32 v136, v136, v137
    v_cvt_pk_bf16_f32 v137, v138, v139
    v_cvt_pk_bf16_f32 v138, v140, v141
    v_cvt_pk_bf16_f32 v139, v142, v143
    buffer_store_dwordx4 v[136:139], v90, s[36:39], s67 offen offset:1024 sc1
    v_mfma_f32_16x16x32_bf16 v[36:39], a[228:231], v[84:87], v[36:39]
    v_mfma_f32_16x16x32_bf16 v[160:163], a[176:179], v[84:87], v[160:163]
    v_exp_f32 v65, v65
    v_mfma_f32_16x16x32_bf16 v[164:167], a[180:183], v[84:87], v[164:167]
    v_cvt_pk_bf16_f32 v80, v64, v65
    v_mfma_f32_16x16x32_bf16 v[168:171], a[184:187], v[84:87], v[168:171]
    v_exp_f32 v66, v66
    v_pk_mul_f32 v[144:145], v[144:145], v[22:23] op_sel_hi:[1,0]
    v_pk_mul_f32 v[146:147], v[146:147], v[22:23] op_sel_hi:[1,0]
    v_pk_mul_f32 v[148:149], v[148:149], v[22:23] op_sel_hi:[1,0]
    v_pk_mul_f32 v[150:151], v[150:151], v[22:23] op_sel_hi:[1,0]
    v_cvt_pk_bf16_f32 v144, v144, v145
    v_cvt_pk_bf16_f32 v145, v146, v147
    v_cvt_pk_bf16_f32 v146, v148, v149
    v_cvt_pk_bf16_f32 v147, v150, v151
    buffer_store_dwordx4 v[144:147], v90, s[36:39], s68 offen offset:1024 sc1
    v_mfma_f32_16x16x32_bf16 v[172:175], a[188:191], v[84:87], v[172:175]
    v_mfma_f32_16x16x32_bf16 v[176:179], a[192:195], v[84:87], v[176:179]
    v_exp_f32 v67, v67
    v_mfma_f32_16x16x32_bf16 v[180:183], a[196:199], v[84:87], v[180:183]
    v_cvt_pk_bf16_f32 v81, v66, v67
    v_mfma_f32_16x16x32_bf16 v[184:187], a[200:203], v[84:87], v[184:187]
    v_exp_f32 v68, v68
    v_mfma_f32_16x16x32_bf16 v[188:191], a[204:207], v[84:87], v[188:191]
    v_pk_mul_f32 v[152:153], v[152:153], v[22:23] op_sel_hi:[1,0]
    v_pk_mul_f32 v[154:155], v[154:155], v[22:23] op_sel_hi:[1,0]
    v_pk_mul_f32 v[156:157], v[156:157], v[22:23] op_sel_hi:[1,0]
    v_pk_mul_f32 v[158:159], v[158:159], v[22:23] op_sel_hi:[1,0]
    v_cvt_pk_bf16_f32 v152, v152, v153
    v_cvt_pk_bf16_f32 v153, v154, v155
    v_cvt_pk_bf16_f32 v154, v156, v157
    v_cvt_pk_bf16_f32 v155, v158, v159
    buffer_store_dwordx4 v[152:155], v90, s[36:39], s69 offen offset:1024 sc1
    v_mfma_f32_16x16x32_bf16 v[72:75], a[112:115], a[64:67], v[56:59]
    v_mfma_f32_16x16x32_bf16 v[72:75], a[116:119], a[68:71], v[72:75]
    v_exp_f32 v69, v69
    v_rcp_f32 v38, v36
    v_mfma_f32_16x16x32_bf16 v[72:75], a[120:123], a[72:75], v[72:75]
    v_cvt_pk_bf16_f32 v82, v68, v69
    v_mfma_f32_16x16x32_bf16 v[72:75], a[124:127], a[76:79], v[72:75]
    v_exp_f32 v70, v70
    v_pk_mul_f32 v[160:161], v[160:161], v[38:39] op_sel_hi:[1,0]
    v_pk_mul_f32 v[162:163], v[162:163], v[38:39] op_sel_hi:[1,0]
    v_pk_mul_f32 v[164:165], v[164:165], v[38:39] op_sel_hi:[1,0]
    v_pk_mul_f32 v[166:167], v[166:167], v[38:39] op_sel_hi:[1,0]
    v_cvt_pk_bf16_f32 v160, v160, v161
    v_cvt_pk_bf16_f32 v161, v162, v163
    v_cvt_pk_bf16_f32 v162, v164, v165
    v_cvt_pk_bf16_f32 v163, v166, v167
    buffer_store_dwordx4 v[160:163], v90, s[36:39], s66 offen offset:2048 sc1
    v_mfma_f32_16x16x32_bf16 v[76:79], a[128:131], a[64:67], v[56:59]
    v_mfma_f32_16x16x32_bf16 v[76:79], a[132:135], a[68:71], v[76:79]
    v_exp_f32 v71, v71
    v_mfma_f32_16x16x32_bf16 v[76:79], a[136:139], a[72:75], v[76:79]
    v_cvt_pk_bf16_f32 v83, v70, v71
    v_mfma_f32_16x16x32_bf16 v[76:79], a[140:143], a[76:79], v[76:79]
    v_exp_f32 v72, v72
    v_pk_mul_f32 v[168:169], v[168:169], v[38:39] op_sel_hi:[1,0]
    v_pk_mul_f32 v[170:171], v[170:171], v[38:39] op_sel_hi:[1,0]
    v_pk_mul_f32 v[172:173], v[172:173], v[38:39] op_sel_hi:[1,0]
    v_pk_mul_f32 v[174:175], v[174:175], v[38:39] op_sel_hi:[1,0]
    v_cvt_pk_bf16_f32 v168, v168, v169
    v_cvt_pk_bf16_f32 v169, v170, v171
    v_cvt_pk_bf16_f32 v170, v172, v173
    v_cvt_pk_bf16_f32 v171, v174, v175
    buffer_store_dwordx4 v[168:171], v90, s[36:39], s67 offen offset:2048 sc1
    v_mfma_f32_16x16x32_bf16 v[24:27], a[228:231], v[80:83], v[24:27]
    v_mfma_f32_16x16x32_bf16 v[192:195], a[176:179], v[80:83], v[192:195]
    v_exp_f32 v73, v73
    v_mfma_f32_16x16x32_bf16 v[196:199], a[180:183], v[80:83], v[196:199]
    v_cvt_pk_bf16_f32 v84, v72, v73
    v_mfma_f32_16x16x32_bf16 v[200:203], a[184:187], v[80:83], v[200:203]
    v_exp_f32 v74, v74
    v_pk_mul_f32 v[176:177], v[176:177], v[38:39] op_sel_hi:[1,0]
    v_pk_mul_f32 v[178:179], v[178:179], v[38:39] op_sel_hi:[1,0]
    v_pk_mul_f32 v[180:181], v[180:181], v[38:39] op_sel_hi:[1,0]
    v_pk_mul_f32 v[182:183], v[182:183], v[38:39] op_sel_hi:[1,0]
    v_cvt_pk_bf16_f32 v176, v176, v177
    v_cvt_pk_bf16_f32 v177, v178, v179
    v_cvt_pk_bf16_f32 v178, v180, v181
    v_cvt_pk_bf16_f32 v179, v182, v183
    buffer_store_dwordx4 v[176:179], v90, s[36:39], s68 offen offset:2048 sc1
    v_mfma_f32_16x16x32_bf16 v[204:207], a[188:191], v[80:83], v[204:207]
    v_mfma_f32_16x16x32_bf16 v[208:211], a[192:195], v[80:83], v[208:211]
    v_exp_f32 v75, v75
    v_mfma_f32_16x16x32_bf16 v[212:215], a[196:199], v[80:83], v[212:215]
    v_cvt_pk_bf16_f32 v85, v74, v75
    v_mfma_f32_16x16x32_bf16 v[216:219], a[200:203], v[80:83], v[216:219]
    v_exp_f32 v76, v76
    v_mfma_f32_16x16x32_bf16 v[220:223], a[204:207], v[80:83], v[220:223]
    v_exp_f32 v77, v77
    v_exp_f32 v78, v78
    v_exp_f32 v79, v79
    v_cvt_pk_bf16_f32 v86, v76, v77
    v_cvt_pk_bf16_f32 v87, v78, v79
    v_pk_mul_f32 v[184:185], v[184:185], v[38:39] op_sel_hi:[1,0]
    v_pk_mul_f32 v[186:187], v[186:187], v[38:39] op_sel_hi:[1,0]
    v_pk_mul_f32 v[188:189], v[188:189], v[38:39] op_sel_hi:[1,0]
    v_pk_mul_f32 v[190:191], v[190:191], v[38:39] op_sel_hi:[1,0]
    v_cvt_pk_bf16_f32 v184, v184, v185
    v_cvt_pk_bf16_f32 v185, v186, v187
    v_cvt_pk_bf16_f32 v186, v188, v189
    v_cvt_pk_bf16_f32 v187, v190, v191
    buffer_store_dwordx4 v[184:187], v90, s[36:39], s69 offen offset:2048 sc1
    v_mfma_f32_16x16x32_bf16 v[60:63], a[228:231], v[84:87], v[60:63]
    v_mfma_f32_16x16x32_bf16 v[224:227], a[176:179], v[84:87], v[224:227]
    v_rcp_f32 v26, v24
    s_nop 0
    v_pk_mul_f32 v[192:193], v[192:193], v[26:27] op_sel_hi:[1,0]
    v_pk_mul_f32 v[194:195], v[194:195], v[26:27] op_sel_hi:[1,0]
    v_pk_mul_f32 v[196:197], v[196:197], v[26:27] op_sel_hi:[1,0]
    v_pk_mul_f32 v[198:199], v[198:199], v[26:27] op_sel_hi:[1,0]
    v_cvt_pk_bf16_f32 v192, v192, v193
    v_cvt_pk_bf16_f32 v193, v194, v195
    v_cvt_pk_bf16_f32 v194, v196, v197
    v_cvt_pk_bf16_f32 v195, v198, v199
    buffer_store_dwordx4 v[192:195], v90, s[36:39], s66 offen offset:3072 sc1
    v_mfma_f32_16x16x32_bf16 v[228:231], a[180:183], v[84:87], v[228:231]
    v_mfma_f32_16x16x32_bf16 v[232:235], a[184:187], v[84:87], v[232:235]
    v_pk_mul_f32 v[200:201], v[200:201], v[26:27] op_sel_hi:[1,0]
    v_pk_mul_f32 v[202:203], v[202:203], v[26:27] op_sel_hi:[1,0]
    v_pk_mul_f32 v[204:205], v[204:205], v[26:27] op_sel_hi:[1,0]
    v_pk_mul_f32 v[206:207], v[206:207], v[26:27] op_sel_hi:[1,0]
    v_cvt_pk_bf16_f32 v200, v200, v201
    v_cvt_pk_bf16_f32 v201, v202, v203
    v_cvt_pk_bf16_f32 v202, v204, v205
    v_cvt_pk_bf16_f32 v203, v206, v207
    buffer_store_dwordx4 v[200:203], v90, s[36:39], s67 offen offset:3072 sc1
    v_mfma_f32_16x16x32_bf16 v[236:239], a[188:191], v[84:87], v[236:239]
    v_mfma_f32_16x16x32_bf16 v[240:243], a[192:195], v[84:87], v[240:243]
    v_pk_mul_f32 v[208:209], v[208:209], v[26:27] op_sel_hi:[1,0]
    v_pk_mul_f32 v[210:211], v[210:211], v[26:27] op_sel_hi:[1,0]
    v_pk_mul_f32 v[212:213], v[212:213], v[26:27] op_sel_hi:[1,0]
    v_pk_mul_f32 v[214:215], v[214:215], v[26:27] op_sel_hi:[1,0]
    v_cvt_pk_bf16_f32 v208, v208, v209
    v_cvt_pk_bf16_f32 v209, v210, v211
    v_cvt_pk_bf16_f32 v210, v212, v213
    v_cvt_pk_bf16_f32 v211, v214, v215
    buffer_store_dwordx4 v[208:211], v90, s[36:39], s68 offen offset:3072 sc1
    v_mfma_f32_16x16x32_bf16 v[244:247], a[196:199], v[84:87], v[244:247]
    v_mfma_f32_16x16x32_bf16 v[248:251], a[200:203], v[84:87], v[248:251]
    v_mfma_f32_16x16x32_bf16 v[252:255], a[204:207], v[84:87], v[252:255]
    v_pk_mul_f32 v[216:217], v[216:217], v[26:27] op_sel_hi:[1,0]
    v_pk_mul_f32 v[218:219], v[218:219], v[26:27] op_sel_hi:[1,0]
    v_pk_mul_f32 v[220:221], v[220:221], v[26:27] op_sel_hi:[1,0]
    v_pk_mul_f32 v[222:223], v[222:223], v[26:27] op_sel_hi:[1,0]
    v_cvt_pk_bf16_f32 v216, v216, v217
    v_cvt_pk_bf16_f32 v217, v218, v219
    v_cvt_pk_bf16_f32 v218, v220, v221
    v_cvt_pk_bf16_f32 v219, v222, v223
    buffer_store_dwordx4 v[216:219], v90, s[36:39], s69 offen offset:3072 sc1
    v_rcp_f32 v62, v60
    v_add_f32 v76, v32, v20
    v_add_f32 v77, v36, v24
    v_add_f32 v76, v76, v60
    v_add_f32 v76, v76, v77
    v_cmp_nge_f32 vcc, 0x4e800000, v76
    s_cmp_lg_u64 vcc, 0
    s_cselect_b32 s56, s31, 0
    s_lshl_b32 s57, s40, 2
    s_add_u32 s57, s57, 0x23000
    s_mov_b64 vcc, 0
    v_mov_b32 v77, s57
    v_mov_b32 v78, s56
    ds_write_b32 v77, v78
    v_mov_b32 v79, 0x23000
    s_waitcnt vmcnt(35) lgkmcnt(0)
    s_barrier
    ds_read_b128 v[80:83], v79
    ds_read_b64_tr_b16 a[100:101], v0 offset:0
    ds_read_b64_tr_b16 a[102:103], v0 offset:5120
    ds_read_b64_tr_b16 a[104:105], v1 offset:32
    ds_read_b64_tr_b16 a[106:107], v1 offset:5152
    ds_read_b64_tr_b16 a[108:109], v0 offset:64
    ds_read_b64_tr_b16 a[110:111], v0 offset:5184
    ds_read_b64_tr_b16 a[112:113], v1 offset:96
    ds_read_b64_tr_b16 a[114:115], v1 offset:5216
    ds_read_b64_tr_b16 a[116:117], v0 offset:128
    ds_read_b64_tr_b16 a[118:119], v0 offset:5248
    ds_read_b64_tr_b16 a[120:121], v1 offset:160
    ds_read_b64_tr_b16 a[122:123], v1 offset:5280
    ds_read_b64_tr_b16 a[124:125], v0 offset:192
    ds_read_b64_tr_b16 a[126:127], v0 offset:5312
    ds_read_b64_tr_b16 a[128:129], v1 offset:224
    ds_read_b64_tr_b16 a[130:131], v1 offset:5344
    ds_read_b64_tr_b16 a[132:133], v0 offset:256
    ds_read_b64_tr_b16 a[134:135], v0 offset:5376
    ds_read_b64_tr_b16 a[136:137], v1 offset:288
    ds_read_b64_tr_b16 a[138:139], v1 offset:5408
    v_pk_mul_f32 v[224:225], v[224:225], v[62:63] op_sel_hi:[1,0]
    v_pk_mul_f32 v[226:227], v[226:227], v[62:63] op_sel_hi:[1,0]
    v_pk_mul_f32 v[228:229], v[228:229], v[62:63] op_sel_hi:[1,0]
    v_pk_mul_f32 v[230:231], v[230:231], v[62:63] op_sel_hi:[1,0]
    v_cvt_pk_bf16_f32 v224, v224, v225
    v_cvt_pk_bf16_f32 v225, v226, v227
    v_cvt_pk_bf16_f32 v226, v228, v229
    v_cvt_pk_bf16_f32 v227, v230, v231
    buffer_store_dwordx4 v[224:227], v91, s[36:39], s66 offen offset:0 sc1
    v_pk_mul_f32 v[232:233], v[232:233], v[62:63] op_sel_hi:[1,0]
    v_pk_mul_f32 v[234:235], v[234:235], v[62:63] op_sel_hi:[1,0]
    v_pk_mul_f32 v[236:237], v[236:237], v[62:63] op_sel_hi:[1,0]
    v_pk_mul_f32 v[238:239], v[238:239], v[62:63] op_sel_hi:[1,0]
    v_cvt_pk_bf16_f32 v232, v232, v233
    v_cvt_pk_bf16_f32 v233, v234, v235
    v_cvt_pk_bf16_f32 v234, v236, v237
    v_cvt_pk_bf16_f32 v235, v238, v239
    buffer_store_dwordx4 v[232:235], v91, s[36:39], s67 offen offset:0 sc1
    v_pk_mul_f32 v[240:241], v[240:241], v[62:63] op_sel_hi:[1,0]
    v_pk_mul_f32 v[242:243], v[242:243], v[62:63] op_sel_hi:[1,0]
    v_pk_mul_f32 v[244:245], v[244:245], v[62:63] op_sel_hi:[1,0]
    v_pk_mul_f32 v[246:247], v[246:247], v[62:63] op_sel_hi:[1,0]
    v_cvt_pk_bf16_f32 v240, v240, v241
    v_cvt_pk_bf16_f32 v241, v242, v243
    v_cvt_pk_bf16_f32 v242, v244, v245
    v_cvt_pk_bf16_f32 v243, v246, v247
    buffer_store_dwordx4 v[240:243], v91, s[36:39], s68 offen offset:0 sc1
    v_pk_mul_f32 v[248:249], v[248:249], v[62:63] op_sel_hi:[1,0]
    v_pk_mul_f32 v[250:251], v[250:251], v[62:63] op_sel_hi:[1,0]
    v_pk_mul_f32 v[252:253], v[252:253], v[62:63] op_sel_hi:[1,0]
    v_pk_mul_f32 v[254:255], v[254:255], v[62:63] op_sel_hi:[1,0]
    v_cvt_pk_bf16_f32 v248, v248, v249
    v_cvt_pk_bf16_f32 v249, v250, v251
    v_cvt_pk_bf16_f32 v250, v252, v253
    v_cvt_pk_bf16_f32 v251, v254, v255
    buffer_store_dwordx4 v[248:251], v91, s[36:39], s69 offen offset:0 sc1
    s_waitcnt lgkmcnt(15)
    v_or3_b32 v80, v80, v81, v82
    v_or_b32 v80, v80, v83
    s_nop 0
    v_readfirstlane_b32 s56, v80
    s_cmp_lg_u32 s56, 0
    s_cbranch_scc1 FALLBACK
    v_mov_b32 v4, v28
    v_mov_b32 v5, v29
    v_mov_b32 v6, v30
    v_mov_b32 v7, v31
    s_cmp_eq_u32 s40, 0
    s_cselect_b32 s78, s78, 0x7000000
    s_lshl_b32 s52, s41, 2
    s_add_u32 s52, s52, s88
    s_lshl_b32 s52, s52, 4
    s_add_u32 s52, s52, s40
    s_mul_i32 s52, s52, 20480
    s_waitcnt lgkmcnt(0)
    v_mfma_f32_16x16x32_bf16 v[8:11], a[100:103], v[96:99], 0
    v_mfma_f32_16x16x32_bf16 v[12:15], a[100:103], v[128:131], 0
    s_add_u32 s75, s61, 40960
    ds_read_b64_tr_b16 a[140:141], v89 offset:0
    ds_read_b64_tr_b16 a[142:143], v89 offset:5120
    v_mfma_f32_16x16x32_bf16 v[16:19], a[100:103], v[160:163], 0
    s_add_u32 m0, s62, 10240
    v_mfma_f32_16x16x32_bf16 v[20:23], a[100:103], v[192:195], 0
    ds_read_b64_tr_b16 a[144:145], v94 offset:32
    ds_read_b64_tr_b16 a[146:147], v94 offset:5152
    v_mfma_f32_16x16x32_bf16 v[24:27], a[100:103], v[224:227], 0
    buffer_load_dwordx4 v4, s[32:35], s75 offen offset:0 lds
    v_mfma_f32_16x16x32_bf16 v[28:31], a[104:107], v[96:99], 0
    ds_read_b64_tr_b16 a[148:149], v89 offset:64
    ds_read_b64_tr_b16 a[150:151], v89 offset:5184
    v_mfma_f32_16x16x32_bf16 v[32:35], a[104:107], v[128:131], 0
    v_mfma_f32_16x16x32_bf16 v[36:39], a[104:107], v[160:163], 0
    ds_read_b64_tr_b16 a[152:153], v94 offset:96
    ds_read_b64_tr_b16 a[154:155], v94 offset:5216
    v_mfma_f32_16x16x32_bf16 v[40:43], a[104:107], v[192:195], 0
    v_mfma_f32_16x16x32_bf16 v[44:47], a[104:107], v[224:227], 0
    ds_read_b64_tr_b16 a[156:157], v89 offset:128
    ds_read_b64_tr_b16 a[158:159], v89 offset:5248
    v_mfma_f32_16x16x32_bf16 v[48:51], a[108:111], v[96:99], 0
    v_mfma_f32_16x16x32_bf16 v[52:55], a[108:111], v[128:131], 0
    ds_read_b64_tr_b16 a[160:161], v94 offset:160
    ds_read_b64_tr_b16 a[162:163], v94 offset:5280
    v_mfma_f32_16x16x32_bf16 v[56:59], a[108:111], v[160:163], 0
    buffer_load_dwordx4 v5, s[32:35], s75 offen offset:1024 lds
    v_mfma_f32_16x16x32_bf16 v[60:63], a[108:111], v[192:195], 0
    ds_read_b64_tr_b16 a[164:165], v89 offset:192
    ds_read_b64_tr_b16 a[166:167], v89 offset:5312
    v_mfma_f32_16x16x32_bf16 v[64:67], a[108:111], v[224:227], 0
    v_mfma_f32_16x16x32_bf16 v[68:71], a[112:115], v[96:99], 0
    ds_read_b64_tr_b16 a[168:169], v94 offset:224
    ds_read_b64_tr_b16 a[170:171], v94 offset:5344
    v_mfma_f32_16x16x32_bf16 v[72:75], a[112:115], v[128:131], 0
    v_mfma_f32_16x16x32_bf16 v[76:79], a[112:115], v[160:163], 0
    ds_read_b64_tr_b16 a[172:173], v89 offset:256
    ds_read_b64_tr_b16 a[174:175], v89 offset:5376
    v_mfma_f32_16x16x32_bf16 v[80:83], a[112:115], v[192:195], 0
    v_mfma_f32_16x16x32_bf16 v[84:87], a[112:115], v[224:227], 0
    ds_read_b64_tr_b16 a[176:177], v94 offset:288
    ds_read_b64_tr_b16 a[178:179], v94 offset:5408
    v_mfma_f32_16x16x32_bf16 v[100:103], a[116:119], v[96:99], 0
    v_mfma_f32_16x16x32_bf16 v[132:135], a[116:119], v[128:131], 0
    buffer_load_dwordx4 v6, s[32:35], s75 offen offset:2048 lds
    v_mfma_f32_16x16x32_bf16 v[164:167], a[116:119], v[160:163], 0
    v_mfma_f32_16x16x32_bf16 v[196:199], a[116:119], v[192:195], 0
    v_mfma_f32_16x16x32_bf16 v[228:231], a[116:119], v[224:227], 0
    v_mfma_f32_16x16x32_bf16 a[0:3], a[120:123], v[96:99], 0
    v_mfma_f32_16x16x32_bf16 a[4:7], a[120:123], v[128:131], 0
    v_mfma_f32_16x16x32_bf16 a[8:11], a[120:123], v[160:163], 0
    v_mfma_f32_16x16x32_bf16 a[12:15], a[120:123], v[192:195], 0
    v_mfma_f32_16x16x32_bf16 a[16:19], a[120:123], v[224:227], 0
    v_mfma_f32_16x16x32_bf16 a[20:23], a[124:127], v[96:99], 0
    buffer_load_dwordx4 v7, s[32:35], s75 offen offset:3072 lds
    v_mfma_f32_16x16x32_bf16 a[24:27], a[124:127], v[128:131], 0
    s_add_u32 m0, s62, 14336
    v_mfma_f32_16x16x32_bf16 a[28:31], a[124:127], v[160:163], 0
    v_mfma_f32_16x16x32_bf16 a[32:35], a[124:127], v[192:195], 0
    v_mfma_f32_16x16x32_bf16 a[36:39], a[124:127], v[224:227], 0
    v_mfma_f32_16x16x32_bf16 a[40:43], a[128:131], v[96:99], 0
    v_mfma_f32_16x16x32_bf16 a[44:47], a[128:131], v[128:131], 0
    v_mfma_f32_16x16x32_bf16 a[48:51], a[128:131], v[160:163], 0
    v_mfma_f32_16x16x32_bf16 a[52:55], a[128:131], v[192:195], 0
    v_mfma_f32_16x16x32_bf16 a[56:59], a[128:131], v[224:227], 0
    buffer_load_dwordx4 v88, s[32:35], s75 offen lds
    v_mfma_f32_16x16x32_bf16 a[60:63], a[132:135], v[96:99], 0
    v_mfma_f32_16x16x32_bf16 a[64:67], a[132:135], v[128:131], 0
    v_mfma_f32_16x16x32_bf16 a[68:71], a[132:135], v[160:163], 0
    v_mfma_f32_16x16x32_bf16 a[72:75], a[132:135], v[192:195], 0
    v_mfma_f32_16x16x32_bf16 a[76:79], a[132:135], v[224:227], 0
    v_mfma_f32_16x16x32_bf16 a[80:83], a[136:139], v[96:99], 0
    v_mfma_f32_16x16x32_bf16 a[84:87], a[136:139], v[128:131], 0
    v_mfma_f32_16x16x32_bf16 a[88:91], a[136:139], v[160:163], 0
    v_mfma_f32_16x16x32_bf16 a[92:95], a[136:139], v[192:195], 0
    v_mfma_f32_16x16x32_bf16 a[96:99], a[136:139], v[224:227], 0
    s_waitcnt vmcnt(35) lgkmcnt(0)
    v_mfma_f32_16x16x32_bf16 v[8:11], a[140:143], v[104:107], v[8:11]
    s_barrier
    v_mfma_f32_16x16x32_bf16 v[12:15], a[140:143], v[136:139], v[12:15]
    s_add_u32 s75, s61, 81920
    ds_read_b64_tr_b16 a[100:101], v3 offset:0
    ds_read_b64_tr_b16 a[102:103], v3 offset:5120
    v_mfma_f32_16x16x32_bf16 v[16:19], a[140:143], v[168:171], v[16:19]
    s_add_u32 m0, s62, 20480
    v_mfma_f32_16x16x32_bf16 v[20:23], a[140:143], v[200:203], v[20:23]
    ds_read_b64_tr_b16 a[104:105], v2 offset:32
    ds_read_b64_tr_b16 a[106:107], v2 offset:5152
    v_mfma_f32_16x16x32_bf16 v[24:27], a[140:143], v[232:235], v[24:27]
    buffer_load_dwordx4 v4, s[32:35], s75 offen offset:0 lds
    v_mfma_f32_16x16x32_bf16 v[28:31], a[144:147], v[104:107], v[28:31]
    ds_read_b64_tr_b16 a[108:109], v3 offset:64
    ds_read_b64_tr_b16 a[110:111], v3 offset:5184
    v_mfma_f32_16x16x32_bf16 v[32:35], a[144:147], v[136:139], v[32:35]
    v_mfma_f32_16x16x32_bf16 v[36:39], a[144:147], v[168:171], v[36:39]
    ds_read_b64_tr_b16 a[112:113], v2 offset:96
    ds_read_b64_tr_b16 a[114:115], v2 offset:5216
    v_mfma_f32_16x16x32_bf16 v[40:43], a[144:147], v[200:203], v[40:43]
    v_mfma_f32_16x16x32_bf16 v[44:47], a[144:147], v[232:235], v[44:47]
    ds_read_b64_tr_b16 a[116:117], v3 offset:128
    ds_read_b64_tr_b16 a[118:119], v3 offset:5248
    v_mfma_f32_16x16x32_bf16 v[48:51], a[148:151], v[104:107], v[48:51]
    v_mfma_f32_16x16x32_bf16 v[52:55], a[148:151], v[136:139], v[52:55]
    ds_read_b64_tr_b16 a[120:121], v2 offset:160
    ds_read_b64_tr_b16 a[122:123], v2 offset:5280
    v_mfma_f32_16x16x32_bf16 v[56:59], a[148:151], v[168:171], v[56:59]
    buffer_load_dwordx4 v5, s[32:35], s75 offen offset:1024 lds
    v_mfma_f32_16x16x32_bf16 v[60:63], a[148:151], v[200:203], v[60:63]
    ds_read_b64_tr_b16 a[124:125], v3 offset:192
    ds_read_b64_tr_b16 a[126:127], v3 offset:5312
    v_mfma_f32_16x16x32_bf16 v[64:67], a[148:151], v[232:235], v[64:67]
    v_mfma_f32_16x16x32_bf16 v[68:71], a[152:155], v[104:107], v[68:71]
    ds_read_b64_tr_b16 a[128:129], v2 offset:224
    ds_read_b64_tr_b16 a[130:131], v2 offset:5344
    v_mfma_f32_16x16x32_bf16 v[72:75], a[152:155], v[136:139], v[72:75]
    v_mfma_f32_16x16x32_bf16 v[76:79], a[152:155], v[168:171], v[76:79]
    ds_read_b64_tr_b16 a[132:133], v3 offset:256
    ds_read_b64_tr_b16 a[134:135], v3 offset:5376
    v_mfma_f32_16x16x32_bf16 v[80:83], a[152:155], v[200:203], v[80:83]
    v_mfma_f32_16x16x32_bf16 v[84:87], a[152:155], v[232:235], v[84:87]
    ds_read_b64_tr_b16 a[136:137], v2 offset:288
    ds_read_b64_tr_b16 a[138:139], v2 offset:5408
    v_mfma_f32_16x16x32_bf16 v[100:103], a[156:159], v[104:107], v[100:103]
    v_mfma_f32_16x16x32_bf16 v[132:135], a[156:159], v[136:139], v[132:135]
    buffer_load_dwordx4 v6, s[32:35], s75 offen offset:2048 lds
    v_mfma_f32_16x16x32_bf16 v[164:167], a[156:159], v[168:171], v[164:167]
    v_mfma_f32_16x16x32_bf16 v[196:199], a[156:159], v[200:203], v[196:199]
    v_mfma_f32_16x16x32_bf16 v[228:231], a[156:159], v[232:235], v[228:231]
    v_mfma_f32_16x16x32_bf16 a[0:3], a[160:163], v[104:107], a[0:3]
    v_mfma_f32_16x16x32_bf16 a[4:7], a[160:163], v[136:139], a[4:7]
    v_mfma_f32_16x16x32_bf16 a[8:11], a[160:163], v[168:171], a[8:11]
    v_mfma_f32_16x16x32_bf16 a[12:15], a[160:163], v[200:203], a[12:15]
    v_mfma_f32_16x16x32_bf16 a[16:19], a[160:163], v[232:235], a[16:19]
    v_mfma_f32_16x16x32_bf16 a[20:23], a[164:167], v[104:107], a[20:23]
    buffer_load_dwordx4 v7, s[32:35], s75 offen offset:3072 lds
    v_mfma_f32_16x16x32_bf16 a[24:27], a[164:167], v[136:139], a[24:27]
    s_add_u32 m0, s62, 24576
    v_mfma_f32_16x16x32_bf16 a[28:31], a[164:167], v[168:171], a[28:31]
    v_mfma_f32_16x16x32_bf16 a[32:35], a[164:167], v[200:203], a[32:35]
    v_mfma_f32_16x16x32_bf16 a[36:39], a[164:167], v[232:235], a[36:39]
    v_mfma_f32_16x16x32_bf16 a[40:43], a[168:171], v[104:107], a[40:43]
    v_mfma_f32_16x16x32_bf16 a[44:47], a[168:171], v[136:139], a[44:47]
    v_mfma_f32_16x16x32_bf16 a[48:51], a[168:171], v[168:171], a[48:51]
    v_mfma_f32_16x16x32_bf16 a[52:55], a[168:171], v[200:203], a[52:55]
    v_mfma_f32_16x16x32_bf16 a[56:59], a[168:171], v[232:235], a[56:59]
    buffer_load_dwordx4 v88, s[32:35], s75 offen lds
    v_mfma_f32_16x16x32_bf16 a[60:63], a[172:175], v[104:107], a[60:63]
    v_mfma_f32_16x16x32_bf16 a[64:67], a[172:175], v[136:139], a[64:67]
    v_mfma_f32_16x16x32_bf16 a[68:71], a[172:175], v[168:171], a[68:71]
    v_mfma_f32_16x16x32_bf16 a[72:75], a[172:175], v[200:203], a[72:75]
    v_mfma_f32_16x16x32_bf16 a[76:79], a[172:175], v[232:235], a[76:79]
    v_mfma_f32_16x16x32_bf16 a[80:83], a[176:179], v[104:107], a[80:83]
    v_mfma_f32_16x16x32_bf16 a[84:87], a[176:179], v[136:139], a[84:87]
    v_mfma_f32_16x16x32_bf16 a[88:91], a[176:179], v[168:171], a[88:91]
    v_mfma_f32_16x16x32_bf16 a[92:95], a[176:179], v[200:203], a[92:95]
    v_mfma_f32_16x16x32_bf16 a[96:99], a[176:179], v[232:235], a[96:99]
    s_waitcnt vmcnt(10) lgkmcnt(0)
    v_mfma_f32_16x16x32_bf16 v[8:11], a[100:103], v[112:115], v[8:11]
    s_barrier
    v_mfma_f32_16x16x32_bf16 v[12:15], a[100:103], v[144:147], v[12:15]
    buffer_store_dword v93, v92, s[36:39], s78 offen sc1
    v_mfma_f32_16x16x32_bf16 v[16:19], a[100:103], v[176:179], v[16:19]
    s_add_u32 s75, s61, 122880
    ds_read_b64_tr_b16 a[140:141], v3 offset:10240
    ds_read_b64_tr_b16 a[142:143], v3 offset:15360
    v_mfma_f32_16x16x32_bf16 v[20:23], a[100:103], v[208:211], v[20:23]
    s_add_u32 m0, s92, 0
    v_mfma_f32_16x16x32_bf16 v[24:27], a[100:103], v[240:243], v[24:27]
    buffer_load_dwordx4 v4, s[32:35], s75 offen offset:0 lds
    v_mfma_f32_16x16x32_bf16 v[28:31], a[104:107], v[112:115], v[28:31]
    ds_read_b64_tr_b16 a[144:145], v2 offset:10272
    ds_read_b64_tr_b16 a[146:147], v2 offset:15392
    v_mfma_f32_16x16x32_bf16 v[32:35], a[104:107], v[144:147], v[32:35]
    v_mfma_f32_16x16x32_bf16 v[36:39], a[104:107], v[176:179], v[36:39]
    ds_read_b64_tr_b16 a[148:149], v3 offset:10304
    ds_read_b64_tr_b16 a[150:151], v3 offset:15424
    v_mfma_f32_16x16x32_bf16 v[40:43], a[104:107], v[208:211], v[40:43]
    v_mfma_f32_16x16x32_bf16 v[44:47], a[104:107], v[240:243], v[44:47]
    buffer_load_dwordx4 v5, s[32:35], s75 offen offset:1024 lds
    v_mfma_f32_16x16x32_bf16 v[48:51], a[108:111], v[112:115], v[48:51]
    ds_read_b64_tr_b16 a[152:153], v2 offset:10336
    ds_read_b64_tr_b16 a[154:155], v2 offset:15456
    v_mfma_f32_16x16x32_bf16 v[52:55], a[108:111], v[144:147], v[52:55]
    v_mfma_f32_16x16x32_bf16 v[56:59], a[108:111], v[176:179], v[56:59]
    ds_read_b64_tr_b16 a[156:157], v3 offset:10368
    ds_read_b64_tr_b16 a[158:159], v3 offset:15488
    v_mfma_f32_16x16x32_bf16 v[60:63], a[108:111], v[208:211], v[60:63]
    v_mfma_f32_16x16x32_bf16 v[64:67], a[108:111], v[240:243], v[64:67]
    buffer_load_dwordx4 v6, s[32:35], s75 offen offset:2048 lds
    v_mfma_f32_16x16x32_bf16 v[68:71], a[112:115], v[112:115], v[68:71]
    ds_read_b64_tr_b16 a[160:161], v2 offset:10400
    ds_read_b64_tr_b16 a[162:163], v2 offset:15520
    v_mfma_f32_16x16x32_bf16 v[72:75], a[112:115], v[144:147], v[72:75]
    v_mfma_f32_16x16x32_bf16 v[76:79], a[112:115], v[176:179], v[76:79]
    ds_read_b64_tr_b16 a[164:165], v3 offset:10432
    ds_read_b64_tr_b16 a[166:167], v3 offset:15552
    v_mfma_f32_16x16x32_bf16 v[80:83], a[112:115], v[208:211], v[80:83]
    v_mfma_f32_16x16x32_bf16 v[84:87], a[112:115], v[240:243], v[84:87]
    buffer_load_dwordx4 v7, s[32:35], s75 offen offset:3072 lds
    v_mfma_f32_16x16x32_bf16 v[100:103], a[116:119], v[112:115], v[100:103]
    s_add_u32 m0, s92, 4096
    ds_read_b64_tr_b16 a[168:169], v2 offset:10464
    ds_read_b64_tr_b16 a[170:171], v2 offset:15584
    v_mfma_f32_16x16x32_bf16 v[132:135], a[116:119], v[144:147], v[132:135]
    v_mfma_f32_16x16x32_bf16 v[164:167], a[116:119], v[176:179], v[164:167]
    ds_read_b64_tr_b16 a[172:173], v3 offset:10496
    ds_read_b64_tr_b16 a[174:175], v3 offset:15616
    v_mfma_f32_16x16x32_bf16 v[196:199], a[116:119], v[208:211], v[196:199]
    v_mfma_f32_16x16x32_bf16 v[228:231], a[116:119], v[240:243], v[228:231]
    buffer_load_dwordx4 v88, s[32:35], s75 offen lds
    v_mfma_f32_16x16x32_bf16 a[0:3], a[120:123], v[112:115], a[0:3]
    ds_read_b64_tr_b16 a[176:177], v2 offset:10528
    ds_read_b64_tr_b16 a[178:179], v2 offset:15648
    v_mfma_f32_16x16x32_bf16 a[4:7], a[120:123], v[144:147], a[4:7]
    v_mfma_f32_16x16x32_bf16 a[8:11], a[120:123], v[176:179], a[8:11]
    v_mfma_f32_16x16x32_bf16 a[12:15], a[120:123], v[208:211], a[12:15]
    v_mfma_f32_16x16x32_bf16 a[16:19], a[120:123], v[240:243], a[16:19]
    v_mfma_f32_16x16x32_bf16 a[20:23], a[124:127], v[112:115], a[20:23]
    buffer_load_dwordx4 v[124:127], v92, s[36:39], s91 offen sc1
    v_mfma_f32_16x16x32_bf16 a[24:27], a[124:127], v[144:147], a[24:27]
    v_mfma_f32_16x16x32_bf16 a[28:31], a[124:127], v[176:179], a[28:31]
    v_mfma_f32_16x16x32_bf16 a[32:35], a[124:127], v[208:211], a[32:35]
    v_mfma_f32_16x16x32_bf16 a[36:39], a[124:127], v[240:243], a[36:39]
    v_mfma_f32_16x16x32_bf16 a[40:43], a[128:131], v[112:115], a[40:43]
    v_mfma_f32_16x16x32_bf16 a[44:47], a[128:131], v[144:147], a[44:47]
    v_mfma_f32_16x16x32_bf16 a[48:51], a[128:131], v[176:179], a[48:51]
    v_mfma_f32_16x16x32_bf16 a[52:55], a[128:131], v[208:211], a[52:55]
    v_mfma_f32_16x16x32_bf16 a[56:59], a[128:131], v[240:243], a[56:59]
    v_mfma_f32_16x16x32_bf16 a[60:63], a[132:135], v[112:115], a[60:63]
    v_mfma_f32_16x16x32_bf16 a[64:67], a[132:135], v[144:147], a[64:67]
    v_mfma_f32_16x16x32_bf16 a[68:71], a[132:135], v[176:179], a[68:71]
    v_mfma_f32_16x16x32_bf16 a[72:75], a[132:135], v[208:211], a[72:75]
    v_mfma_f32_16x16x32_bf16 a[76:79], a[132:135], v[240:243], a[76:79]
    v_mfma_f32_16x16x32_bf16 a[80:83], a[136:139], v[112:115], a[80:83]
    v_mfma_f32_16x16x32_bf16 a[84:87], a[136:139], v[144:147], a[84:87]
    v_mfma_f32_16x16x32_bf16 a[88:91], a[136:139], v[176:179], a[88:91]
    v_mfma_f32_16x16x32_bf16 a[92:95], a[136:139], v[208:211], a[92:95]
    v_mfma_f32_16x16x32_bf16 a[96:99], a[136:139], v[240:243], a[96:99]
    s_mov_b32 s56, 0
    s_waitcnt vmcnt(0)
POLL:
    v_xor_b32 v124, s30, v124
    v_xor_b32 v125, s30, v125
    v_xor_b32 v126, s30, v126
    v_xor_b32 v127, s30, v127
    v_or3_b32 v124, v124, v125, v126
    v_or_b32 v124, v124, v127
    s_add_u32 s56, s56, 1
    v_readfirstlane_b32 s57, v124
    s_cmp_eq_u32 s57, 0
    s_cbranch_scc1 POLL_OK
    s_cmp_ge_u32 s56, 0x40000
    s_cbranch_scc1 POLL_OK
    buffer_load_dwordx4 v[124:127], v92, s[36:39], s91 offen sc1
    s_waitcnt vmcnt(0)
    s_branch POLL
POLL_OK:
    s_waitcnt vmcnt(34) lgkmcnt(0)
    v_mfma_f32_16x16x32_bf16 v[8:11], a[140:143], v[120:123], v[8:11]
    s_barrier
    v_mfma_f32_16x16x32_bf16 v[12:15], a[140:143], v[152:155], v[12:15]
    s_cmp_lt_u32 s89, 1
    s_cselect_b32 s53, 1, 0
    ds_read_b64_tr_b16 a[100:101], v3 offset:20480
    ds_read_b64_tr_b16 a[102:103], v3 offset:25600
    v_mfma_f32_16x16x32_bf16 v[16:19], a[140:143], v[184:187], v[16:19]
    s_mul_i32 s53, s53, 81920
    s_add_u32 s53, s53, s52
    v_mfma_f32_16x16x32_bf16 v[20:23], a[140:143], v[216:219], v[20:23]
    buffer_load_dwordx4 v[108:111], v90, s[36:39], s53 offen offset:0 sc1
    v_mfma_f32_16x16x32_bf16 v[24:27], a[140:143], v[248:251], v[24:27]
    ds_read_b64_tr_b16 a[104:105], v2 offset:20512
    ds_read_b64_tr_b16 a[106:107], v2 offset:25632
    v_mfma_f32_16x16x32_bf16 v[28:31], a[144:147], v[120:123], v[28:31]
    v_mfma_f32_16x16x32_bf16 v[32:35], a[144:147], v[152:155], v[32:35]
    buffer_load_dwordx4 v[140:143], v90, s[36:39], s53 offen offset:1024 sc1
    v_mfma_f32_16x16x32_bf16 v[36:39], a[144:147], v[184:187], v[36:39]
    ds_read_b64_tr_b16 a[108:109], v3 offset:20544
    ds_read_b64_tr_b16 a[110:111], v3 offset:25664
    v_mfma_f32_16x16x32_bf16 v[40:43], a[144:147], v[216:219], v[40:43]
    v_mfma_f32_16x16x32_bf16 v[44:47], a[144:147], v[248:251], v[44:47]
    buffer_load_dwordx4 v[172:175], v90, s[36:39], s53 offen offset:2048 sc1
    v_mfma_f32_16x16x32_bf16 v[48:51], a[148:151], v[120:123], v[48:51]
    ds_read_b64_tr_b16 a[112:113], v2 offset:20576
    ds_read_b64_tr_b16 a[114:115], v2 offset:25696
    v_mfma_f32_16x16x32_bf16 v[52:55], a[148:151], v[152:155], v[52:55]
    v_mfma_f32_16x16x32_bf16 v[56:59], a[148:151], v[184:187], v[56:59]
    buffer_load_dwordx4 v[204:207], v90, s[36:39], s53 offen offset:3072 sc1
    v_mfma_f32_16x16x32_bf16 v[60:63], a[148:151], v[216:219], v[60:63]
    ds_read_b64_tr_b16 a[116:117], v3 offset:20608
    ds_read_b64_tr_b16 a[118:119], v3 offset:25728
    v_mfma_f32_16x16x32_bf16 v[64:67], a[148:151], v[248:251], v[64:67]
    v_mfma_f32_16x16x32_bf16 v[68:71], a[152:155], v[120:123], v[68:71]
    buffer_load_dwordx4 v[236:239], v91, s[36:39], s53 offen offset:0 sc1
    v_mfma_f32_16x16x32_bf16 v[72:75], a[152:155], v[152:155], v[72:75]
    s_add_u32 s53, s53, 5120
    ds_read_b64_tr_b16 a[120:121], v2 offset:20640
    ds_read_b64_tr_b16 a[122:123], v2 offset:25760
    v_mfma_f32_16x16x32_bf16 v[76:79], a[152:155], v[184:187], v[76:79]
    v_mfma_f32_16x16x32_bf16 v[80:83], a[152:155], v[216:219], v[80:83]
    buffer_load_dwordx4 v[116:119], v90, s[36:39], s53 offen offset:0 sc1
    v_mfma_f32_16x16x32_bf16 v[84:87], a[152:155], v[248:251], v[84:87]
    ds_read_b64_tr_b16 a[124:125], v3 offset:20672
    ds_read_b64_tr_b16 a[126:127], v3 offset:25792
    v_mfma_f32_16x16x32_bf16 v[100:103], a[156:159], v[120:123], v[100:103]
    v_mfma_f32_16x16x32_bf16 v[132:135], a[156:159], v[152:155], v[132:135]
    buffer_load_dwordx4 v[148:151], v90, s[36:39], s53 offen offset:1024 sc1
    v_mfma_f32_16x16x32_bf16 v[164:167], a[156:159], v[184:187], v[164:167]
    ds_read_b64_tr_b16 a[128:129], v2 offset:20704
    ds_read_b64_tr_b16 a[130:131], v2 offset:25824
    v_mfma_f32_16x16x32_bf16 v[196:199], a[156:159], v[216:219], v[196:199]
    v_mfma_f32_16x16x32_bf16 v[228:231], a[156:159], v[248:251], v[228:231]
    buffer_load_dwordx4 v[180:183], v90, s[36:39], s53 offen offset:2048 sc1
    v_mfma_f32_16x16x32_bf16 a[0:3], a[160:163], v[120:123], a[0:3]
    ds_read_b64_tr_b16 a[132:133], v3 offset:20736
    ds_read_b64_tr_b16 a[134:135], v3 offset:25856
    v_mfma_f32_16x16x32_bf16 a[4:7], a[160:163], v[152:155], a[4:7]
    v_mfma_f32_16x16x32_bf16 a[8:11], a[160:163], v[184:187], a[8:11]
    buffer_load_dwordx4 v[212:215], v90, s[36:39], s53 offen offset:3072 sc1
    v_mfma_f32_16x16x32_bf16 a[12:15], a[160:163], v[216:219], a[12:15]
    ds_read_b64_tr_b16 a[136:137], v2 offset:20768
    ds_read_b64_tr_b16 a[138:139], v2 offset:25888
    v_mfma_f32_16x16x32_bf16 a[16:19], a[160:163], v[248:251], a[16:19]
    v_mfma_f32_16x16x32_bf16 a[20:23], a[164:167], v[120:123], a[20:23]
    buffer_load_dwordx4 v[244:247], v91, s[36:39], s53 offen offset:0 sc1
    v_mfma_f32_16x16x32_bf16 a[24:27], a[164:167], v[152:155], a[24:27]
    s_add_u32 s53, s53, 5120
    v_mfma_f32_16x16x32_bf16 a[28:31], a[164:167], v[184:187], a[28:31]
    v_mfma_f32_16x16x32_bf16 a[32:35], a[164:167], v[216:219], a[32:35]
    v_mfma_f32_16x16x32_bf16 a[36:39], a[164:167], v[248:251], a[36:39]
    v_mfma_f32_16x16x32_bf16 a[40:43], a[168:171], v[120:123], a[40:43]
    v_mfma_f32_16x16x32_bf16 a[44:47], a[168:171], v[152:155], a[44:47]
    v_mfma_f32_16x16x32_bf16 a[48:51], a[168:171], v[184:187], a[48:51]
    v_mfma_f32_16x16x32_bf16 a[52:55], a[168:171], v[216:219], a[52:55]
    v_mfma_f32_16x16x32_bf16 a[56:59], a[168:171], v[248:251], a[56:59]
    v_mfma_f32_16x16x32_bf16 a[60:63], a[172:175], v[120:123], a[60:63]
    v_mfma_f32_16x16x32_bf16 a[64:67], a[172:175], v[152:155], a[64:67]
    v_mfma_f32_16x16x32_bf16 a[68:71], a[172:175], v[184:187], a[68:71]
    v_mfma_f32_16x16x32_bf16 a[72:75], a[172:175], v[216:219], a[72:75]
    v_mfma_f32_16x16x32_bf16 a[76:79], a[172:175], v[248:251], a[76:79]
    v_mfma_f32_16x16x32_bf16 a[80:83], a[176:179], v[120:123], a[80:83]
    v_mfma_f32_16x16x32_bf16 a[84:87], a[176:179], v[152:155], a[84:87]
    v_mfma_f32_16x16x32_bf16 a[88:91], a[176:179], v[184:187], a[88:91]
    v_mfma_f32_16x16x32_bf16 a[92:95], a[176:179], v[216:219], a[92:95]
    v_mfma_f32_16x16x32_bf16 a[96:99], a[176:179], v[248:251], a[96:99]
    s_waitcnt vmcnt(5) lgkmcnt(0)
    v_mfma_f32_16x16x32_bf16 v[8:11], a[100:103], v[108:111], v[8:11]
    s_barrier
    v_mfma_f32_16x16x32_bf16 v[12:15], a[100:103], v[140:143], v[12:15]
    ds_read_b64_tr_b16 a[140:141], v89 offset:10240
    ds_read_b64_tr_b16 a[142:143], v89 offset:15360
    v_mfma_f32_16x16x32_bf16 v[16:19], a[100:103], v[172:175], v[16:19]
    v_mfma_f32_16x16x32_bf16 v[20:23], a[100:103], v[204:207], v[20:23]
    ds_read_b64_tr_b16 a[144:145], v94 offset:10272
    ds_read_b64_tr_b16 a[146:147], v94 offset:15392
    v_mfma_f32_16x16x32_bf16 v[24:27], a[100:103], v[236:239], v[24:27]
    buffer_load_dwordx4 v[124:127], v90, s[36:39], s53 offen offset:0 sc1
    v_mfma_f32_16x16x32_bf16 v[28:31], a[104:107], v[108:111], v[28:31]
    ds_read_b64_tr_b16 a[148:149], v89 offset:10304
    ds_read_b64_tr_b16 a[150:151], v89 offset:15424
    v_mfma_f32_16x16x32_bf16 v[32:35], a[104:107], v[140:143], v[32:35]
    v_mfma_f32_16x16x32_bf16 v[36:39], a[104:107], v[172:175], v[36:39]
    ds_read_b64_tr_b16 a[152:153], v94 offset:10336
    ds_read_b64_tr_b16 a[154:155], v94 offset:15456
    v_mfma_f32_16x16x32_bf16 v[40:43], a[104:107], v[204:207], v[40:43]
    buffer_load_dwordx4 v[156:159], v90, s[36:39], s53 offen offset:1024 sc1
    v_mfma_f32_16x16x32_bf16 v[44:47], a[104:107], v[236:239], v[44:47]
    ds_read_b64_tr_b16 a[156:157], v89 offset:10368
    ds_read_b64_tr_b16 a[158:159], v89 offset:15488
    v_mfma_f32_16x16x32_bf16 v[48:51], a[108:111], v[108:111], v[48:51]
    v_mfma_f32_16x16x32_bf16 v[52:55], a[108:111], v[140:143], v[52:55]
    ds_read_b64_tr_b16 a[160:161], v94 offset:10400
    ds_read_b64_tr_b16 a[162:163], v94 offset:15520
    v_mfma_f32_16x16x32_bf16 v[56:59], a[108:111], v[172:175], v[56:59]
    buffer_load_dwordx4 v[188:191], v90, s[36:39], s53 offen offset:2048 sc1
    v_mfma_f32_16x16x32_bf16 v[60:63], a[108:111], v[204:207], v[60:63]
    ds_read_b64_tr_b16 a[164:165], v89 offset:10432
    ds_read_b64_tr_b16 a[166:167], v89 offset:15552
    v_mfma_f32_16x16x32_bf16 v[64:67], a[108:111], v[236:239], v[64:67]
    v_mfma_f32_16x16x32_bf16 v[68:71], a[112:115], v[108:111], v[68:71]
    ds_read_b64_tr_b16 a[168:169], v94 offset:10464
    ds_read_b64_tr_b16 a[170:171], v94 offset:15584
    v_mfma_f32_16x16x32_bf16 v[72:75], a[112:115], v[140:143], v[72:75]
    v_mfma_f32_16x16x32_bf16 v[76:79], a[112:115], v[172:175], v[76:79]
    buffer_load_dwordx4 v[220:223], v90, s[36:39], s53 offen offset:3072 sc1
    v_mfma_f32_16x16x32_bf16 v[80:83], a[112:115], v[204:207], v[80:83]
    ds_read_b64_tr_b16 a[172:173], v89 offset:10496
    ds_read_b64_tr_b16 a[174:175], v89 offset:15616
    v_mfma_f32_16x16x32_bf16 v[84:87], a[112:115], v[236:239], v[84:87]
    v_mfma_f32_16x16x32_bf16 v[100:103], a[116:119], v[108:111], v[100:103]
    ds_read_b64_tr_b16 a[176:177], v94 offset:10528
    ds_read_b64_tr_b16 a[178:179], v94 offset:15648
    v_mfma_f32_16x16x32_bf16 v[132:135], a[116:119], v[140:143], v[132:135]
    buffer_load_dwordx4 v[252:255], v91, s[36:39], s53 offen offset:0 sc1
    v_mfma_f32_16x16x32_bf16 v[164:167], a[116:119], v[172:175], v[164:167]
    s_add_u32 s53, s53, 5120
    v_mfma_f32_16x16x32_bf16 v[196:199], a[116:119], v[204:207], v[196:199]
    s_add_u32 s75, s64, 0
    v_mfma_f32_16x16x32_bf16 v[228:231], a[116:119], v[236:239], v[228:231]
    s_add_u32 m0, s62, 0
    v_mfma_f32_16x16x32_bf16 a[0:3], a[120:123], v[108:111], a[0:3]
    v_mfma_f32_16x16x32_bf16 a[4:7], a[120:123], v[140:143], a[4:7]
    buffer_load_dwordx4 v4, s[32:35], s75 offen offset:0 lds
    v_mfma_f32_16x16x32_bf16 a[8:11], a[120:123], v[172:175], a[8:11]
    v_mfma_f32_16x16x32_bf16 a[12:15], a[120:123], v[204:207], a[12:15]
    v_mfma_f32_16x16x32_bf16 a[16:19], a[120:123], v[236:239], a[16:19]
    v_mfma_f32_16x16x32_bf16 a[20:23], a[124:127], v[108:111], a[20:23]
    buffer_load_dwordx4 v5, s[32:35], s75 offen offset:1024 lds
    v_mfma_f32_16x16x32_bf16 a[24:27], a[124:127], v[140:143], a[24:27]
    v_mfma_f32_16x16x32_bf16 a[28:31], a[124:127], v[172:175], a[28:31]
    v_mfma_f32_16x16x32_bf16 a[32:35], a[124:127], v[204:207], a[32:35]
    v_mfma_f32_16x16x32_bf16 a[36:39], a[124:127], v[236:239], a[36:39]
    buffer_load_dwordx4 v6, s[32:35], s75 offen offset:2048 lds
    v_mfma_f32_16x16x32_bf16 a[40:43], a[128:131], v[108:111], a[40:43]
    v_mfma_f32_16x16x32_bf16 a[44:47], a[128:131], v[140:143], a[44:47]
    v_mfma_f32_16x16x32_bf16 a[48:51], a[128:131], v[172:175], a[48:51]
    v_mfma_f32_16x16x32_bf16 a[52:55], a[128:131], v[204:207], a[52:55]
    v_mfma_f32_16x16x32_bf16 a[56:59], a[128:131], v[236:239], a[56:59]
    buffer_load_dwordx4 v7, s[32:35], s75 offen offset:3072 lds
    v_mfma_f32_16x16x32_bf16 a[60:63], a[132:135], v[108:111], a[60:63]
    s_add_u32 m0, s62, 4096
    v_mfma_f32_16x16x32_bf16 a[64:67], a[132:135], v[140:143], a[64:67]
    v_mfma_f32_16x16x32_bf16 a[68:71], a[132:135], v[172:175], a[68:71]
    v_mfma_f32_16x16x32_bf16 a[72:75], a[132:135], v[204:207], a[72:75]
    buffer_load_dwordx4 v88, s[32:35], s75 offen lds
    v_mfma_f32_16x16x32_bf16 a[76:79], a[132:135], v[236:239], a[76:79]
    v_mfma_f32_16x16x32_bf16 a[80:83], a[136:139], v[108:111], a[80:83]
    v_mfma_f32_16x16x32_bf16 a[84:87], a[136:139], v[140:143], a[84:87]
    v_mfma_f32_16x16x32_bf16 a[88:91], a[136:139], v[172:175], a[88:91]
    v_mfma_f32_16x16x32_bf16 a[92:95], a[136:139], v[204:207], a[92:95]
    v_mfma_f32_16x16x32_bf16 a[96:99], a[136:139], v[236:239], a[96:99]
    s_waitcnt vmcnt(10) lgkmcnt(0)
    v_mfma_f32_16x16x32_bf16 v[8:11], a[140:143], v[116:119], v[8:11]
    s_barrier
    v_mfma_f32_16x16x32_bf16 v[12:15], a[140:143], v[148:151], v[12:15]
    ds_read_b64_tr_b16 a[100:101], v89 offset:20480
    ds_read_b64_tr_b16 a[102:103], v89 offset:25600
    v_mfma_f32_16x16x32_bf16 v[16:19], a[140:143], v[180:183], v[16:19]
    v_mfma_f32_16x16x32_bf16 v[20:23], a[140:143], v[212:215], v[20:23]
    ds_read_b64_tr_b16 a[104:105], v94 offset:20512
    ds_read_b64_tr_b16 a[106:107], v94 offset:25632
    v_mfma_f32_16x16x32_bf16 v[24:27], a[140:143], v[244:247], v[24:27]
    buffer_load_dwordx4 a[180:183], v90, s[36:39], s53 offen offset:0 sc1
    v_mfma_f32_16x16x32_bf16 v[28:31], a[144:147], v[116:119], v[28:31]
    ds_read_b64_tr_b16 a[108:109], v89 offset:20544
    ds_read_b64_tr_b16 a[110:111], v89 offset:25664
    v_mfma_f32_16x16x32_bf16 v[32:35], a[144:147], v[148:151], v[32:35]
    v_mfma_f32_16x16x32_bf16 v[36:39], a[144:147], v[180:183], v[36:39]
    ds_read_b64_tr_b16 a[112:113], v94 offset:20576
    ds_read_b64_tr_b16 a[114:115], v94 offset:25696
    v_mfma_f32_16x16x32_bf16 v[40:43], a[144:147], v[212:215], v[40:43]
    buffer_load_dwordx4 a[184:187], v90, s[36:39], s53 offen offset:1024 sc1
    v_mfma_f32_16x16x32_bf16 v[44:47], a[144:147], v[244:247], v[44:47]
    ds_read_b64_tr_b16 a[116:117], v89 offset:20608
    ds_read_b64_tr_b16 a[118:119], v89 offset:25728
    v_mfma_f32_16x16x32_bf16 v[48:51], a[148:151], v[116:119], v[48:51]
    v_mfma_f32_16x16x32_bf16 v[52:55], a[148:151], v[148:151], v[52:55]
    ds_read_b64_tr_b16 a[120:121], v94 offset:20640
    ds_read_b64_tr_b16 a[122:123], v94 offset:25760
    v_mfma_f32_16x16x32_bf16 v[56:59], a[148:151], v[180:183], v[56:59]
    buffer_load_dwordx4 a[188:191], v90, s[36:39], s53 offen offset:2048 sc1
    v_mfma_f32_16x16x32_bf16 v[60:63], a[148:151], v[212:215], v[60:63]
    ds_read_b64_tr_b16 a[124:125], v89 offset:20672
    ds_read_b64_tr_b16 a[126:127], v89 offset:25792
    v_mfma_f32_16x16x32_bf16 v[64:67], a[148:151], v[244:247], v[64:67]
    v_mfma_f32_16x16x32_bf16 v[68:71], a[152:155], v[116:119], v[68:71]
    ds_read_b64_tr_b16 a[128:129], v94 offset:20704
    ds_read_b64_tr_b16 a[130:131], v94 offset:25824
    v_mfma_f32_16x16x32_bf16 v[72:75], a[152:155], v[148:151], v[72:75]
    v_mfma_f32_16x16x32_bf16 v[76:79], a[152:155], v[180:183], v[76:79]
    buffer_load_dwordx4 a[192:195], v90, s[36:39], s53 offen offset:3072 sc1
    v_mfma_f32_16x16x32_bf16 v[80:83], a[152:155], v[212:215], v[80:83]
    ds_read_b64_tr_b16 a[132:133], v89 offset:20736
    ds_read_b64_tr_b16 a[134:135], v89 offset:25856
    v_mfma_f32_16x16x32_bf16 v[84:87], a[152:155], v[244:247], v[84:87]
    v_mfma_f32_16x16x32_bf16 v[100:103], a[156:159], v[116:119], v[100:103]
    ds_read_b64_tr_b16 a[136:137], v94 offset:20768
    ds_read_b64_tr_b16 a[138:139], v94 offset:25888
    v_mfma_f32_16x16x32_bf16 v[132:135], a[156:159], v[148:151], v[132:135]
    buffer_load_dwordx4 a[196:199], v91, s[36:39], s53 offen offset:0 sc1
    v_mfma_f32_16x16x32_bf16 v[164:167], a[156:159], v[180:183], v[164:167]
    s_add_u32 s53, s53, 5120
    v_mfma_f32_16x16x32_bf16 v[196:199], a[156:159], v[212:215], v[196:199]
    s_add_u32 s75, s64, 40960
    v_mfma_f32_16x16x32_bf16 v[228:231], a[156:159], v[244:247], v[228:231]
    s_add_u32 m0, s63, 0
    v_mfma_f32_16x16x32_bf16 a[0:3], a[160:163], v[116:119], a[0:3]
    v_mfma_f32_16x16x32_bf16 a[4:7], a[160:163], v[148:151], a[4:7]
    buffer_load_dwordx4 v4, s[32:35], s75 offen offset:0 lds
    v_mfma_f32_16x16x32_bf16 a[8:11], a[160:163], v[180:183], a[8:11]
    v_mfma_f32_16x16x32_bf16 a[12:15], a[160:163], v[212:215], a[12:15]
    v_mfma_f32_16x16x32_bf16 a[16:19], a[160:163], v[244:247], a[16:19]
    v_mfma_f32_16x16x32_bf16 a[20:23], a[164:167], v[116:119], a[20:23]
    buffer_load_dwordx4 v5, s[32:35], s75 offen offset:1024 lds
    v_mfma_f32_16x16x32_bf16 a[24:27], a[164:167], v[148:151], a[24:27]
    v_mfma_f32_16x16x32_bf16 a[28:31], a[164:167], v[180:183], a[28:31]
    v_mfma_f32_16x16x32_bf16 a[32:35], a[164:167], v[212:215], a[32:35]
    v_mfma_f32_16x16x32_bf16 a[36:39], a[164:167], v[244:247], a[36:39]
    buffer_load_dwordx4 v6, s[32:35], s75 offen offset:2048 lds
    v_mfma_f32_16x16x32_bf16 a[40:43], a[168:171], v[116:119], a[40:43]
    v_mfma_f32_16x16x32_bf16 a[44:47], a[168:171], v[148:151], a[44:47]
    v_mfma_f32_16x16x32_bf16 a[48:51], a[168:171], v[180:183], a[48:51]
    v_mfma_f32_16x16x32_bf16 a[52:55], a[168:171], v[212:215], a[52:55]
    v_mfma_f32_16x16x32_bf16 a[56:59], a[168:171], v[244:247], a[56:59]
    buffer_load_dwordx4 v7, s[32:35], s75 offen offset:3072 lds
    v_mfma_f32_16x16x32_bf16 a[60:63], a[172:175], v[116:119], a[60:63]
    s_add_u32 m0, s63, 4096
    v_mfma_f32_16x16x32_bf16 a[64:67], a[172:175], v[148:151], a[64:67]
    v_mfma_f32_16x16x32_bf16 a[68:71], a[172:175], v[180:183], a[68:71]
    v_mfma_f32_16x16x32_bf16 a[72:75], a[172:175], v[212:215], a[72:75]
    buffer_load_dwordx4 v88, s[32:35], s75 offen lds
    v_mfma_f32_16x16x32_bf16 a[76:79], a[172:175], v[244:247], a[76:79]
    v_mfma_f32_16x16x32_bf16 a[80:83], a[176:179], v[116:119], a[80:83]
    v_mfma_f32_16x16x32_bf16 a[84:87], a[176:179], v[148:151], a[84:87]
    v_mfma_f32_16x16x32_bf16 a[88:91], a[176:179], v[180:183], a[88:91]
    v_mfma_f32_16x16x32_bf16 a[92:95], a[176:179], v[212:215], a[92:95]
    v_mfma_f32_16x16x32_bf16 a[96:99], a[176:179], v[244:247], a[96:99]
    s_waitcnt vmcnt(15) lgkmcnt(0)
    v_mfma_f32_16x16x32_bf16 v[8:11], a[100:103], v[124:127], v[8:11]
    s_barrier
    v_mfma_f32_16x16x32_bf16 v[12:15], a[100:103], v[156:159], v[12:15]
    s_cmp_lt_u32 s89, 2
    s_cselect_b32 s53, 2, 1
    ds_read_b64_tr_b16 a[140:141], v0 offset:0
    ds_read_b64_tr_b16 a[142:143], v0 offset:5120
    v_mfma_f32_16x16x32_bf16 v[16:19], a[100:103], v[188:191], v[16:19]
    s_mul_i32 s53, s53, 81920
    v_mfma_f32_16x16x32_bf16 v[20:23], a[100:103], v[220:223], v[20:23]
    s_add_u32 s53, s53, s52
    ds_read_b64_tr_b16 a[144:145], v1 offset:32
    ds_read_b64_tr_b16 a[146:147], v1 offset:5152
    v_mfma_f32_16x16x32_bf16 v[24:27], a[100:103], v[252:255], v[24:27]
    buffer_load_dwordx4 a[200:203], v90, s[36:39], s53 offen offset:0 sc1
    v_mfma_f32_16x16x32_bf16 v[28:31], a[104:107], v[124:127], v[28:31]
    ds_read_b64_tr_b16 a[148:149], v0 offset:64
    ds_read_b64_tr_b16 a[150:151], v0 offset:5184
    v_mfma_f32_16x16x32_bf16 v[32:35], a[104:107], v[156:159], v[32:35]
    v_mfma_f32_16x16x32_bf16 v[36:39], a[104:107], v[188:191], v[36:39]
    ds_read_b64_tr_b16 a[152:153], v1 offset:96
    ds_read_b64_tr_b16 a[154:155], v1 offset:5216
    v_mfma_f32_16x16x32_bf16 v[40:43], a[104:107], v[220:223], v[40:43]
    buffer_load_dwordx4 a[204:207], v90, s[36:39], s53 offen offset:1024 sc1
    v_mfma_f32_16x16x32_bf16 v[44:47], a[104:107], v[252:255], v[44:47]
    ds_read_b64_tr_b16 a[156:157], v0 offset:128
    ds_read_b64_tr_b16 a[158:159], v0 offset:5248
    v_mfma_f32_16x16x32_bf16 v[48:51], a[108:111], v[124:127], v[48:51]
    v_mfma_f32_16x16x32_bf16 v[52:55], a[108:111], v[156:159], v[52:55]
    ds_read_b64_tr_b16 a[160:161], v1 offset:160
    ds_read_b64_tr_b16 a[162:163], v1 offset:5280
    v_mfma_f32_16x16x32_bf16 v[56:59], a[108:111], v[188:191], v[56:59]
    buffer_load_dwordx4 a[208:211], v90, s[36:39], s53 offen offset:2048 sc1
    v_mfma_f32_16x16x32_bf16 v[60:63], a[108:111], v[220:223], v[60:63]
    ds_read_b64_tr_b16 a[164:165], v0 offset:192
    ds_read_b64_tr_b16 a[166:167], v0 offset:5312
    v_mfma_f32_16x16x32_bf16 v[64:67], a[108:111], v[252:255], v[64:67]
    v_mfma_f32_16x16x32_bf16 v[68:71], a[112:115], v[124:127], v[68:71]
    ds_read_b64_tr_b16 a[168:169], v1 offset:224
    ds_read_b64_tr_b16 a[170:171], v1 offset:5344
    v_mfma_f32_16x16x32_bf16 v[72:75], a[112:115], v[156:159], v[72:75]
    v_mfma_f32_16x16x32_bf16 v[76:79], a[112:115], v[188:191], v[76:79]
    buffer_load_dwordx4 a[212:215], v90, s[36:39], s53 offen offset:3072 sc1
    v_mfma_f32_16x16x32_bf16 v[80:83], a[112:115], v[220:223], v[80:83]
    ds_read_b64_tr_b16 a[172:173], v0 offset:256
    ds_read_b64_tr_b16 a[174:175], v0 offset:5376
    v_mfma_f32_16x16x32_bf16 v[84:87], a[112:115], v[252:255], v[84:87]
    v_mfma_f32_16x16x32_bf16 v[100:103], a[116:119], v[124:127], v[100:103]
    ds_read_b64_tr_b16 a[176:177], v1 offset:288
    ds_read_b64_tr_b16 a[178:179], v1 offset:5408
    v_mfma_f32_16x16x32_bf16 v[132:135], a[116:119], v[156:159], v[132:135]
    buffer_load_dwordx4 a[216:219], v91, s[36:39], s53 offen offset:0 sc1
    v_mfma_f32_16x16x32_bf16 v[164:167], a[116:119], v[188:191], v[164:167]
    s_add_u32 s53, s53, 5120
    v_mfma_f32_16x16x32_bf16 v[196:199], a[116:119], v[220:223], v[196:199]
    s_add_u32 s75, s64, 81920
    v_mfma_f32_16x16x32_bf16 v[228:231], a[116:119], v[252:255], v[228:231]
    s_add_u32 m0, s63, 10240
    v_mfma_f32_16x16x32_bf16 a[0:3], a[120:123], v[124:127], a[0:3]
    v_mfma_f32_16x16x32_bf16 a[4:7], a[120:123], v[156:159], a[4:7]
    buffer_load_dwordx4 v4, s[32:35], s75 offen offset:0 lds
    v_mfma_f32_16x16x32_bf16 a[8:11], a[120:123], v[188:191], a[8:11]
    v_mfma_f32_16x16x32_bf16 a[12:15], a[120:123], v[220:223], a[12:15]
    v_mfma_f32_16x16x32_bf16 a[16:19], a[120:123], v[252:255], a[16:19]
    v_mfma_f32_16x16x32_bf16 a[20:23], a[124:127], v[124:127], a[20:23]
    buffer_load_dwordx4 v5, s[32:35], s75 offen offset:1024 lds
    v_mfma_f32_16x16x32_bf16 a[24:27], a[124:127], v[156:159], a[24:27]
    v_mfma_f32_16x16x32_bf16 a[28:31], a[124:127], v[188:191], a[28:31]
    v_mfma_f32_16x16x32_bf16 a[32:35], a[124:127], v[220:223], a[32:35]
    v_mfma_f32_16x16x32_bf16 a[36:39], a[124:127], v[252:255], a[36:39]
    buffer_load_dwordx4 v6, s[32:35], s75 offen offset:2048 lds
    v_mfma_f32_16x16x32_bf16 a[40:43], a[128:131], v[124:127], a[40:43]
    v_mfma_f32_16x16x32_bf16 a[44:47], a[128:131], v[156:159], a[44:47]
    v_mfma_f32_16x16x32_bf16 a[48:51], a[128:131], v[188:191], a[48:51]
    v_mfma_f32_16x16x32_bf16 a[52:55], a[128:131], v[220:223], a[52:55]
    v_mfma_f32_16x16x32_bf16 a[56:59], a[128:131], v[252:255], a[56:59]
    buffer_load_dwordx4 v7, s[32:35], s75 offen offset:3072 lds
    v_mfma_f32_16x16x32_bf16 a[60:63], a[132:135], v[124:127], a[60:63]
    s_add_u32 m0, s63, 14336
    v_mfma_f32_16x16x32_bf16 a[64:67], a[132:135], v[156:159], a[64:67]
    v_mfma_f32_16x16x32_bf16 a[68:71], a[132:135], v[188:191], a[68:71]
    v_mfma_f32_16x16x32_bf16 a[72:75], a[132:135], v[220:223], a[72:75]
    buffer_load_dwordx4 v88, s[32:35], s75 offen lds
    v_mfma_f32_16x16x32_bf16 a[76:79], a[132:135], v[252:255], a[76:79]
    v_mfma_f32_16x16x32_bf16 a[80:83], a[136:139], v[124:127], a[80:83]
    v_mfma_f32_16x16x32_bf16 a[84:87], a[136:139], v[156:159], a[84:87]
    v_mfma_f32_16x16x32_bf16 a[88:91], a[136:139], v[188:191], a[88:91]
    v_mfma_f32_16x16x32_bf16 a[92:95], a[136:139], v[220:223], a[92:95]
    v_mfma_f32_16x16x32_bf16 a[96:99], a[136:139], v[252:255], a[96:99]
    s_waitcnt vmcnt(15) lgkmcnt(0)
    v_mfma_f32_16x16x32_bf16 v[8:11], a[140:143], a[180:183], v[8:11]
    s_barrier
    v_mfma_f32_16x16x32_bf16 v[12:15], a[140:143], a[184:187], v[12:15]
    ds_read_b64_tr_b16 a[100:101], v89 offset:0
    ds_read_b64_tr_b16 a[102:103], v89 offset:5120
    v_mfma_f32_16x16x32_bf16 v[16:19], a[140:143], a[188:191], v[16:19]
    v_mfma_f32_16x16x32_bf16 v[20:23], a[140:143], a[192:195], v[20:23]
    ds_read_b64_tr_b16 a[104:105], v94 offset:32
    ds_read_b64_tr_b16 a[106:107], v94 offset:5152
    v_mfma_f32_16x16x32_bf16 v[24:27], a[140:143], a[196:199], v[24:27]
    buffer_load_dwordx4 a[220:223], v90, s[36:39], s53 offen offset:0 sc1
    v_mfma_f32_16x16x32_bf16 v[28:31], a[144:147], a[180:183], v[28:31]
    ds_read_b64_tr_b16 a[108:109], v89 offset:64
    ds_read_b64_tr_b16 a[110:111], v89 offset:5184
    v_mfma_f32_16x16x32_bf16 v[32:35], a[144:147], a[184:187], v[32:35]
    v_mfma_f32_16x16x32_bf16 v[36:39], a[144:147], a[188:191], v[36:39]
    ds_read_b64_tr_b16 a[112:113], v94 offset:96
    ds_read_b64_tr_b16 a[114:115], v94 offset:5216
    v_mfma_f32_16x16x32_bf16 v[40:43], a[144:147], a[192:195], v[40:43]
    buffer_load_dwordx4 a[224:227], v90, s[36:39], s53 offen offset:1024 sc1
    v_mfma_f32_16x16x32_bf16 v[44:47], a[144:147], a[196:199], v[44:47]
    ds_read_b64_tr_b16 a[116:117], v89 offset:128
    ds_read_b64_tr_b16 a[118:119], v89 offset:5248
    v_mfma_f32_16x16x32_bf16 v[48:51], a[148:151], a[180:183], v[48:51]
    v_mfma_f32_16x16x32_bf16 v[52:55], a[148:151], a[184:187], v[52:55]
    ds_read_b64_tr_b16 a[120:121], v94 offset:160
    ds_read_b64_tr_b16 a[122:123], v94 offset:5280
    v_mfma_f32_16x16x32_bf16 v[56:59], a[148:151], a[188:191], v[56:59]
    buffer_load_dwordx4 a[228:231], v90, s[36:39], s53 offen offset:2048 sc1
    v_mfma_f32_16x16x32_bf16 v[60:63], a[148:151], a[192:195], v[60:63]
    ds_read_b64_tr_b16 a[124:125], v89 offset:192
    ds_read_b64_tr_b16 a[126:127], v89 offset:5312
    v_mfma_f32_16x16x32_bf16 v[64:67], a[148:151], a[196:199], v[64:67]
    v_mfma_f32_16x16x32_bf16 v[68:71], a[152:155], a[180:183], v[68:71]
    ds_read_b64_tr_b16 a[128:129], v94 offset:224
    ds_read_b64_tr_b16 a[130:131], v94 offset:5344
    v_mfma_f32_16x16x32_bf16 v[72:75], a[152:155], a[184:187], v[72:75]
    v_mfma_f32_16x16x32_bf16 v[76:79], a[152:155], a[188:191], v[76:79]
    buffer_load_dwordx4 a[232:235], v90, s[36:39], s53 offen offset:3072 sc1
    v_mfma_f32_16x16x32_bf16 v[80:83], a[152:155], a[192:195], v[80:83]
    ds_read_b64_tr_b16 a[132:133], v89 offset:256
    ds_read_b64_tr_b16 a[134:135], v89 offset:5376
    v_mfma_f32_16x16x32_bf16 v[84:87], a[152:155], a[196:199], v[84:87]
    v_mfma_f32_16x16x32_bf16 v[100:103], a[156:159], a[180:183], v[100:103]
    ds_read_b64_tr_b16 a[136:137], v94 offset:288
    ds_read_b64_tr_b16 a[138:139], v94 offset:5408
    v_mfma_f32_16x16x32_bf16 v[132:135], a[156:159], a[184:187], v[132:135]
    buffer_load_dwordx4 a[236:239], v91, s[36:39], s53 offen offset:0 sc1
    v_mfma_f32_16x16x32_bf16 v[164:167], a[156:159], a[188:191], v[164:167]
    s_add_u32 s53, s53, 5120
    v_mfma_f32_16x16x32_bf16 v[196:199], a[156:159], a[192:195], v[196:199]
    s_add_u32 s75, s64, 122880
    v_mfma_f32_16x16x32_bf16 v[228:231], a[156:159], a[196:199], v[228:231]
    s_add_u32 m0, s63, 20480
    v_mfma_f32_16x16x32_bf16 a[0:3], a[160:163], a[180:183], a[0:3]
    v_mfma_f32_16x16x32_bf16 a[4:7], a[160:163], a[184:187], a[4:7]
    buffer_load_dwordx4 v4, s[32:35], s75 offen offset:0 lds
    v_mfma_f32_16x16x32_bf16 a[8:11], a[160:163], a[188:191], a[8:11]
    v_mfma_f32_16x16x32_bf16 a[12:15], a[160:163], a[192:195], a[12:15]
    v_mfma_f32_16x16x32_bf16 a[16:19], a[160:163], a[196:199], a[16:19]
    v_mfma_f32_16x16x32_bf16 a[20:23], a[164:167], a[180:183], a[20:23]
    buffer_load_dwordx4 v5, s[32:35], s75 offen offset:1024 lds
    v_mfma_f32_16x16x32_bf16 a[24:27], a[164:167], a[184:187], a[24:27]
    v_mfma_f32_16x16x32_bf16 a[28:31], a[164:167], a[188:191], a[28:31]
    v_mfma_f32_16x16x32_bf16 a[32:35], a[164:167], a[192:195], a[32:35]
    v_mfma_f32_16x16x32_bf16 a[36:39], a[164:167], a[196:199], a[36:39]
    buffer_load_dwordx4 v6, s[32:35], s75 offen offset:2048 lds
    v_mfma_f32_16x16x32_bf16 a[40:43], a[168:171], a[180:183], a[40:43]
    v_mfma_f32_16x16x32_bf16 a[44:47], a[168:171], a[184:187], a[44:47]
    v_mfma_f32_16x16x32_bf16 a[48:51], a[168:171], a[188:191], a[48:51]
    v_mfma_f32_16x16x32_bf16 a[52:55], a[168:171], a[192:195], a[52:55]
    v_mfma_f32_16x16x32_bf16 a[56:59], a[168:171], a[196:199], a[56:59]
    buffer_load_dwordx4 v7, s[32:35], s75 offen offset:3072 lds
    v_mfma_f32_16x16x32_bf16 a[60:63], a[172:175], a[180:183], a[60:63]
    s_add_u32 m0, s63, 24576
    v_mfma_f32_16x16x32_bf16 a[64:67], a[172:175], a[184:187], a[64:67]
    v_mfma_f32_16x16x32_bf16 a[68:71], a[172:175], a[188:191], a[68:71]
    v_mfma_f32_16x16x32_bf16 a[72:75], a[172:175], a[192:195], a[72:75]
    buffer_load_dwordx4 v88, s[32:35], s75 offen lds
    v_mfma_f32_16x16x32_bf16 a[76:79], a[172:175], a[196:199], a[76:79]
    v_mfma_f32_16x16x32_bf16 a[80:83], a[176:179], a[180:183], a[80:83]
    v_mfma_f32_16x16x32_bf16 a[84:87], a[176:179], a[184:187], a[84:87]
    v_mfma_f32_16x16x32_bf16 a[88:91], a[176:179], a[188:191], a[88:91]
    v_mfma_f32_16x16x32_bf16 a[92:95], a[176:179], a[192:195], a[92:95]
    v_mfma_f32_16x16x32_bf16 a[96:99], a[176:179], a[196:199], a[96:99]
    s_waitcnt vmcnt(15) lgkmcnt(0)
    v_mfma_f32_16x16x32_bf16 v[8:11], a[100:103], a[200:203], v[8:11]
    s_barrier
    v_mfma_f32_16x16x32_bf16 v[12:15], a[100:103], a[204:207], v[12:15]
    ds_read_b64_tr_b16 a[140:141], v3 offset:0
    ds_read_b64_tr_b16 a[142:143], v3 offset:5120
    v_mfma_f32_16x16x32_bf16 v[16:19], a[100:103], a[208:211], v[16:19]
    v_mfma_f32_16x16x32_bf16 v[20:23], a[100:103], a[212:215], v[20:23]
    ds_read_b64_tr_b16 a[144:145], v2 offset:32
    ds_read_b64_tr_b16 a[146:147], v2 offset:5152
    v_mfma_f32_16x16x32_bf16 v[24:27], a[100:103], a[216:219], v[24:27]
    buffer_load_dwordx4 v[96:99], v90, s[36:39], s53 offen offset:0 sc1
    v_mfma_f32_16x16x32_bf16 v[28:31], a[104:107], a[200:203], v[28:31]
    ds_read_b64_tr_b16 a[148:149], v3 offset:64
    ds_read_b64_tr_b16 a[150:151], v3 offset:5184
    v_mfma_f32_16x16x32_bf16 v[32:35], a[104:107], a[204:207], v[32:35]
    v_mfma_f32_16x16x32_bf16 v[36:39], a[104:107], a[208:211], v[36:39]
    ds_read_b64_tr_b16 a[152:153], v2 offset:96
    ds_read_b64_tr_b16 a[154:155], v2 offset:5216
    v_mfma_f32_16x16x32_bf16 v[40:43], a[104:107], a[212:215], v[40:43]
    buffer_load_dwordx4 v[128:131], v90, s[36:39], s53 offen offset:1024 sc1
    v_mfma_f32_16x16x32_bf16 v[44:47], a[104:107], a[216:219], v[44:47]
    ds_read_b64_tr_b16 a[156:157], v3 offset:128
    ds_read_b64_tr_b16 a[158:159], v3 offset:5248
    v_mfma_f32_16x16x32_bf16 v[48:51], a[108:111], a[200:203], v[48:51]
    v_mfma_f32_16x16x32_bf16 v[52:55], a[108:111], a[204:207], v[52:55]
    ds_read_b64_tr_b16 a[160:161], v2 offset:160
    ds_read_b64_tr_b16 a[162:163], v2 offset:5280
    v_mfma_f32_16x16x32_bf16 v[56:59], a[108:111], a[208:211], v[56:59]
    buffer_load_dwordx4 v[160:163], v90, s[36:39], s53 offen offset:2048 sc1
    v_mfma_f32_16x16x32_bf16 v[60:63], a[108:111], a[212:215], v[60:63]
    ds_read_b64_tr_b16 a[164:165], v3 offset:192
    ds_read_b64_tr_b16 a[166:167], v3 offset:5312
    v_mfma_f32_16x16x32_bf16 v[64:67], a[108:111], a[216:219], v[64:67]
    v_mfma_f32_16x16x32_bf16 v[68:71], a[112:115], a[200:203], v[68:71]
    ds_read_b64_tr_b16 a[168:169], v2 offset:224
    ds_read_b64_tr_b16 a[170:171], v2 offset:5344
    v_mfma_f32_16x16x32_bf16 v[72:75], a[112:115], a[204:207], v[72:75]
    v_mfma_f32_16x16x32_bf16 v[76:79], a[112:115], a[208:211], v[76:79]
    buffer_load_dwordx4 v[192:195], v90, s[36:39], s53 offen offset:3072 sc1
    v_mfma_f32_16x16x32_bf16 v[80:83], a[112:115], a[212:215], v[80:83]
    ds_read_b64_tr_b16 a[172:173], v3 offset:256
    ds_read_b64_tr_b16 a[174:175], v3 offset:5376
    v_mfma_f32_16x16x32_bf16 v[84:87], a[112:115], a[216:219], v[84:87]
    v_mfma_f32_16x16x32_bf16 v[100:103], a[116:119], a[200:203], v[100:103]
    ds_read_b64_tr_b16 a[176:177], v2 offset:288
    ds_read_b64_tr_b16 a[178:179], v2 offset:5408
    v_mfma_f32_16x16x32_bf16 v[132:135], a[116:119], a[204:207], v[132:135]
    buffer_load_dwordx4 v[224:227], v91, s[36:39], s53 offen offset:0 sc1
    v_mfma_f32_16x16x32_bf16 v[164:167], a[116:119], a[208:211], v[164:167]
    s_add_u32 s53, s53, 5120
    v_mfma_f32_16x16x32_bf16 v[196:199], a[116:119], a[212:215], v[196:199]
    s_add_u32 s75, s65, 0
    v_mfma_f32_16x16x32_bf16 v[228:231], a[116:119], a[216:219], v[228:231]
    s_add_u32 m0, s62, 10240
    v_mfma_f32_16x16x32_bf16 a[0:3], a[120:123], a[200:203], a[0:3]
    v_mfma_f32_16x16x32_bf16 a[4:7], a[120:123], a[204:207], a[4:7]
    buffer_load_dwordx4 v4, s[32:35], s75 offen offset:0 lds
    v_mfma_f32_16x16x32_bf16 a[8:11], a[120:123], a[208:211], a[8:11]
    v_mfma_f32_16x16x32_bf16 a[12:15], a[120:123], a[212:215], a[12:15]
    v_mfma_f32_16x16x32_bf16 a[16:19], a[120:123], a[216:219], a[16:19]
    v_mfma_f32_16x16x32_bf16 a[20:23], a[124:127], a[200:203], a[20:23]
    buffer_load_dwordx4 v5, s[32:35], s75 offen offset:1024 lds
    v_mfma_f32_16x16x32_bf16 a[24:27], a[124:127], a[204:207], a[24:27]
    v_mfma_f32_16x16x32_bf16 a[28:31], a[124:127], a[208:211], a[28:31]
    v_mfma_f32_16x16x32_bf16 a[32:35], a[124:127], a[212:215], a[32:35]
    v_mfma_f32_16x16x32_bf16 a[36:39], a[124:127], a[216:219], a[36:39]
    buffer_load_dwordx4 v6, s[32:35], s75 offen offset:2048 lds
    v_mfma_f32_16x16x32_bf16 a[40:43], a[128:131], a[200:203], a[40:43]
    v_mfma_f32_16x16x32_bf16 a[44:47], a[128:131], a[204:207], a[44:47]
    v_mfma_f32_16x16x32_bf16 a[48:51], a[128:131], a[208:211], a[48:51]
    v_mfma_f32_16x16x32_bf16 a[52:55], a[128:131], a[212:215], a[52:55]
    v_mfma_f32_16x16x32_bf16 a[56:59], a[128:131], a[216:219], a[56:59]
    buffer_load_dwordx4 v7, s[32:35], s75 offen offset:3072 lds
    v_mfma_f32_16x16x32_bf16 a[60:63], a[132:135], a[200:203], a[60:63]
    s_add_u32 m0, s62, 14336
    v_mfma_f32_16x16x32_bf16 a[64:67], a[132:135], a[204:207], a[64:67]
    v_mfma_f32_16x16x32_bf16 a[68:71], a[132:135], a[208:211], a[68:71]
    v_mfma_f32_16x16x32_bf16 a[72:75], a[132:135], a[212:215], a[72:75]
    buffer_load_dwordx4 v88, s[32:35], s75 offen lds
    v_mfma_f32_16x16x32_bf16 a[76:79], a[132:135], a[216:219], a[76:79]
    v_mfma_f32_16x16x32_bf16 a[80:83], a[136:139], a[200:203], a[80:83]
    v_mfma_f32_16x16x32_bf16 a[84:87], a[136:139], a[204:207], a[84:87]
    v_mfma_f32_16x16x32_bf16 a[88:91], a[136:139], a[208:211], a[88:91]
    v_mfma_f32_16x16x32_bf16 a[92:95], a[136:139], a[212:215], a[92:95]
    v_mfma_f32_16x16x32_bf16 a[96:99], a[136:139], a[216:219], a[96:99]
    s_waitcnt vmcnt(15) lgkmcnt(0)
    v_mfma_f32_16x16x32_bf16 v[8:11], a[140:143], a[220:223], v[8:11]
    s_barrier
    v_mfma_f32_16x16x32_bf16 v[12:15], a[140:143], a[224:227], v[12:15]
    ds_read_b64_tr_b16 a[100:101], v3 offset:10240
    ds_read_b64_tr_b16 a[102:103], v3 offset:15360
    v_mfma_f32_16x16x32_bf16 v[16:19], a[140:143], a[228:231], v[16:19]
    v_mfma_f32_16x16x32_bf16 v[20:23], a[140:143], a[232:235], v[20:23]
    ds_read_b64_tr_b16 a[104:105], v2 offset:10272
    ds_read_b64_tr_b16 a[106:107], v2 offset:15392
    v_mfma_f32_16x16x32_bf16 v[24:27], a[140:143], a[236:239], v[24:27]
    buffer_load_dwordx4 v[104:107], v90, s[36:39], s53 offen offset:0 sc1
    v_mfma_f32_16x16x32_bf16 v[28:31], a[144:147], a[220:223], v[28:31]
    ds_read_b64_tr_b16 a[108:109], v3 offset:10304
    ds_read_b64_tr_b16 a[110:111], v3 offset:15424
    v_mfma_f32_16x16x32_bf16 v[32:35], a[144:147], a[224:227], v[32:35]
    v_mfma_f32_16x16x32_bf16 v[36:39], a[144:147], a[228:231], v[36:39]
    ds_read_b64_tr_b16 a[112:113], v2 offset:10336
    ds_read_b64_tr_b16 a[114:115], v2 offset:15456
    v_mfma_f32_16x16x32_bf16 v[40:43], a[144:147], a[232:235], v[40:43]
    buffer_load_dwordx4 v[136:139], v90, s[36:39], s53 offen offset:1024 sc1
    v_mfma_f32_16x16x32_bf16 v[44:47], a[144:147], a[236:239], v[44:47]
    ds_read_b64_tr_b16 a[116:117], v3 offset:10368
    ds_read_b64_tr_b16 a[118:119], v3 offset:15488
    v_mfma_f32_16x16x32_bf16 v[48:51], a[148:151], a[220:223], v[48:51]
    v_mfma_f32_16x16x32_bf16 v[52:55], a[148:151], a[224:227], v[52:55]
    ds_read_b64_tr_b16 a[120:121], v2 offset:10400
    ds_read_b64_tr_b16 a[122:123], v2 offset:15520
    v_mfma_f32_16x16x32_bf16 v[56:59], a[148:151], a[228:231], v[56:59]
    buffer_load_dwordx4 v[168:171], v90, s[36:39], s53 offen offset:2048 sc1
    v_mfma_f32_16x16x32_bf16 v[60:63], a[148:151], a[232:235], v[60:63]
    ds_read_b64_tr_b16 a[124:125], v3 offset:10432
    ds_read_b64_tr_b16 a[126:127], v3 offset:15552
    v_mfma_f32_16x16x32_bf16 v[64:67], a[148:151], a[236:239], v[64:67]
    v_mfma_f32_16x16x32_bf16 v[68:71], a[152:155], a[220:223], v[68:71]
    ds_read_b64_tr_b16 a[128:129], v2 offset:10464
    ds_read_b64_tr_b16 a[130:131], v2 offset:15584
    v_mfma_f32_16x16x32_bf16 v[72:75], a[152:155], a[224:227], v[72:75]
    v_mfma_f32_16x16x32_bf16 v[76:79], a[152:155], a[228:231], v[76:79]
    buffer_load_dwordx4 v[200:203], v90, s[36:39], s53 offen offset:3072 sc1
    v_mfma_f32_16x16x32_bf16 v[80:83], a[152:155], a[232:235], v[80:83]
    ds_read_b64_tr_b16 a[132:133], v3 offset:10496
    ds_read_b64_tr_b16 a[134:135], v3 offset:15616
    v_mfma_f32_16x16x32_bf16 v[84:87], a[152:155], a[236:239], v[84:87]
    v_mfma_f32_16x16x32_bf16 v[100:103], a[156:159], a[220:223], v[100:103]
    ds_read_b64_tr_b16 a[136:137], v2 offset:10528
    ds_read_b64_tr_b16 a[138:139], v2 offset:15648
    v_mfma_f32_16x16x32_bf16 v[132:135], a[156:159], a[224:227], v[132:135]
    buffer_load_dwordx4 v[232:235], v91, s[36:39], s53 offen offset:0 sc1
    v_mfma_f32_16x16x32_bf16 v[164:167], a[156:159], a[228:231], v[164:167]
    s_add_u32 s53, s53, 5120
    v_mfma_f32_16x16x32_bf16 v[196:199], a[156:159], a[232:235], v[196:199]
    s_add_u32 s75, s65, 40960
    v_mfma_f32_16x16x32_bf16 v[228:231], a[156:159], a[236:239], v[228:231]
    s_add_u32 m0, s62, 20480
    v_mfma_f32_16x16x32_bf16 a[0:3], a[160:163], a[220:223], a[0:3]
    v_mfma_f32_16x16x32_bf16 a[4:7], a[160:163], a[224:227], a[4:7]
    buffer_load_dwordx4 v4, s[32:35], s75 offen offset:0 lds
    v_mfma_f32_16x16x32_bf16 a[8:11], a[160:163], a[228:231], a[8:11]
    v_mfma_f32_16x16x32_bf16 a[12:15], a[160:163], a[232:235], a[12:15]
    v_mfma_f32_16x16x32_bf16 a[16:19], a[160:163], a[236:239], a[16:19]
    v_mfma_f32_16x16x32_bf16 a[20:23], a[164:167], a[220:223], a[20:23]
    buffer_load_dwordx4 v5, s[32:35], s75 offen offset:1024 lds
    v_mfma_f32_16x16x32_bf16 a[24:27], a[164:167], a[224:227], a[24:27]
    v_mfma_f32_16x16x32_bf16 a[28:31], a[164:167], a[228:231], a[28:31]
    v_mfma_f32_16x16x32_bf16 a[32:35], a[164:167], a[232:235], a[32:35]
    v_mfma_f32_16x16x32_bf16 a[36:39], a[164:167], a[236:239], a[36:39]
    buffer_load_dwordx4 v6, s[32:35], s75 offen offset:2048 lds
    v_mfma_f32_16x16x32_bf16 a[40:43], a[168:171], a[220:223], a[40:43]
    v_mfma_f32_16x16x32_bf16 a[44:47], a[168:171], a[224:227], a[44:47]
    v_mfma_f32_16x16x32_bf16 a[48:51], a[168:171], a[228:231], a[48:51]
    v_mfma_f32_16x16x32_bf16 a[52:55], a[168:171], a[232:235], a[52:55]
    v_mfma_f32_16x16x32_bf16 a[56:59], a[168:171], a[236:239], a[56:59]
    buffer_load_dwordx4 v7, s[32:35], s75 offen offset:3072 lds
    v_mfma_f32_16x16x32_bf16 a[60:63], a[172:175], a[220:223], a[60:63]
    s_add_u32 m0, s62, 24576
    v_mfma_f32_16x16x32_bf16 a[64:67], a[172:175], a[224:227], a[64:67]
    v_mfma_f32_16x16x32_bf16 a[68:71], a[172:175], a[228:231], a[68:71]
    v_mfma_f32_16x16x32_bf16 a[72:75], a[172:175], a[232:235], a[72:75]
    buffer_load_dwordx4 v88, s[32:35], s75 offen lds
    v_mfma_f32_16x16x32_bf16 a[76:79], a[172:175], a[236:239], a[76:79]
    v_mfma_f32_16x16x32_bf16 a[80:83], a[176:179], a[220:223], a[80:83]
    v_mfma_f32_16x16x32_bf16 a[84:87], a[176:179], a[224:227], a[84:87]
    v_mfma_f32_16x16x32_bf16 a[88:91], a[176:179], a[228:231], a[88:91]
    v_mfma_f32_16x16x32_bf16 a[92:95], a[176:179], a[232:235], a[92:95]
    v_mfma_f32_16x16x32_bf16 a[96:99], a[176:179], a[236:239], a[96:99]
    s_waitcnt vmcnt(15) lgkmcnt(0)
    v_mfma_f32_16x16x32_bf16 v[8:11], a[100:103], v[96:99], v[8:11]
    s_barrier
    v_mfma_f32_16x16x32_bf16 v[12:15], a[100:103], v[128:131], v[12:15]
    s_cmp_lt_u32 s89, 3
    s_cselect_b32 s53, 3, 2
    ds_read_b64_tr_b16 a[140:141], v3 offset:20480
    ds_read_b64_tr_b16 a[142:143], v3 offset:25600
    v_mfma_f32_16x16x32_bf16 v[16:19], a[100:103], v[160:163], v[16:19]
    s_mul_i32 s53, s53, 81920
    v_mfma_f32_16x16x32_bf16 v[20:23], a[100:103], v[192:195], v[20:23]
    s_add_u32 s53, s53, s52
    ds_read_b64_tr_b16 a[144:145], v2 offset:20512
    ds_read_b64_tr_b16 a[146:147], v2 offset:25632
    v_mfma_f32_16x16x32_bf16 v[24:27], a[100:103], v[224:227], v[24:27]
    buffer_load_dwordx4 v[112:115], v90, s[36:39], s53 offen offset:0 sc1
    v_mfma_f32_16x16x32_bf16 v[28:31], a[104:107], v[96:99], v[28:31]
    ds_read_b64_tr_b16 a[148:149], v3 offset:20544
    ds_read_b64_tr_b16 a[150:151], v3 offset:25664
    v_mfma_f32_16x16x32_bf16 v[32:35], a[104:107], v[128:131], v[32:35]
    v_mfma_f32_16x16x32_bf16 v[36:39], a[104:107], v[160:163], v[36:39]
    ds_read_b64_tr_b16 a[152:153], v2 offset:20576
    ds_read_b64_tr_b16 a[154:155], v2 offset:25696
    v_mfma_f32_16x16x32_bf16 v[40:43], a[104:107], v[192:195], v[40:43]
    buffer_load_dwordx4 v[144:147], v90, s[36:39], s53 offen offset:1024 sc1
    v_mfma_f32_16x16x32_bf16 v[44:47], a[104:107], v[224:227], v[44:47]
    ds_read_b64_tr_b16 a[156:157], v3 offset:20608
    ds_read_b64_tr_b16 a[158:159], v3 offset:25728
    v_mfma_f32_16x16x32_bf16 v[48:51], a[108:111], v[96:99], v[48:51]
    v_mfma_f32_16x16x32_bf16 v[52:55], a[108:111], v[128:131], v[52:55]
    ds_read_b64_tr_b16 a[160:161], v2 offset:20640
    ds_read_b64_tr_b16 a[162:163], v2 offset:25760
    v_mfma_f32_16x16x32_bf16 v[56:59], a[108:111], v[160:163], v[56:59]
    buffer_load_dwordx4 v[176:179], v90, s[36:39], s53 offen offset:2048 sc1
    v_mfma_f32_16x16x32_bf16 v[60:63], a[108:111], v[192:195], v[60:63]
    ds_read_b64_tr_b16 a[164:165], v3 offset:20672
    ds_read_b64_tr_b16 a[166:167], v3 offset:25792
    v_mfma_f32_16x16x32_bf16 v[64:67], a[108:111], v[224:227], v[64:67]
    v_mfma_f32_16x16x32_bf16 v[68:71], a[112:115], v[96:99], v[68:71]
    ds_read_b64_tr_b16 a[168:169], v2 offset:20704
    ds_read_b64_tr_b16 a[170:171], v2 offset:25824
    v_mfma_f32_16x16x32_bf16 v[72:75], a[112:115], v[128:131], v[72:75]
    v_mfma_f32_16x16x32_bf16 v[76:79], a[112:115], v[160:163], v[76:79]
    buffer_load_dwordx4 v[208:211], v90, s[36:39], s53 offen offset:3072 sc1
    v_mfma_f32_16x16x32_bf16 v[80:83], a[112:115], v[192:195], v[80:83]
    ds_read_b64_tr_b16 a[172:173], v3 offset:20736
    ds_read_b64_tr_b16 a[174:175], v3 offset:25856
    v_mfma_f32_16x16x32_bf16 v[84:87], a[112:115], v[224:227], v[84:87]
    v_mfma_f32_16x16x32_bf16 v[100:103], a[116:119], v[96:99], v[100:103]
    ds_read_b64_tr_b16 a[176:177], v2 offset:20768
    ds_read_b64_tr_b16 a[178:179], v2 offset:25888
    v_mfma_f32_16x16x32_bf16 v[132:135], a[116:119], v[128:131], v[132:135]
    buffer_load_dwordx4 v[240:243], v91, s[36:39], s53 offen offset:0 sc1
    v_mfma_f32_16x16x32_bf16 v[164:167], a[116:119], v[160:163], v[164:167]
    s_add_u32 s53, s53, 5120
    v_mfma_f32_16x16x32_bf16 v[196:199], a[116:119], v[192:195], v[196:199]
    s_add_u32 s75, s65, 81920
    v_mfma_f32_16x16x32_bf16 v[228:231], a[116:119], v[224:227], v[228:231]
    s_add_u32 m0, s92, 0
    v_mfma_f32_16x16x32_bf16 a[0:3], a[120:123], v[96:99], a[0:3]
    v_mfma_f32_16x16x32_bf16 a[4:7], a[120:123], v[128:131], a[4:7]
    buffer_load_dwordx4 v4, s[32:35], s75 offen offset:0 lds
    v_mfma_f32_16x16x32_bf16 a[8:11], a[120:123], v[160:163], a[8:11]
    v_mfma_f32_16x16x32_bf16 a[12:15], a[120:123], v[192:195], a[12:15]
    v_mfma_f32_16x16x32_bf16 a[16:19], a[120:123], v[224:227], a[16:19]
    v_mfma_f32_16x16x32_bf16 a[20:23], a[124:127], v[96:99], a[20:23]
    buffer_load_dwordx4 v5, s[32:35], s75 offen offset:1024 lds
    v_mfma_f32_16x16x32_bf16 a[24:27], a[124:127], v[128:131], a[24:27]
    v_mfma_f32_16x16x32_bf16 a[28:31], a[124:127], v[160:163], a[28:31]
    v_mfma_f32_16x16x32_bf16 a[32:35], a[124:127], v[192:195], a[32:35]
    v_mfma_f32_16x16x32_bf16 a[36:39], a[124:127], v[224:227], a[36:39]
    buffer_load_dwordx4 v6, s[32:35], s75 offen offset:2048 lds
    v_mfma_f32_16x16x32_bf16 a[40:43], a[128:131], v[96:99], a[40:43]
    v_mfma_f32_16x16x32_bf16 a[44:47], a[128:131], v[128:131], a[44:47]
    v_mfma_f32_16x16x32_bf16 a[48:51], a[128:131], v[160:163], a[48:51]
    v_mfma_f32_16x16x32_bf16 a[52:55], a[128:131], v[192:195], a[52:55]
    v_mfma_f32_16x16x32_bf16 a[56:59], a[128:131], v[224:227], a[56:59]
    buffer_load_dwordx4 v7, s[32:35], s75 offen offset:3072 lds
    v_mfma_f32_16x16x32_bf16 a[60:63], a[132:135], v[96:99], a[60:63]
    s_add_u32 m0, s92, 4096
    v_mfma_f32_16x16x32_bf16 a[64:67], a[132:135], v[128:131], a[64:67]
    v_mfma_f32_16x16x32_bf16 a[68:71], a[132:135], v[160:163], a[68:71]
    v_mfma_f32_16x16x32_bf16 a[72:75], a[132:135], v[192:195], a[72:75]
    buffer_load_dwordx4 v88, s[32:35], s75 offen lds
    v_mfma_f32_16x16x32_bf16 a[76:79], a[132:135], v[224:227], a[76:79]
    v_mfma_f32_16x16x32_bf16 a[80:83], a[136:139], v[96:99], a[80:83]
    v_mfma_f32_16x16x32_bf16 a[84:87], a[136:139], v[128:131], a[84:87]
    v_mfma_f32_16x16x32_bf16 a[88:91], a[136:139], v[160:163], a[88:91]
    v_mfma_f32_16x16x32_bf16 a[92:95], a[136:139], v[192:195], a[92:95]
    v_mfma_f32_16x16x32_bf16 a[96:99], a[136:139], v[224:227], a[96:99]
    s_waitcnt vmcnt(15) lgkmcnt(0)
    v_mfma_f32_16x16x32_bf16 v[8:11], a[140:143], v[104:107], v[8:11]
    s_barrier
    v_mfma_f32_16x16x32_bf16 v[12:15], a[140:143], v[136:139], v[12:15]
    ds_read_b64_tr_b16 a[100:101], v89 offset:10240
    ds_read_b64_tr_b16 a[102:103], v89 offset:15360
    v_mfma_f32_16x16x32_bf16 v[16:19], a[140:143], v[168:171], v[16:19]
    v_mfma_f32_16x16x32_bf16 v[20:23], a[140:143], v[200:203], v[20:23]
    ds_read_b64_tr_b16 a[104:105], v94 offset:10272
    ds_read_b64_tr_b16 a[106:107], v94 offset:15392
    v_mfma_f32_16x16x32_bf16 v[24:27], a[140:143], v[232:235], v[24:27]
    buffer_load_dwordx4 v[120:123], v90, s[36:39], s53 offen offset:0 sc1
    v_mfma_f32_16x16x32_bf16 v[28:31], a[144:147], v[104:107], v[28:31]
    ds_read_b64_tr_b16 a[108:109], v89 offset:10304
    ds_read_b64_tr_b16 a[110:111], v89 offset:15424
    v_mfma_f32_16x16x32_bf16 v[32:35], a[144:147], v[136:139], v[32:35]
    v_mfma_f32_16x16x32_bf16 v[36:39], a[144:147], v[168:171], v[36:39]
    ds_read_b64_tr_b16 a[112:113], v94 offset:10336
    ds_read_b64_tr_b16 a[114:115], v94 offset:15456
    v_mfma_f32_16x16x32_bf16 v[40:43], a[144:147], v[200:203], v[40:43]
    buffer_load_dwordx4 v[152:155], v90, s[36:39], s53 offen offset:1024 sc1
    v_mfma_f32_16x16x32_bf16 v[44:47], a[144:147], v[232:235], v[44:47]
    ds_read_b64_tr_b16 a[116:117], v89 offset:10368
    ds_read_b64_tr_b16 a[118:119], v89 offset:15488
    v_mfma_f32_16x16x32_bf16 v[48:51], a[148:151], v[104:107], v[48:51]
    v_mfma_f32_16x16x32_bf16 v[52:55], a[148:151], v[136:139], v[52:55]
    ds_read_b64_tr_b16 a[120:121], v94 offset:10400
    ds_read_b64_tr_b16 a[122:123], v94 offset:15520
    v_mfma_f32_16x16x32_bf16 v[56:59], a[148:151], v[168:171], v[56:59]
    buffer_load_dwordx4 v[184:187], v90, s[36:39], s53 offen offset:2048 sc1
    v_mfma_f32_16x16x32_bf16 v[60:63], a[148:151], v[200:203], v[60:63]
    ds_read_b64_tr_b16 a[124:125], v89 offset:10432
    ds_read_b64_tr_b16 a[126:127], v89 offset:15552
    v_mfma_f32_16x16x32_bf16 v[64:67], a[148:151], v[232:235], v[64:67]
    v_mfma_f32_16x16x32_bf16 v[68:71], a[152:155], v[104:107], v[68:71]
    ds_read_b64_tr_b16 a[128:129], v94 offset:10464
    ds_read_b64_tr_b16 a[130:131], v94 offset:15584
    v_mfma_f32_16x16x32_bf16 v[72:75], a[152:155], v[136:139], v[72:75]
    v_mfma_f32_16x16x32_bf16 v[76:79], a[152:155], v[168:171], v[76:79]
    buffer_load_dwordx4 v[216:219], v90, s[36:39], s53 offen offset:3072 sc1
    v_mfma_f32_16x16x32_bf16 v[80:83], a[152:155], v[200:203], v[80:83]
    ds_read_b64_tr_b16 a[132:133], v89 offset:10496
    ds_read_b64_tr_b16 a[134:135], v89 offset:15616
    v_mfma_f32_16x16x32_bf16 v[84:87], a[152:155], v[232:235], v[84:87]
    v_mfma_f32_16x16x32_bf16 v[100:103], a[156:159], v[104:107], v[100:103]
    ds_read_b64_tr_b16 a[136:137], v94 offset:10528
    ds_read_b64_tr_b16 a[138:139], v94 offset:15648
    v_mfma_f32_16x16x32_bf16 v[132:135], a[156:159], v[136:139], v[132:135]
    buffer_load_dwordx4 v[248:251], v91, s[36:39], s53 offen offset:0 sc1
    v_mfma_f32_16x16x32_bf16 v[164:167], a[156:159], v[168:171], v[164:167]
    s_add_u32 s53, s53, 5120
    v_mfma_f32_16x16x32_bf16 v[196:199], a[156:159], v[200:203], v[196:199]
    s_add_u32 s75, s65, 122880
    v_mfma_f32_16x16x32_bf16 v[228:231], a[156:159], v[232:235], v[228:231]
    s_add_u32 m0, s62, 0
    v_mfma_f32_16x16x32_bf16 a[0:3], a[160:163], v[104:107], a[0:3]
    v_mfma_f32_16x16x32_bf16 a[4:7], a[160:163], v[136:139], a[4:7]
    buffer_load_dwordx4 v4, s[32:35], s75 offen offset:0 lds
    v_mfma_f32_16x16x32_bf16 a[8:11], a[160:163], v[168:171], a[8:11]
    v_mfma_f32_16x16x32_bf16 a[12:15], a[160:163], v[200:203], a[12:15]
    v_mfma_f32_16x16x32_bf16 a[16:19], a[160:163], v[232:235], a[16:19]
    v_mfma_f32_16x16x32_bf16 a[20:23], a[164:167], v[104:107], a[20:23]
    buffer_load_dwordx4 v5, s[32:35], s75 offen offset:1024 lds
    v_mfma_f32_16x16x32_bf16 a[24:27], a[164:167], v[136:139], a[24:27]
    v_mfma_f32_16x16x32_bf16 a[28:31], a[164:167], v[168:171], a[28:31]
    v_mfma_f32_16x16x32_bf16 a[32:35], a[164:167], v[200:203], a[32:35]
    v_mfma_f32_16x16x32_bf16 a[36:39], a[164:167], v[232:235], a[36:39]
    buffer_load_dwordx4 v6, s[32:35], s75 offen offset:2048 lds
    v_mfma_f32_16x16x32_bf16 a[40:43], a[168:171], v[104:107], a[40:43]
    v_mfma_f32_16x16x32_bf16 a[44:47], a[168:171], v[136:139], a[44:47]
    v_mfma_f32_16x16x32_bf16 a[48:51], a[168:171], v[168:171], a[48:51]
    v_mfma_f32_16x16x32_bf16 a[52:55], a[168:171], v[200:203], a[52:55]
    v_mfma_f32_16x16x32_bf16 a[56:59], a[168:171], v[232:235], a[56:59]
    buffer_load_dwordx4 v7, s[32:35], s75 offen offset:3072 lds
    v_mfma_f32_16x16x32_bf16 a[60:63], a[172:175], v[104:107], a[60:63]
    s_add_u32 m0, s62, 4096
    v_mfma_f32_16x16x32_bf16 a[64:67], a[172:175], v[136:139], a[64:67]
    v_mfma_f32_16x16x32_bf16 a[68:71], a[172:175], v[168:171], a[68:71]
    v_mfma_f32_16x16x32_bf16 a[72:75], a[172:175], v[200:203], a[72:75]
    buffer_load_dwordx4 v88, s[32:35], s75 offen lds
    v_mfma_f32_16x16x32_bf16 a[76:79], a[172:175], v[232:235], a[76:79]
    v_mfma_f32_16x16x32_bf16 a[80:83], a[176:179], v[104:107], a[80:83]
    v_mfma_f32_16x16x32_bf16 a[84:87], a[176:179], v[136:139], a[84:87]
    v_mfma_f32_16x16x32_bf16 a[88:91], a[176:179], v[168:171], a[88:91]
    v_mfma_f32_16x16x32_bf16 a[92:95], a[176:179], v[200:203], a[92:95]
    v_mfma_f32_16x16x32_bf16 a[96:99], a[176:179], v[232:235], a[96:99]
    s_waitcnt vmcnt(15) lgkmcnt(0)
    v_mfma_f32_16x16x32_bf16 v[8:11], a[100:103], v[112:115], v[8:11]
    s_barrier
    v_mfma_f32_16x16x32_bf16 v[12:15], a[100:103], v[144:147], v[12:15]
    ds_read_b64_tr_b16 a[140:141], v89 offset:20480
    ds_read_b64_tr_b16 a[142:143], v89 offset:25600
    v_mfma_f32_16x16x32_bf16 v[16:19], a[100:103], v[176:179], v[16:19]
    v_mfma_f32_16x16x32_bf16 v[20:23], a[100:103], v[208:211], v[20:23]
    ds_read_b64_tr_b16 a[144:145], v94 offset:20512
    ds_read_b64_tr_b16 a[146:147], v94 offset:25632
    v_mfma_f32_16x16x32_bf16 v[24:27], a[100:103], v[240:243], v[24:27]
    buffer_load_dwordx4 v[108:111], v90, s[36:39], s53 offen offset:0 sc1
    v_mfma_f32_16x16x32_bf16 v[28:31], a[104:107], v[112:115], v[28:31]
    ds_read_b64_tr_b16 a[148:149], v89 offset:20544
    ds_read_b64_tr_b16 a[150:151], v89 offset:25664
    v_mfma_f32_16x16x32_bf16 v[32:35], a[104:107], v[144:147], v[32:35]
    v_mfma_f32_16x16x32_bf16 v[36:39], a[104:107], v[176:179], v[36:39]
    ds_read_b64_tr_b16 a[152:153], v94 offset:20576
    ds_read_b64_tr_b16 a[154:155], v94 offset:25696
    v_mfma_f32_16x16x32_bf16 v[40:43], a[104:107], v[208:211], v[40:43]
    buffer_load_dwordx4 v[140:143], v90, s[36:39], s53 offen offset:1024 sc1
    v_mfma_f32_16x16x32_bf16 v[44:47], a[104:107], v[240:243], v[44:47]
    ds_read_b64_tr_b16 a[156:157], v89 offset:20608
    ds_read_b64_tr_b16 a[158:159], v89 offset:25728
    v_mfma_f32_16x16x32_bf16 v[48:51], a[108:111], v[112:115], v[48:51]
    v_mfma_f32_16x16x32_bf16 v[52:55], a[108:111], v[144:147], v[52:55]
    ds_read_b64_tr_b16 a[160:161], v94 offset:20640
    ds_read_b64_tr_b16 a[162:163], v94 offset:25760
    v_mfma_f32_16x16x32_bf16 v[56:59], a[108:111], v[176:179], v[56:59]
    buffer_load_dwordx4 v[172:175], v90, s[36:39], s53 offen offset:2048 sc1
    v_mfma_f32_16x16x32_bf16 v[60:63], a[108:111], v[208:211], v[60:63]
    ds_read_b64_tr_b16 a[164:165], v89 offset:20672
    ds_read_b64_tr_b16 a[166:167], v89 offset:25792
    v_mfma_f32_16x16x32_bf16 v[64:67], a[108:111], v[240:243], v[64:67]
    v_mfma_f32_16x16x32_bf16 v[68:71], a[112:115], v[112:115], v[68:71]
    ds_read_b64_tr_b16 a[168:169], v94 offset:20704
    ds_read_b64_tr_b16 a[170:171], v94 offset:25824
    v_mfma_f32_16x16x32_bf16 v[72:75], a[112:115], v[144:147], v[72:75]
    v_mfma_f32_16x16x32_bf16 v[76:79], a[112:115], v[176:179], v[76:79]
    buffer_load_dwordx4 v[204:207], v90, s[36:39], s53 offen offset:3072 sc1
    v_mfma_f32_16x16x32_bf16 v[80:83], a[112:115], v[208:211], v[80:83]
    ds_read_b64_tr_b16 a[172:173], v89 offset:20736
    ds_read_b64_tr_b16 a[174:175], v89 offset:25856
    v_mfma_f32_16x16x32_bf16 v[84:87], a[112:115], v[240:243], v[84:87]
    v_mfma_f32_16x16x32_bf16 v[100:103], a[116:119], v[112:115], v[100:103]
    ds_read_b64_tr_b16 a[176:177], v94 offset:20768
    ds_read_b64_tr_b16 a[178:179], v94 offset:25888
    v_mfma_f32_16x16x32_bf16 v[132:135], a[116:119], v[144:147], v[132:135]
    buffer_load_dwordx4 v[236:239], v91, s[36:39], s53 offen offset:0 sc1
    v_mfma_f32_16x16x32_bf16 v[164:167], a[116:119], v[176:179], v[164:167]
    s_add_u32 s53, s53, 5120
    v_mfma_f32_16x16x32_bf16 v[196:199], a[116:119], v[208:211], v[196:199]
    v_mfma_f32_16x16x32_bf16 v[228:231], a[116:119], v[240:243], v[228:231]
    v_mfma_f32_16x16x32_bf16 a[0:3], a[120:123], v[112:115], a[0:3]
    v_mfma_f32_16x16x32_bf16 a[4:7], a[120:123], v[144:147], a[4:7]
    buffer_load_dwordx4 v[116:119], v90, s[36:39], s53 offen offset:0 sc1
    v_mfma_f32_16x16x32_bf16 a[8:11], a[120:123], v[176:179], a[8:11]
    v_mfma_f32_16x16x32_bf16 a[12:15], a[120:123], v[208:211], a[12:15]
    v_mfma_f32_16x16x32_bf16 a[16:19], a[120:123], v[240:243], a[16:19]
    v_mfma_f32_16x16x32_bf16 a[20:23], a[124:127], v[112:115], a[20:23]
    buffer_load_dwordx4 v[148:151], v90, s[36:39], s53 offen offset:1024 sc1
    v_mfma_f32_16x16x32_bf16 a[24:27], a[124:127], v[144:147], a[24:27]
    v_mfma_f32_16x16x32_bf16 a[28:31], a[124:127], v[176:179], a[28:31]
    v_mfma_f32_16x16x32_bf16 a[32:35], a[124:127], v[208:211], a[32:35]
    v_mfma_f32_16x16x32_bf16 a[36:39], a[124:127], v[240:243], a[36:39]
    buffer_load_dwordx4 v[180:183], v90, s[36:39], s53 offen offset:2048 sc1
    v_mfma_f32_16x16x32_bf16 a[40:43], a[128:131], v[112:115], a[40:43]
    v_mfma_f32_16x16x32_bf16 a[44:47], a[128:131], v[144:147], a[44:47]
    v_mfma_f32_16x16x32_bf16 a[48:51], a[128:131], v[176:179], a[48:51]
    v_mfma_f32_16x16x32_bf16 a[52:55], a[128:131], v[208:211], a[52:55]
    v_mfma_f32_16x16x32_bf16 a[56:59], a[128:131], v[240:243], a[56:59]
    buffer_load_dwordx4 v[212:215], v90, s[36:39], s53 offen offset:3072 sc1
    v_mfma_f32_16x16x32_bf16 a[60:63], a[132:135], v[112:115], a[60:63]
    v_mfma_f32_16x16x32_bf16 a[64:67], a[132:135], v[144:147], a[64:67]
    v_mfma_f32_16x16x32_bf16 a[68:71], a[132:135], v[176:179], a[68:71]
    v_mfma_f32_16x16x32_bf16 a[72:75], a[132:135], v[208:211], a[72:75]
    buffer_load_dwordx4 v[244:247], v91, s[36:39], s53 offen offset:0 sc1
    v_mfma_f32_16x16x32_bf16 a[76:79], a[132:135], v[240:243], a[76:79]
    s_add_u32 s53, s53, 5120
    v_mfma_f32_16x16x32_bf16 a[80:83], a[136:139], v[112:115], a[80:83]
    v_mfma_f32_16x16x32_bf16 a[84:87], a[136:139], v[144:147], a[84:87]
    v_mfma_f32_16x16x32_bf16 a[88:91], a[136:139], v[176:179], a[88:91]
    v_mfma_f32_16x16x32_bf16 a[92:95], a[136:139], v[208:211], a[92:95]
    v_mfma_f32_16x16x32_bf16 a[96:99], a[136:139], v[240:243], a[96:99]
    s_waitcnt vmcnt(15) lgkmcnt(0)
    v_mfma_f32_16x16x32_bf16 v[8:11], a[140:143], v[120:123], v[8:11]
    s_barrier
    v_mfma_f32_16x16x32_bf16 v[12:15], a[140:143], v[152:155], v[12:15]
    ds_read_b64_tr_b16 a[120:121], v1 offset:160
    ds_read_b64_tr_b16 a[122:123], v1 offset:5280
    v_mfma_f32_16x16x32_bf16 v[16:19], a[140:143], v[184:187], v[16:19]
    v_mfma_f32_16x16x32_bf16 v[20:23], a[140:143], v[216:219], v[20:23]
    ds_read_b64_tr_b16 a[124:125], v0 offset:192
    ds_read_b64_tr_b16 a[126:127], v0 offset:5312
    v_mfma_f32_16x16x32_bf16 v[24:27], a[140:143], v[248:251], v[24:27]
    v_mfma_f32_16x16x32_bf16 v[28:31], a[144:147], v[120:123], v[28:31]
    ds_read_b64_tr_b16 a[128:129], v1 offset:224
    ds_read_b64_tr_b16 a[130:131], v1 offset:5344
    v_mfma_f32_16x16x32_bf16 v[32:35], a[144:147], v[152:155], v[32:35]
    v_mfma_f32_16x16x32_bf16 v[36:39], a[144:147], v[184:187], v[36:39]
    ds_read_b64_tr_b16 a[132:133], v0 offset:256
    ds_read_b64_tr_b16 a[134:135], v0 offset:5376
    v_mfma_f32_16x16x32_bf16 v[40:43], a[144:147], v[216:219], v[40:43]
    v_mfma_f32_16x16x32_bf16 v[44:47], a[144:147], v[248:251], v[44:47]
    ds_read_b64_tr_b16 a[136:137], v1 offset:288
    ds_read_b64_tr_b16 a[138:139], v1 offset:5408
    v_mfma_f32_16x16x32_bf16 v[48:51], a[148:151], v[120:123], v[48:51]
    v_mfma_f32_16x16x32_bf16 v[52:55], a[148:151], v[152:155], v[52:55]
    ds_read_b64_tr_b16 a[100:101], v0 offset:0
    ds_read_b64_tr_b16 a[102:103], v0 offset:5120
    v_mfma_f32_16x16x32_bf16 v[56:59], a[148:151], v[184:187], v[56:59]
    v_mfma_f32_16x16x32_bf16 v[60:63], a[148:151], v[216:219], v[60:63]
    ds_read_b64_tr_b16 a[104:105], v1 offset:32
    ds_read_b64_tr_b16 a[106:107], v1 offset:5152
    v_mfma_f32_16x16x32_bf16 v[64:67], a[148:151], v[248:251], v[64:67]
    v_mfma_f32_16x16x32_bf16 v[68:71], a[152:155], v[120:123], v[68:71]
    ds_read_b64_tr_b16 a[108:109], v0 offset:64
    ds_read_b64_tr_b16 a[110:111], v0 offset:5184
    v_mfma_f32_16x16x32_bf16 v[72:75], a[152:155], v[152:155], v[72:75]
    v_mfma_f32_16x16x32_bf16 v[76:79], a[152:155], v[184:187], v[76:79]
    ds_read_b64_tr_b16 a[112:113], v1 offset:96
    ds_read_b64_tr_b16 a[114:115], v1 offset:5216
    v_mfma_f32_16x16x32_bf16 v[80:83], a[152:155], v[216:219], v[80:83]
    v_mfma_f32_16x16x32_bf16 v[84:87], a[152:155], v[248:251], v[84:87]
    ds_read_b64_tr_b16 a[116:117], v0 offset:128
    ds_read_b64_tr_b16 a[118:119], v0 offset:5248
    v_mfma_f32_16x16x32_bf16 v[100:103], a[156:159], v[120:123], v[100:103]
    v_mfma_f32_16x16x32_bf16 v[132:135], a[156:159], v[152:155], v[132:135]
    v_mfma_f32_16x16x32_bf16 v[164:167], a[156:159], v[184:187], v[164:167]
    v_mfma_f32_16x16x32_bf16 v[196:199], a[156:159], v[216:219], v[196:199]
    v_mfma_f32_16x16x32_bf16 v[228:231], a[156:159], v[248:251], v[228:231]
    v_mfma_f32_16x16x32_bf16 a[0:3], a[160:163], v[120:123], a[0:3]
    v_mfma_f32_16x16x32_bf16 a[4:7], a[160:163], v[152:155], a[4:7]
    v_mfma_f32_16x16x32_bf16 a[8:11], a[160:163], v[184:187], a[8:11]
    v_mfma_f32_16x16x32_bf16 a[12:15], a[160:163], v[216:219], a[12:15]
    v_mfma_f32_16x16x32_bf16 a[16:19], a[160:163], v[248:251], a[16:19]
    v_mfma_f32_16x16x32_bf16 a[20:23], a[164:167], v[120:123], a[20:23]
    v_mfma_f32_16x16x32_bf16 a[24:27], a[164:167], v[152:155], a[24:27]
    v_mfma_f32_16x16x32_bf16 a[28:31], a[164:167], v[184:187], a[28:31]
    v_mfma_f32_16x16x32_bf16 a[32:35], a[164:167], v[216:219], a[32:35]
    v_mfma_f32_16x16x32_bf16 a[36:39], a[164:167], v[248:251], a[36:39]
    v_mfma_f32_16x16x32_bf16 a[40:43], a[168:171], v[120:123], a[40:43]
    v_mfma_f32_16x16x32_bf16 a[44:47], a[168:171], v[152:155], a[44:47]
    v_mfma_f32_16x16x32_bf16 a[48:51], a[168:171], v[184:187], a[48:51]
    v_mfma_f32_16x16x32_bf16 a[52:55], a[168:171], v[216:219], a[52:55]
    v_mfma_f32_16x16x32_bf16 a[56:59], a[168:171], v[248:251], a[56:59]
    v_mfma_f32_16x16x32_bf16 a[60:63], a[172:175], v[120:123], a[60:63]
    v_mfma_f32_16x16x32_bf16 a[64:67], a[172:175], v[152:155], a[64:67]
    v_mfma_f32_16x16x32_bf16 a[68:71], a[172:175], v[184:187], a[68:71]
    v_mfma_f32_16x16x32_bf16 a[72:75], a[172:175], v[216:219], a[72:75]
    v_mfma_f32_16x16x32_bf16 a[76:79], a[172:175], v[248:251], a[76:79]
    v_mfma_f32_16x16x32_bf16 a[80:83], a[176:179], v[120:123], a[80:83]
    v_mfma_f32_16x16x32_bf16 a[84:87], a[176:179], v[152:155], a[84:87]
    v_mfma_f32_16x16x32_bf16 a[88:91], a[176:179], v[184:187], a[88:91]
    v_mfma_f32_16x16x32_bf16 a[92:95], a[176:179], v[216:219], a[92:95]
    v_mfma_f32_16x16x32_bf16 a[96:99], a[176:179], v[248:251], a[96:99]
    s_waitcnt vmcnt(5) lgkmcnt(0)
    s_mov_b32 s57, 10240
    s_mov_b32 s58, 61440
    s_cmp_eq_u32 s40, 1
    s_cselect_b32 s57, 35840, s57
    s_cselect_b32 s58, 108544, s58
    s_cmp_eq_u32 s40, 2
    s_cselect_b32 s57, 61440, s57
    s_cselect_b32 s58, 10240, s58
    s_cmp_eq_u32 s40, 3
    s_cselect_b32 s57, 108544, s57
    s_cselect_b32 s58, 35840, s58
    s_lshl_b32 s50, s41, 2
    s_add_u32 s50, s50, s89
    s_lshl_b32 s51, s50, 2
    s_add_u32 s48, s51, s40
    s_lshl_b32 s48, s48, 2
    s_add_u32 s48, s48, s88
    s_mul_i32 s48, s48, 13312
    s_add_u32 s48, s48, 20971520
    s_cmp_eq_u32 s40, s88
    s_cselect_b32 s48, 0x7000000, s48
    s_mov_b32 s59, 0x30000
    s_cselect_b32 s59, 134144, s59
    v_mfma_f32_16x16x32_bf16 a[0:3], a[120:123], v[108:111], a[0:3]
    s_barrier
    v_mfma_f32_16x16x32_bf16 a[4:7], a[120:123], v[140:143], a[4:7]
    ds_read_b64_tr_b16 a[160:161], v94 offset:160
    ds_read_b64_tr_b16 a[162:163], v94 offset:5280
    v_mfma_f32_16x16x32_bf16 a[8:11], a[120:123], v[172:175], a[8:11]
    ds_read_b64_tr_b16 a[164:165], v89 offset:192
    ds_read_b64_tr_b16 a[166:167], v89 offset:5312
    v_mfma_f32_16x16x32_bf16 a[12:15], a[120:123], v[204:207], a[12:15]
    ds_read_b64_tr_b16 a[168:169], v94 offset:224
    ds_read_b64_tr_b16 a[170:171], v94 offset:5344
    v_mfma_f32_16x16x32_bf16 a[16:19], a[120:123], v[236:239], a[16:19]
    ds_read_b64_tr_b16 a[172:173], v89 offset:256
    ds_read_b64_tr_b16 a[174:175], v89 offset:5376
    v_mfma_f32_16x16x32_bf16 a[20:23], a[124:127], v[108:111], a[20:23]
    ds_read_b64_tr_b16 a[176:177], v94 offset:288
    ds_read_b64_tr_b16 a[178:179], v94 offset:5408
    v_mfma_f32_16x16x32_bf16 a[24:27], a[124:127], v[140:143], a[24:27]
    ds_read_b64_tr_b16 a[140:141], v89 offset:0
    ds_read_b64_tr_b16 a[142:143], v89 offset:5120
    v_mfma_f32_16x16x32_bf16 a[28:31], a[124:127], v[172:175], a[28:31]
    ds_read_b64_tr_b16 a[144:145], v94 offset:32
    ds_read_b64_tr_b16 a[146:147], v94 offset:5152
    v_mfma_f32_16x16x32_bf16 a[32:35], a[124:127], v[204:207], a[32:35]
    ds_read_b64_tr_b16 a[148:149], v89 offset:64
    ds_read_b64_tr_b16 a[150:151], v89 offset:5184
    v_mfma_f32_16x16x32_bf16 a[36:39], a[124:127], v[236:239], a[36:39]
    s_waitcnt vmcnt(0) lgkmcnt(8)
    ds_read_b64_tr_b16 a[152:153], v94 offset:96
    ds_read_b64_tr_b16 a[154:155], v94 offset:5216
    v_mfma_f32_16x16x32_bf16 a[0:3], a[160:163], v[116:119], a[0:3]
    ds_read_b64_tr_b16 a[156:157], v89 offset:128
    ds_read_b64_tr_b16 a[158:159], v89 offset:5248
    v_mfma_f32_16x16x32_bf16 a[4:7], a[160:163], v[148:151], a[4:7]
    v_mfma_f32_16x16x32_bf16 a[8:11], a[160:163], v[180:183], a[8:11]
    v_add_u32 v88, s57, v90
    v_add_u32 v89, s58, v90
    v_mfma_f32_16x16x32_bf16 a[12:15], a[160:163], v[212:215], a[12:15]
    v_add_u32 v3, s59, v90
    v_mfma_f32_16x16x32_bf16 a[16:19], a[160:163], v[244:247], a[16:19]
    v_mfma_f32_16x16x32_bf16 a[20:23], a[164:167], v[116:119], a[20:23]
    v_mfma_f32_16x16x32_bf16 a[24:27], a[164:167], v[148:151], a[24:27]
    ds_write_b128 v88, a[0:3] offset:0
    v_mfma_f32_16x16x32_bf16 a[28:31], a[164:167], v[180:183], a[28:31]
    v_mfma_f32_16x16x32_bf16 a[32:35], a[164:167], v[212:215], a[32:35]
    ds_write_b128 v88, a[4:7] offset:1024
    v_mfma_f32_16x16x32_bf16 a[36:39], a[164:167], v[244:247], a[36:39]
    s_waitcnt lgkmcnt(0)
    ds_write_b128 v88, a[8:11] offset:2048
    v_mfma_f32_16x16x32_bf16 a[40:43], a[128:131], v[108:111], a[40:43]
    v_mfma_f32_16x16x32_bf16 a[40:43], a[168:171], v[116:119], a[40:43]
    ds_write_b128 v88, a[12:15] offset:3072
    v_mfma_f32_16x16x32_bf16 a[44:47], a[128:131], v[140:143], a[44:47]
    ds_write_b128 v88, a[16:19] offset:4096
    v_mfma_f32_16x16x32_bf16 a[44:47], a[168:171], v[148:151], a[44:47]
    v_mfma_f32_16x16x32_bf16 a[48:51], a[128:131], v[172:175], a[48:51]
    ds_write_b128 v88, a[20:23] offset:5120
    v_mfma_f32_16x16x32_bf16 a[48:51], a[168:171], v[180:183], a[48:51]
    ds_write_b128 v88, a[24:27] offset:6144
    v_mfma_f32_16x16x32_bf16 a[52:55], a[128:131], v[204:207], a[52:55]
    v_mfma_f32_16x16x32_bf16 a[52:55], a[168:171], v[212:215], a[52:55]
    ds_write_b128 v88, a[28:31] offset:7168
    v_mfma_f32_16x16x32_bf16 a[56:59], a[128:131], v[236:239], a[56:59]
    ds_write_b128 v88, a[32:35] offset:8192
    v_mfma_f32_16x16x32_bf16 a[56:59], a[168:171], v[244:247], a[56:59]
    v_mfma_f32_16x16x32_bf16 a[60:63], a[132:135], v[108:111], a[60:63]
    ds_write_b128 v88, a[36:39] offset:9216
    v_mfma_f32_16x16x32_bf16 a[60:63], a[172:175], v[116:119], a[60:63]
    ds_write_b128 v88, a[40:43] offset:10240
    v_mfma_f32_16x16x32_bf16 a[64:67], a[132:135], v[140:143], a[64:67]
    v_mfma_f32_16x16x32_bf16 a[64:67], a[172:175], v[148:151], a[64:67]
    ds_write_b128 v88, a[44:47] offset:11264
    v_mfma_f32_16x16x32_bf16 a[68:71], a[132:135], v[172:175], a[68:71]
    ds_write_b128 v88, a[48:51] offset:12288
    v_mfma_f32_16x16x32_bf16 a[68:71], a[172:175], v[180:183], a[68:71]
    v_mfma_f32_16x16x32_bf16 a[72:75], a[132:135], v[204:207], a[72:75]
    ds_write_b128 v88, a[52:55] offset:13312
    v_mfma_f32_16x16x32_bf16 a[72:75], a[172:175], v[212:215], a[72:75]
    ds_write_b128 v88, a[56:59] offset:14336
    v_mfma_f32_16x16x32_bf16 a[76:79], a[132:135], v[236:239], a[76:79]
    v_mfma_f32_16x16x32_bf16 a[76:79], a[172:175], v[244:247], a[76:79]
    ds_write_b128 v88, a[60:63] offset:15360
    v_mfma_f32_16x16x32_bf16 a[80:83], a[136:139], v[108:111], a[80:83]
    ds_write_b128 v88, a[64:67] offset:16384
    v_mfma_f32_16x16x32_bf16 a[80:83], a[176:179], v[116:119], a[80:83]
    v_mfma_f32_16x16x32_bf16 a[84:87], a[136:139], v[140:143], a[84:87]
    ds_write_b128 v88, a[68:71] offset:17408
    v_mfma_f32_16x16x32_bf16 a[84:87], a[176:179], v[148:151], a[84:87]
    ds_write_b128 v88, a[72:75] offset:18432
    v_mfma_f32_16x16x32_bf16 a[88:91], a[136:139], v[172:175], a[88:91]
    v_mfma_f32_16x16x32_bf16 a[88:91], a[176:179], v[180:183], a[88:91]
    ds_write_b128 v88, a[76:79] offset:19456
    v_mfma_f32_16x16x32_bf16 a[92:95], a[136:139], v[204:207], a[92:95]
    ds_write_b128 v88, a[80:83] offset:20480
    v_mfma_f32_16x16x32_bf16 a[92:95], a[176:179], v[212:215], a[92:95]
    v_mfma_f32_16x16x32_bf16 a[96:99], a[136:139], v[236:239], a[96:99]
    ds_write_b128 v88, a[84:87] offset:21504
    v_mfma_f32_16x16x32_bf16 a[96:99], a[176:179], v[244:247], a[96:99]
    v_mfma_f32_16x16x32_bf16 v[8:11], a[100:103], v[108:111], v[8:11]
    ds_write_b128 v88, a[88:91] offset:22528
    v_mfma_f32_16x16x32_bf16 v[8:11], a[140:143], v[116:119], v[8:11]
    v_mfma_f32_16x16x32_bf16 v[12:15], a[100:103], v[140:143], v[12:15]
    s_nop 0
    ds_write_b128 v88, a[92:95] offset:23552
    v_mfma_f32_16x16x32_bf16 v[12:15], a[140:143], v[148:151], v[12:15]
    v_mfma_f32_16x16x32_bf16 v[16:19], a[100:103], v[172:175], v[16:19]
    ds_write_b128 v88, a[96:99] offset:24576
    v_mfma_f32_16x16x32_bf16 v[16:19], a[140:143], v[180:183], v[16:19]
    v_mfma_f32_16x16x32_bf16 v[20:23], a[100:103], v[204:207], v[20:23]
    v_mfma_f32_16x16x32_bf16 v[20:23], a[140:143], v[212:215], v[20:23]
    s_waitcnt lgkmcnt(0)
    v_mfma_f32_16x16x32_bf16 v[24:27], a[100:103], v[236:239], v[24:27]
    s_barrier
    v_mfma_f32_16x16x32_bf16 v[24:27], a[140:143], v[244:247], v[24:27]
    ds_read_b128 v[96:99], v89 offset:0
    ds_read_b128 v[128:131], v89 offset:1024
    ds_read_b128 v[160:163], v89 offset:2048
    v_mfma_f32_16x16x32_bf16 v[28:31], a[104:107], v[108:111], v[28:31]
    ds_read_b128 v[192:195], v89 offset:3072
    ds_read_b128 v[224:227], v89 offset:4096
    ds_read_b128 v[104:107], v89 offset:5120
    v_mfma_f32_16x16x32_bf16 v[28:31], a[144:147], v[116:119], v[28:31]
    ds_read_b128 v[136:139], v89 offset:6144
    ds_read_b128 v[168:171], v89 offset:7168
    s_waitcnt lgkmcnt(6)
    v_mfma_f32_16x16x32_bf16 v[32:35], a[104:107], v[140:143], v[32:35]
    v_add_f32 v8, v8, v96
    v_add_f32 v9, v9, v97
    v_add_f32 v10, v10, v98
    v_mfma_f32_16x16x32_bf16 v[32:35], a[144:147], v[148:151], v[32:35]
    v_add_f32 v11, v11, v99
    v_add_f32 v12, v12, v128
    v_add_f32 v13, v13, v129
    v_mfma_f32_16x16x32_bf16 v[36:39], a[104:107], v[172:175], v[36:39]
    v_add_f32 v14, v14, v130
    v_add_f32 v15, v15, v131
    v_cvt_pk_bf16_f32 v96, v8, v9
    v_mfma_f32_16x16x32_bf16 v[36:39], a[144:147], v[180:183], v[36:39]
    v_cvt_pk_bf16_f32 v97, v10, v11
    v_cvt_pk_bf16_f32 v98, v12, v13
    v_cvt_pk_bf16_f32 v99, v14, v15
    v_mfma_f32_16x16x32_bf16 v[40:43], a[104:107], v[204:207], v[40:43]
    buffer_store_dwordx4 v[96:99], v90, s[36:39], s48 offen offset:0 sc1
    ds_write_b128 v3, v[96:99] offset:0
    ds_read_b128 v[200:203], v89 offset:8192
    v_mfma_f32_16x16x32_bf16 v[40:43], a[144:147], v[212:215], v[40:43]
    ds_read_b128 v[232:235], v89 offset:9216
    s_waitcnt lgkmcnt(7)
    v_add_f32 v16, v16, v160
    v_mfma_f32_16x16x32_bf16 v[44:47], a[104:107], v[236:239], v[44:47]
    v_add_f32 v17, v17, v161
    v_add_f32 v18, v18, v162
    v_add_f32 v19, v19, v163
    v_mfma_f32_16x16x32_bf16 v[44:47], a[144:147], v[244:247], v[44:47]
    v_add_f32 v20, v20, v192
    v_add_f32 v21, v21, v193
    v_add_f32 v22, v22, v194
    v_mfma_f32_16x16x32_bf16 v[48:51], a[108:111], v[108:111], v[48:51]
    v_add_f32 v23, v23, v195
    v_cvt_pk_bf16_f32 v160, v16, v17
    v_cvt_pk_bf16_f32 v161, v18, v19
    v_mfma_f32_16x16x32_bf16 v[48:51], a[148:151], v[116:119], v[48:51]
    v_cvt_pk_bf16_f32 v162, v20, v21
    v_cvt_pk_bf16_f32 v163, v22, v23
    buffer_store_dwordx4 v[160:163], v90, s[36:39], s48 offen offset:1024 sc1
    v_mfma_f32_16x16x32_bf16 v[52:55], a[108:111], v[140:143], v[52:55]
    ds_write_b128 v3, v[160:163] offset:1024
    ds_read_b128 v[112:115], v89 offset:10240
    ds_read_b128 v[144:147], v89 offset:11264
    s_waitcnt lgkmcnt(8)
    v_mfma_f32_16x16x32_bf16 v[52:55], a[148:151], v[148:151], v[52:55]
    v_add_f32 v24, v24, v224
    v_add_f32 v25, v25, v225
    v_add_f32 v26, v26, v226
    v_mfma_f32_16x16x32_bf16 v[56:59], a[108:111], v[172:175], v[56:59]
    v_add_f32 v27, v27, v227
    v_add_f32 v28, v28, v104
    v_add_f32 v29, v29, v105
    v_mfma_f32_16x16x32_bf16 v[56:59], a[148:151], v[180:183], v[56:59]
    v_add_f32 v30, v30, v106
    v_add_f32 v31, v31, v107
    v_cvt_pk_bf16_f32 v224, v24, v25
    v_mfma_f32_16x16x32_bf16 v[60:63], a[108:111], v[204:207], v[60:63]
    v_cvt_pk_bf16_f32 v225, v26, v27
    v_cvt_pk_bf16_f32 v226, v28, v29
    v_cvt_pk_bf16_f32 v227, v30, v31
    v_mfma_f32_16x16x32_bf16 v[60:63], a[148:151], v[212:215], v[60:63]
    buffer_store_dwordx4 v[224:227], v90, s[36:39], s48 offen offset:2048 sc1
    ds_write_b128 v3, v[224:227] offset:2048
    ds_read_b128 v[176:179], v89 offset:12288
    v_mfma_f32_16x16x32_bf16 v[64:67], a[108:111], v[236:239], v[64:67]
    ds_read_b128 v[208:211], v89 offset:13312
    s_waitcnt lgkmcnt(9)
    v_add_f32 v32, v32, v136
    v_mfma_f32_16x16x32_bf16 v[64:67], a[148:151], v[244:247], v[64:67]
    v_add_f32 v33, v33, v137
    v_add_f32 v34, v34, v138
    v_add_f32 v35, v35, v139
    v_mfma_f32_16x16x32_bf16 v[68:71], a[112:115], v[108:111], v[68:71]
    v_add_f32 v36, v36, v168
    v_add_f32 v37, v37, v169
    v_add_f32 v38, v38, v170
    v_mfma_f32_16x16x32_bf16 v[68:71], a[152:155], v[116:119], v[68:71]
    v_add_f32 v39, v39, v171
    v_cvt_pk_bf16_f32 v136, v32, v33
    v_cvt_pk_bf16_f32 v137, v34, v35
    v_mfma_f32_16x16x32_bf16 v[72:75], a[112:115], v[140:143], v[72:75]
    v_cvt_pk_bf16_f32 v138, v36, v37
    v_cvt_pk_bf16_f32 v139, v38, v39
    buffer_store_dwordx4 v[136:139], v90, s[36:39], s48 offen offset:3072 sc1
    v_mfma_f32_16x16x32_bf16 v[72:75], a[152:155], v[148:151], v[72:75]
    ds_write_b128 v3, v[136:139] offset:3072
    s_add_u32 s48, s48, 4096
    ds_read_b128 v[240:243], v89 offset:14336
    v_mfma_f32_16x16x32_bf16 v[76:79], a[112:115], v[172:175], v[76:79]
    ds_read_b128 v[120:123], v89 offset:15360
    s_waitcnt lgkmcnt(9)
    v_add_f32 v40, v40, v200
    v_mfma_f32_16x16x32_bf16 v[76:79], a[152:155], v[180:183], v[76:79]
    v_add_f32 v41, v41, v201
    v_add_f32 v42, v42, v202
    v_add_f32 v43, v43, v203
    v_mfma_f32_16x16x32_bf16 v[80:83], a[112:115], v[204:207], v[80:83]
    v_add_f32 v44, v44, v232
    v_add_f32 v45, v45, v233
    v_add_f32 v46, v46, v234
    v_mfma_f32_16x16x32_bf16 v[80:83], a[152:155], v[212:215], v[80:83]
    v_add_f32 v47, v47, v235
    v_cvt_pk_bf16_f32 v200, v40, v41
    v_cvt_pk_bf16_f32 v201, v42, v43
    v_mfma_f32_16x16x32_bf16 v[84:87], a[112:115], v[236:239], v[84:87]
    v_cvt_pk_bf16_f32 v202, v44, v45
    v_cvt_pk_bf16_f32 v203, v46, v47
    buffer_store_dwordx4 v[200:203], v90, s[36:39], s48 offen offset:0 sc1
    v_mfma_f32_16x16x32_bf16 v[84:87], a[152:155], v[244:247], v[84:87]
    ds_write_b128 v3, v[200:203] offset:4096
    ds_read_b128 v[152:155], v89 offset:16384
    ds_read_b128 v[184:187], v89 offset:17408
    s_waitcnt lgkmcnt(9)
    v_mfma_f32_16x16x32_bf16 v[100:103], a[116:119], v[108:111], v[100:103]
    v_add_f32 v48, v48, v112
    v_add_f32 v49, v49, v113
    v_add_f32 v50, v50, v114
    v_mfma_f32_16x16x32_bf16 v[100:103], a[156:159], v[116:119], v[100:103]
    v_add_f32 v51, v51, v115
    v_add_f32 v52, v52, v144
    v_add_f32 v53, v53, v145
    v_mfma_f32_16x16x32_bf16 v[132:135], a[116:119], v[140:143], v[132:135]
    v_add_f32 v54, v54, v146
    v_add_f32 v55, v55, v147
    v_cvt_pk_bf16_f32 v112, v48, v49
    v_mfma_f32_16x16x32_bf16 v[132:135], a[156:159], v[148:151], v[132:135]
    v_cvt_pk_bf16_f32 v113, v50, v51
    v_cvt_pk_bf16_f32 v114, v52, v53
    v_cvt_pk_bf16_f32 v115, v54, v55
    v_mfma_f32_16x16x32_bf16 v[164:167], a[116:119], v[172:175], v[164:167]
    buffer_store_dwordx4 v[112:115], v90, s[36:39], s48 offen offset:1024 sc1
    ds_write_b128 v3, v[112:115] offset:5120
    ds_read_b128 v[216:219], v89 offset:18432
    v_mfma_f32_16x16x32_bf16 v[164:167], a[156:159], v[180:183], v[164:167]
    ds_read_b128 v[248:251], v89 offset:19456
    s_waitcnt lgkmcnt(9)
    v_add_f32 v56, v56, v176
    v_mfma_f32_16x16x32_bf16 v[196:199], a[116:119], v[204:207], v[196:199]
    v_add_f32 v57, v57, v177
    v_add_f32 v58, v58, v178
    v_add_f32 v59, v59, v179
    v_mfma_f32_16x16x32_bf16 v[196:199], a[156:159], v[212:215], v[196:199]
    v_add_f32 v60, v60, v208
    v_add_f32 v61, v61, v209
    v_add_f32 v62, v62, v210
    v_mfma_f32_16x16x32_bf16 v[228:231], a[116:119], v[236:239], v[228:231]
    v_add_f32 v63, v63, v211
    v_cvt_pk_bf16_f32 v176, v56, v57
    v_cvt_pk_bf16_f32 v177, v58, v59
    v_mfma_f32_16x16x32_bf16 v[228:231], a[156:159], v[244:247], v[228:231]
    v_cvt_pk_bf16_f32 v178, v60, v61
    v_cvt_pk_bf16_f32 v179, v62, v63
    buffer_store_dwordx4 v[176:179], v90, s[36:39], s48 offen offset:2048 sc1
    ds_write_b128 v3, v[176:179] offset:6144
    ds_read_b128 v[124:127], v89 offset:20480
    ds_read_b128 v[156:159], v89 offset:21504
    s_waitcnt lgkmcnt(9)
    v_add_f32 v64, v64, v240
    v_add_f32 v65, v65, v241
    v_add_f32 v66, v66, v242
    v_add_f32 v67, v67, v243
    v_add_f32 v68, v68, v120
    v_add_f32 v69, v69, v121
    v_add_f32 v70, v70, v122
    v_add_f32 v71, v71, v123
    v_cvt_pk_bf16_f32 v240, v64, v65
    v_cvt_pk_bf16_f32 v241, v66, v67
    v_cvt_pk_bf16_f32 v242, v68, v69
    v_cvt_pk_bf16_f32 v243, v70, v71
    buffer_store_dwordx4 v[240:243], v90, s[36:39], s48 offen offset:3072 sc1
    ds_write_b128 v3, v[240:243] offset:7168
    s_add_u32 s48, s48, 4096
    ds_read_b128 v[188:191], v89 offset:22528
    ds_read_b128 v[220:223], v89 offset:23552
    s_waitcnt lgkmcnt(9)
    v_add_f32 v72, v72, v152
    v_add_f32 v73, v73, v153
    v_add_f32 v74, v74, v154
    v_add_f32 v75, v75, v155
    v_add_f32 v76, v76, v184
    v_add_f32 v77, v77, v185
    v_add_f32 v78, v78, v186
    v_add_f32 v79, v79, v187
    v_cvt_pk_bf16_f32 v152, v72, v73
    v_cvt_pk_bf16_f32 v153, v74, v75
    v_cvt_pk_bf16_f32 v154, v76, v77
    v_cvt_pk_bf16_f32 v155, v78, v79
    buffer_store_dwordx4 v[152:155], v90, s[36:39], s48 offen offset:0 sc1
    ds_write_b128 v3, v[152:155] offset:8192
    ds_read_b128 v[252:255], v89 offset:24576
    s_waitcnt lgkmcnt(8)
    v_add_f32 v80, v80, v216
    v_add_f32 v81, v81, v217
    v_add_f32 v82, v82, v218
    v_add_f32 v83, v83, v219
    v_add_f32 v84, v84, v248
    v_add_f32 v85, v85, v249
    v_add_f32 v86, v86, v250
    v_add_f32 v87, v87, v251
    v_cvt_pk_bf16_f32 v216, v80, v81
    v_cvt_pk_bf16_f32 v217, v82, v83
    v_cvt_pk_bf16_f32 v218, v84, v85
    v_cvt_pk_bf16_f32 v219, v86, v87
    buffer_store_dwordx4 v[216:219], v90, s[36:39], s48 offen offset:1024 sc1
    ds_write_b128 v3, v[216:219] offset:9216
    s_waitcnt lgkmcnt(6)
    v_add_f32 v100, v100, v124
    v_add_f32 v101, v101, v125
    v_add_f32 v102, v102, v126
    v_add_f32 v103, v103, v127
    v_add_f32 v132, v132, v156
    v_add_f32 v133, v133, v157
    v_add_f32 v134, v134, v158
    v_add_f32 v135, v135, v159
    v_cvt_pk_bf16_f32 v124, v100, v101
    v_cvt_pk_bf16_f32 v125, v102, v103
    v_cvt_pk_bf16_f32 v126, v132, v133
    v_cvt_pk_bf16_f32 v127, v134, v135
    buffer_store_dwordx4 v[124:127], v90, s[36:39], s48 offen offset:2048 sc1
    ds_write_b128 v3, v[124:127] offset:10240
    s_waitcnt lgkmcnt(4)
    v_add_f32 v164, v164, v188
    v_add_f32 v165, v165, v189
    v_add_f32 v166, v166, v190
    v_add_f32 v167, v167, v191
    v_add_f32 v196, v196, v220
    v_add_f32 v197, v197, v221
    v_add_f32 v198, v198, v222
    v_add_f32 v199, v199, v223
    v_cvt_pk_bf16_f32 v188, v164, v165
    v_cvt_pk_bf16_f32 v189, v166, v167
    v_cvt_pk_bf16_f32 v190, v196, v197
    v_cvt_pk_bf16_f32 v191, v198, v199
    buffer_store_dwordx4 v[188:191], v90, s[36:39], s48 offen offset:3072 sc1
    ds_write_b128 v3, v[188:191] offset:11264
    s_add_u32 s48, s48, 4096
    s_waitcnt lgkmcnt(3)
    v_add_f32 v228, v228, v252
    v_add_f32 v229, v229, v253
    v_add_f32 v230, v230, v254
    v_add_f32 v231, v231, v255
    v_cvt_pk_bf16_f32 v252, v228, v229
    v_cvt_pk_bf16_f32 v253, v230, v231
    buffer_store_dwordx4 v[252:255], v90, s[36:39], s48 offen offset:0 sc1
    ds_write_b128 v3, v[252:255] offset:12288
    s_lshl_b32 s55, s50, 7
    s_add_u32 s55, s55, 34611200
    s_lshl_b32 s56, s88, 2
    s_add_u32 s54, s55, s56
    s_add_u32 s48, s51, s88
    s_mul_i32 s48, s48, 53248
    s_add_u32 s48, s48, 20971520
    s_lshl_b32 s56, s40, 10
    s_add_u32 s48, s48, s56
    s_add_u32 s56, s56, 134144
    v_add_u32 v3, s56, v90
    v_bfe_u32 v8, v90, 4, 4
    v_mul_u32_u24 v8, 1280, v8
    v_lshrrev_b32 v9, 8, v90
    v_lshl_add_u32 v8, v9, 3, v8
    v_lshlrev_b32 v9, 3, v90
    s_lshl_b32 s72, s2, 2
    s_add_u32 s72, s72, s40
    s_cmp_eq_u32 s72, 1
    s_mov_b32 s73, 0x7000000
    s_cselect_b32 s73, 34603008, s73
    s_lshl_b32 s52, s41, 1
    s_and_b32 s56, s88, 1
    s_add_u32 s52, s52, s56
    s_mul_i32 s52, s52, 102400
    s_lshl_b32 s53, s89, 1
    s_lshr_b32 s56, s88, 1
    s_add_u32 s53, s53, s56
    s_mul_i32 s53, s53, 160
    s_add_u32 s52, s52, s53
    s_cmp_le_u32 s88, 0
    s_cselect_b32 s60, 1, 0
    s_mul_i32 s60, s60, 13312
    s_add_u32 s60, s60, s48
    s_cmp_le_u32 s88, 1
    s_cselect_b32 s61, 2, 1
    s_mul_i32 s61, s61, 13312
    s_add_u32 s61, s61, s48
    s_cmp_le_u32 s88, 2
    s_cselect_b32 s62, 3, 2
    s_mul_i32 s62, s62, 13312
    s_add_u32 s62, s62, s48
    s_lshl_b32 s57, s40, 1
    s_add_u32 s57, s57, 0
    s_mul_i32 s58, s57, 52
    s_lshr_b32 s58, s58, 8
    s_mul_i32 s56, s58, 5
    s_sub_u32 s56, s57, s56
    s_mul_i32 s56, s56, 20480
    s_lshl_b32 s58, s58, 5
    s_add_u32 s58, s58, s56
    s_add_u32 s64, s58, s52
    s_lshl_b32 s57, s40, 1
    s_add_u32 s57, s57, 1
    s_mul_i32 s58, s57, 52
    s_lshr_b32 s58, s58, 8
    s_mul_i32 s56, s58, 5
    s_sub_u32 s56, s57, s56
    s_mul_i32 s56, s56, 20480
    s_lshl_b32 s58, s58, 5
    s_add_u32 s58, s58, s56
    s_add_u32 s65, s58, s52
    s_lshl_b32 s57, s40, 1
    s_add_u32 s57, s57, 8
    s_mul_i32 s58, s57, 52
    s_lshr_b32 s58, s58, 8
    s_mul_i32 s56, s58, 5
    s_sub_u32 s56, s57, s56
    s_mul_i32 s56, s56, 20480
    s_lshl_b32 s58, s58, 5
    s_add_u32 s58, s58, s56
    s_add_u32 s66, s58, s52
    s_lshl_b32 s57, s40, 1
    s_add_u32 s57, s57, 9
    s_mul_i32 s58, s57, 52
    s_lshr_b32 s58, s58, 8
    s_mul_i32 s56, s58, 5
    s_sub_u32 s56, s57, s56
    s_mul_i32 s56, s56, 20480
    s_lshl_b32 s58, s58, 5
    s_add_u32 s58, s58, s56
    s_add_u32 s67, s58, s52
    s_lshl_b32 s57, s40, 1
    s_add_u32 s57, s57, 16
    s_mul_i32 s58, s57, 52
    s_lshr_b32 s58, s58, 8
    s_mul_i32 s56, s58, 5
    s_sub_u32 s56, s57, s56
    s_mul_i32 s56, s56, 20480
    s_lshl_b32 s58, s58, 5
    s_add_u32 s58, s58, s56
    s_add_u32 s68, s58, s52
    s_lshl_b32 s57, s40, 1
    s_add_u32 s57, s57, 17
    s_mul_i32 s58, s57, 52
    s_lshr_b32 s58, s58, 8
    s_mul_i32 s56, s58, 5
    s_sub_u32 s56, s57, s56
    s_mul_i32 s56, s56, 20480
    s_lshl_b32 s58, s58, 5
    s_add_u32 s58, s58, s56
    s_add_u32 s69, s58, s52
    s_lshl_b32 s57, s40, 1
    s_add_u32 s57, s57, 24
    s_mul_i32 s58, s57, 52
    s_lshr_b32 s58, s58, 8
    s_mul_i32 s56, s58, 5
    s_sub_u32 s56, s57, s56
    s_mul_i32 s56, s56, 20480
    s_lshl_b32 s58, s58, 5
    s_add_u32 s58, s58, s56
    s_add_u32 s70, s58, s52
    s_cmp_eq_u32 s40, 0
    s_cselect_b32 s58, 0, 0x7000000
    v_add_u32 v10, 0x2000, v90
    v_add_u32 v11, 0x3000, v90
    v_add_u32 v11, s58, v11
    s_mov_b32 s59, 0xffff0000
    s_add_u32 s54, s54, s58
    s_waitcnt vmcnt(0) lgkmcnt(0)
    s_barrier
    buffer_store_dword v93, v92, s[36:39], s54 offen sc1
    buffer_load_dwordx4 v[160:163], v9, s[36:39], s73 offen sc1
    ds_read_b128 v[108:111], v3 offset:0
    ds_read_b128 v[124:127], v3 offset:4096
    ds_read_b128 v[140:143], v3 offset:8192
    ds_read_b128 v[156:159], v3 offset:12288
    s_mov_b32 s56, 0
POLL2:
    buffer_load_dwordx4 v[12:15], v92, s[36:39], s55 offen sc1
    s_add_u32 s56, s56, 1
    s_waitcnt vmcnt(0)
    v_xor_b32 v12, s30, v12
    v_xor_b32 v13, s30, v13
    v_xor_b32 v14, s30, v14
    v_xor_b32 v15, s30, v15
    v_or3_b32 v12, v12, v13, v14
    v_or_b32 v12, v12, v15
    s_nop 0
    v_readfirstlane_b32 s57, v12
    s_cmp_eq_u32 s57, 0
    s_cbranch_scc1 POLL2_OK
    s_cmp_lt_u32 s56, 0x40000
    s_cbranch_scc1 POLL2
POLL2_OK:
    buffer_load_dwordx4 v[96:99], v90, s[36:39], s60 offen sc1
    buffer_load_dwordx4 v[100:103], v90, s[36:39], s61 offen sc1
    buffer_load_dwordx4 v[104:107], v90, s[36:39], s62 offen sc1
    buffer_load_dwordx4 v[112:115], v91, s[36:39], s60 offen sc1
    buffer_load_dwordx4 v[116:119], v91, s[36:39], s61 offen sc1
    buffer_load_dwordx4 v[120:123], v91, s[36:39], s62 offen sc1
    buffer_load_dwordx4 v[128:131], v10, s[36:39], s60 offen sc1
    buffer_load_dwordx4 v[132:135], v10, s[36:39], s61 offen sc1
    buffer_load_dwordx4 v[136:139], v10, s[36:39], s62 offen sc1
    buffer_load_dwordx4 v[144:147], v11, s[36:39], s60 offen sc1
    buffer_load_dwordx4 v[148:151], v11, s[36:39], s61 offen sc1
    buffer_load_dwordx4 v[152:155], v11, s[36:39], s62 offen sc1
    s_waitcnt lgkmcnt(0)
    v_lshlrev_b32 v16, 16, v108
    v_and_b32 v17, s59, v108
    v_lshlrev_b32 v18, 16, v109
    v_and_b32 v19, s59, v109
    v_lshlrev_b32 v20, 16, v110
    v_and_b32 v21, s59, v110
    v_lshlrev_b32 v22, 16, v111
    v_and_b32 v23, s59, v111
    v_lshlrev_b32 v24, 16, v124
    v_and_b32 v25, s59, v124
    v_lshlrev_b32 v26, 16, v125
    v_and_b32 v27, s59, v125
    v_lshlrev_b32 v28, 16, v126
    v_and_b32 v29, s59, v126
    v_lshlrev_b32 v30, 16, v127
    v_and_b32 v31, s59, v127
    v_lshlrev_b32 v32, 16, v140
    v_and_b32 v33, s59, v140
    v_lshlrev_b32 v34, 16, v141
    v_and_b32 v35, s59, v141
    v_lshlrev_b32 v36, 16, v142
    v_and_b32 v37, s59, v142
    v_lshlrev_b32 v38, 16, v143
    v_and_b32 v39, s59, v143
    v_lshlrev_b32 v40, 16, v156
    v_and_b32 v41, s59, v156
    v_lshlrev_b32 v42, 16, v157
    v_and_b32 v43, s59, v157
    s_waitcnt vmcnt(9)
    v_lshlrev_b32 v48, 16, v96
    v_and_b32 v49, s59, v96
    v_lshlrev_b32 v50, 16, v97
    v_and_b32 v51, s59, v97
    v_lshlrev_b32 v52, 16, v98
    v_and_b32 v53, s59, v98
    v_lshlrev_b32 v54, 16, v99
    v_and_b32 v55, s59, v99
    v_pk_add_f32 v[16:17], v[16:17], v[48:49]
    v_pk_add_f32 v[18:19], v[18:19], v[50:51]
    v_pk_add_f32 v[20:21], v[20:21], v[52:53]
    v_pk_add_f32 v[22:23], v[22:23], v[54:55]
    v_lshlrev_b32 v48, 16, v100
    v_and_b32 v49, s59, v100
    v_lshlrev_b32 v50, 16, v101
    v_and_b32 v51, s59, v101
    v_lshlrev_b32 v52, 16, v102
    v_and_b32 v53, s59, v102
    v_lshlrev_b32 v54, 16, v103
    v_and_b32 v55, s59, v103
    v_pk_add_f32 v[16:17], v[16:17], v[48:49]
    v_pk_add_f32 v[18:19], v[18:19], v[50:51]
    v_pk_add_f32 v[20:21], v[20:21], v[52:53]
    v_pk_add_f32 v[22:23], v[22:23], v[54:55]
    v_lshlrev_b32 v48, 16, v104
    v_and_b32 v49, s59, v104
    v_lshlrev_b32 v50, 16, v105
    v_and_b32 v51, s59, v105
    v_lshlrev_b32 v52, 16, v106
    v_and_b32 v53, s59, v106
    v_lshlrev_b32 v54, 16, v107
    v_and_b32 v55, s59, v107
    v_pk_add_f32 v[16:17], v[16:17], v[48:49]
    v_pk_add_f32 v[18:19], v[18:19], v[50:51]
    v_pk_add_f32 v[20:21], v[20:21], v[52:53]
    v_pk_add_f32 v[22:23], v[22:23], v[54:55]
    v_cvt_pk_bf16_f32 v96, v16, v17
    v_cvt_pk_bf16_f32 v97, v18, v19
    v_cvt_pk_bf16_f32 v98, v20, v21
    v_cvt_pk_bf16_f32 v99, v22, v23
    buffer_store_dwordx2 v[96:97], v8, s[8:11], s64 offen
    buffer_store_dwordx2 v[98:99], v8, s[8:11], s65 offen
    s_waitcnt vmcnt(8)
    v_lshlrev_b32 v48, 16, v112
    v_and_b32 v49, s59, v112
    v_lshlrev_b32 v50, 16, v113
    v_and_b32 v51, s59, v113
    v_lshlrev_b32 v52, 16, v114
    v_and_b32 v53, s59, v114
    v_lshlrev_b32 v54, 16, v115
    v_and_b32 v55, s59, v115
    v_pk_add_f32 v[24:25], v[24:25], v[48:49]
    v_pk_add_f32 v[26:27], v[26:27], v[50:51]
    v_pk_add_f32 v[28:29], v[28:29], v[52:53]
    v_pk_add_f32 v[30:31], v[30:31], v[54:55]
    v_lshlrev_b32 v48, 16, v116
    v_and_b32 v49, s59, v116
    v_lshlrev_b32 v50, 16, v117
    v_and_b32 v51, s59, v117
    v_lshlrev_b32 v52, 16, v118
    v_and_b32 v53, s59, v118
    v_lshlrev_b32 v54, 16, v119
    v_and_b32 v55, s59, v119
    v_pk_add_f32 v[24:25], v[24:25], v[48:49]
    v_pk_add_f32 v[26:27], v[26:27], v[50:51]
    v_pk_add_f32 v[28:29], v[28:29], v[52:53]
    v_pk_add_f32 v[30:31], v[30:31], v[54:55]
    v_lshlrev_b32 v48, 16, v120
    v_and_b32 v49, s59, v120
    v_lshlrev_b32 v50, 16, v121
    v_and_b32 v51, s59, v121
    v_lshlrev_b32 v52, 16, v122
    v_and_b32 v53, s59, v122
    v_lshlrev_b32 v54, 16, v123
    v_and_b32 v55, s59, v123
    v_pk_add_f32 v[24:25], v[24:25], v[48:49]
    v_pk_add_f32 v[26:27], v[26:27], v[50:51]
    v_pk_add_f32 v[28:29], v[28:29], v[52:53]
    v_pk_add_f32 v[30:31], v[30:31], v[54:55]
    v_cvt_pk_bf16_f32 v112, v24, v25
    v_cvt_pk_bf16_f32 v113, v26, v27
    v_cvt_pk_bf16_f32 v114, v28, v29
    v_cvt_pk_bf16_f32 v115, v30, v31
    buffer_store_dwordx2 v[112:113], v8, s[8:11], s66 offen
    buffer_store_dwordx2 v[114:115], v8, s[8:11], s67 offen
    s_waitcnt vmcnt(7)
    v_lshlrev_b32 v48, 16, v128
    v_and_b32 v49, s59, v128
    v_lshlrev_b32 v50, 16, v129
    v_and_b32 v51, s59, v129
    v_lshlrev_b32 v52, 16, v130
    v_and_b32 v53, s59, v130
    v_lshlrev_b32 v54, 16, v131
    v_and_b32 v55, s59, v131
    v_pk_add_f32 v[32:33], v[32:33], v[48:49]
    v_pk_add_f32 v[34:35], v[34:35], v[50:51]
    v_pk_add_f32 v[36:37], v[36:37], v[52:53]
    v_pk_add_f32 v[38:39], v[38:39], v[54:55]
    v_lshlrev_b32 v48, 16, v132
    v_and_b32 v49, s59, v132
    v_lshlrev_b32 v50, 16, v133
    v_and_b32 v51, s59, v133
    v_lshlrev_b32 v52, 16, v134
    v_and_b32 v53, s59, v134
    v_lshlrev_b32 v54, 16, v135
    v_and_b32 v55, s59, v135
    v_pk_add_f32 v[32:33], v[32:33], v[48:49]
    v_pk_add_f32 v[34:35], v[34:35], v[50:51]
    v_pk_add_f32 v[36:37], v[36:37], v[52:53]
    v_pk_add_f32 v[38:39], v[38:39], v[54:55]
    v_lshlrev_b32 v48, 16, v136
    v_and_b32 v49, s59, v136
    v_lshlrev_b32 v50, 16, v137
    v_and_b32 v51, s59, v137
    v_lshlrev_b32 v52, 16, v138
    v_and_b32 v53, s59, v138
    v_lshlrev_b32 v54, 16, v139
    v_and_b32 v55, s59, v139
    v_pk_add_f32 v[32:33], v[32:33], v[48:49]
    v_pk_add_f32 v[34:35], v[34:35], v[50:51]
    v_pk_add_f32 v[36:37], v[36:37], v[52:53]
    v_pk_add_f32 v[38:39], v[38:39], v[54:55]
    v_cvt_pk_bf16_f32 v128, v32, v33
    v_cvt_pk_bf16_f32 v129, v34, v35
    v_cvt_pk_bf16_f32 v130, v36, v37
    v_cvt_pk_bf16_f32 v131, v38, v39
    buffer_store_dwordx2 v[128:129], v8, s[8:11], s68 offen
    buffer_store_dwordx2 v[130:131], v8, s[8:11], s69 offen
    s_cmp_lg_u32 s40, 0
    s_cbranch_scc1 K2_EP
    s_waitcnt vmcnt(6)
    v_lshlrev_b32 v48, 16, v144
    v_and_b32 v49, s59, v144
    v_lshlrev_b32 v50, 16, v145
    v_and_b32 v51, s59, v145
    v_pk_add_f32 v[40:41], v[40:41], v[48:49]
    v_pk_add_f32 v[42:43], v[42:43], v[50:51]
    v_lshlrev_b32 v48, 16, v148
    v_and_b32 v49, s59, v148
    v_lshlrev_b32 v50, 16, v149
    v_and_b32 v51, s59, v149
    v_pk_add_f32 v[40:41], v[40:41], v[48:49]
    v_pk_add_f32 v[42:43], v[42:43], v[50:51]
    v_lshlrev_b32 v48, 16, v152
    v_and_b32 v49, s59, v152
    v_lshlrev_b32 v50, 16, v153
    v_and_b32 v51, s59, v153
    v_pk_add_f32 v[40:41], v[40:41], v[48:49]
    v_pk_add_f32 v[42:43], v[42:43], v[50:51]
    v_cvt_pk_bf16_f32 v144, v40, v41
    v_cvt_pk_bf16_f32 v145, v42, v43
    buffer_store_dwordx2 v[144:145], v8, s[8:11], s70 offen
K2_EP:
    s_cmp_lg_u32 s72, 1
    s_cbranch_scc1 K2_FIN
    s_mov_b32 s48, 0
EP_CHK:
    v_cmp_ne_u32 vcc, s30, v160
    v_cmp_ne_u32 s[94:95], s30, v161
    s_nop 1
    s_or_b64 s[94:95], s[94:95], vcc
    v_cmp_ne_u32 vcc, s30, v162
    s_nop 1
    s_or_b64 s[94:95], s[94:95], vcc
    v_cmp_ne_u32 vcc, s30, v163
    s_nop 1
    s_or_b64 s[94:95], s[94:95], vcc
    s_cbranch_scc0 EP_OK
    s_add_u32 s48, s48, 1
    s_cmp_ge_u32 s48, 0x40000
    s_cbranch_scc1 EP_OK
    s_sleep 8
    buffer_load_dwordx4 v[160:163], v9, s[36:39], s73 offen sc1
    s_waitcnt vmcnt(0)
    s_branch EP_CHK
EP_OK:
    s_mov_b32 s55, 34623488
    buffer_store_dword v93, v92, s[36:39], s55 offen sc1
K2_FIN:
    s_endpgm
FALLBACK:
    s_waitcnt vmcnt(0) lgkmcnt(0)
    s_barrier
    s_mov_b32 s31, 0
    s_mov_b32 s66, 0
    v_mov_b32 v40, 0xff800000
    v_mov_b32 v41, 0xff800000
    v_mov_b32 v42, 0xff800000
    v_mov_b32 v43, 0xff800000
    v_mov_b32 v44, 0xff800000
    v_mov_b32 v45, 0xff800000
    v_mov_b32 v46, 0xff800000
    v_mov_b32 v47, 0xff800000
    v_mov_b32 v48, 0xff800000
    v_mov_b32 v49, 0xff800000
    v_mov_b32 v50, 0xff800000
    v_mov_b32 v51, 0xff800000
    v_mov_b32 v52, 0xff800000
    v_mov_b32 v53, 0xff800000
    v_mov_b32 v54, 0xff800000
    v_mov_b32 v55, 0xff800000
    v_mov_b32 v56, 0xff800000
    v_mov_b32 v57, 0xff800000
    v_mov_b32 v58, 0xff800000
    v_mov_b32 v59, 0xff800000
FB_LOOP:
    s_add_u32 s75, s74, s66
    s_add_u32 s75, s75, 0
    s_add_u32 m0, s74, 0
    s_nop 0
    buffer_load_dwordx4 v16, s[80:83], s75 offen offset:0 lds
    buffer_load_dwordx4 v17, s[80:83], s75 offen offset:1024 lds
    s_add_u32 s75, s74, s66
    s_add_u32 s75, s75, 131072
    s_add_u32 m0, s74, 8192
    s_nop 0
    buffer_load_dwordx4 v16, s[80:83], s75 offen offset:0 lds
    buffer_load_dwordx4 v17, s[80:83], s75 offen offset:1024 lds
    s_waitcnt vmcnt(0)
    s_barrier
    ds_read_b128 a[80:83], v4 offset:0
    ds_read_b128 a[84:87], v5 offset:0
    ds_read_b128 a[88:91], v6 offset:0
    ds_read_b128 a[92:95], v7 offset:0
    ds_read_b128 a[96:99], v4 offset:4096
    ds_read_b128 a[100:103], v5 offset:4096
    ds_read_b128 a[104:107], v6 offset:4096
    ds_read_b128 a[108:111], v7 offset:4096
    s_waitcnt lgkmcnt(0)
    s_barrier
    v_mfma_f32_16x16x32_bf16 v[64:67], a[80:83], a[0:3], 0
    v_mfma_f32_16x16x32_bf16 v[64:67], a[84:87], a[4:7], v[64:67]
    v_mfma_f32_16x16x32_bf16 v[64:67], a[88:91], a[8:11], v[64:67]
    v_mfma_f32_16x16x32_bf16 v[64:67], a[92:95], a[12:15], v[64:67]
    v_mfma_f32_16x16x32_bf16 v[68:71], a[96:99], a[0:3], 0
    v_mfma_f32_16x16x32_bf16 v[68:71], a[100:103], a[4:7], v[68:71]
    v_mfma_f32_16x16x32_bf16 v[68:71], a[104:107], a[8:11], v[68:71]
    v_mfma_f32_16x16x32_bf16 v[68:71], a[108:111], a[12:15], v[68:71]
    s_nop 7
    v_max3_f32 v40, v64, v68, v40
    v_max3_f32 v41, v65, v69, v41
    v_max3_f32 v42, v66, v70, v42
    v_max3_f32 v43, v67, v71, v43
    s_nop 3
    v_mfma_f32_16x16x32_bf16 v[64:67], a[80:83], a[16:19], 0
    v_mfma_f32_16x16x32_bf16 v[64:67], a[84:87], a[20:23], v[64:67]
    v_mfma_f32_16x16x32_bf16 v[64:67], a[88:91], a[24:27], v[64:67]
    v_mfma_f32_16x16x32_bf16 v[64:67], a[92:95], a[28:31], v[64:67]
    v_mfma_f32_16x16x32_bf16 v[68:71], a[96:99], a[16:19], 0
    v_mfma_f32_16x16x32_bf16 v[68:71], a[100:103], a[20:23], v[68:71]
    v_mfma_f32_16x16x32_bf16 v[68:71], a[104:107], a[24:27], v[68:71]
    v_mfma_f32_16x16x32_bf16 v[68:71], a[108:111], a[28:31], v[68:71]
    s_nop 7
    v_max3_f32 v44, v64, v68, v44
    v_max3_f32 v45, v65, v69, v45
    v_max3_f32 v46, v66, v70, v46
    v_max3_f32 v47, v67, v71, v47
    s_nop 3
    v_mfma_f32_16x16x32_bf16 v[64:67], a[80:83], a[32:35], 0
    v_mfma_f32_16x16x32_bf16 v[64:67], a[84:87], a[36:39], v[64:67]
    v_mfma_f32_16x16x32_bf16 v[64:67], a[88:91], a[40:43], v[64:67]
    v_mfma_f32_16x16x32_bf16 v[64:67], a[92:95], a[44:47], v[64:67]
    v_mfma_f32_16x16x32_bf16 v[68:71], a[96:99], a[32:35], 0
    v_mfma_f32_16x16x32_bf16 v[68:71], a[100:103], a[36:39], v[68:71]
    v_mfma_f32_16x16x32_bf16 v[68:71], a[104:107], a[40:43], v[68:71]
    v_mfma_f32_16x16x32_bf16 v[68:71], a[108:111], a[44:47], v[68:71]
    s_nop 7
    v_max3_f32 v48, v64, v68, v48
    v_max3_f32 v49, v65, v69, v49
    v_max3_f32 v50, v66, v70, v50
    v_max3_f32 v51, v67, v71, v51
    s_nop 3
    v_mfma_f32_16x16x32_bf16 v[64:67], a[80:83], a[48:51], 0
    v_mfma_f32_16x16x32_bf16 v[64:67], a[84:87], a[52:55], v[64:67]
    v_mfma_f32_16x16x32_bf16 v[64:67], a[88:91], a[56:59], v[64:67]
    v_mfma_f32_16x16x32_bf16 v[64:67], a[92:95], a[60:63], v[64:67]
    v_mfma_f32_16x16x32_bf16 v[68:71], a[96:99], a[48:51], 0
    v_mfma_f32_16x16x32_bf16 v[68:71], a[100:103], a[52:55], v[68:71]
    v_mfma_f32_16x16x32_bf16 v[68:71], a[104:107], a[56:59], v[68:71]
    v_mfma_f32_16x16x32_bf16 v[68:71], a[108:111], a[60:63], v[68:71]
    s_nop 7
    v_max3_f32 v52, v64, v68, v52
    v_max3_f32 v53, v65, v69, v53
    v_max3_f32 v54, v66, v70, v54
    v_max3_f32 v55, v67, v71, v55
    s_nop 3
    v_mfma_f32_16x16x32_bf16 v[64:67], a[80:83], a[64:67], 0
    v_mfma_f32_16x16x32_bf16 v[64:67], a[84:87], a[68:71], v[64:67]
    v_mfma_f32_16x16x32_bf16 v[64:67], a[88:91], a[72:75], v[64:67]
    v_mfma_f32_16x16x32_bf16 v[64:67], a[92:95], a[76:79], v[64:67]
    v_mfma_f32_16x16x32_bf16 v[68:71], a[96:99], a[64:67], 0
    v_mfma_f32_16x16x32_bf16 v[68:71], a[100:103], a[68:71], v[68:71]
    v_mfma_f32_16x16x32_bf16 v[68:71], a[104:107], a[72:75], v[68:71]
    v_mfma_f32_16x16x32_bf16 v[68:71], a[108:111], a[76:79], v[68:71]
    s_nop 7
    v_max3_f32 v56, v64, v68, v56
    v_max3_f32 v57, v65, v69, v57
    v_max3_f32 v58, v66, v70, v58
    v_max3_f32 v59, v67, v71, v59
    s_nop 3
    s_add_u32 s66, s66, 8192
    s_cmp_lt_u32 s66, 131072
    s_cbranch_scc1 FB_LOOP
    s_add_u32 s75, s100, 0
    s_and_b32 s75, s75, s79
    s_add_u32 m0, s74, 0
    s_nop 0
    buffer_load_dwordx4 v16, s[80:83], s75 offen offset:0 nt lds
    buffer_load_dwordx4 v17, s[80:83], s75 offen offset:1024 nt lds
    s_add_u32 s75, s101, 0
    s_and_b32 s75, s75, s79
    s_add_u32 s75, s75, 131072
    s_add_u32 m0, s74, 8192
    s_nop 0
    buffer_load_dwordx4 v16, s[80:83], s75 offen offset:0 nt lds
    buffer_load_dwordx4 v17, s[80:83], s75 offen offset:1024 nt lds
    s_add_u32 s75, s100, 0
    s_and_b32 s75, s75, s79
    s_add_u32 m0, s74, 98304
    s_nop 0
    buffer_load_dwordx4 v18, s[84:87], s75 offen offset:0 nt lds
    buffer_load_dwordx4 v19, s[84:87], s75 offen offset:1024 nt lds
    s_add_u32 s75, s101, 0
    s_and_b32 s75, s75, s79
    s_add_u32 s75, s75, 131072
    s_add_u32 m0, s74, 106496
    s_nop 0
    buffer_load_dwordx4 v18, s[84:87], s75 offen offset:0 nt lds
    buffer_load_dwordx4 v19, s[84:87], s75 offen offset:1024 nt lds
    s_waitcnt vmcnt(0)
    s_barrier
    ds_read_b128 a[80:83], v4 offset:0
    ds_read_b128 a[84:87], v5 offset:0
    ds_read_b128 a[88:91], v6 offset:0
    ds_read_b128 a[92:95], v7 offset:0
    ds_read_b128 a[96:99], v4 offset:4096
    ds_read_b128 a[100:103], v5 offset:4096
    ds_read_b128 a[104:107], v6 offset:4096
    ds_read_b128 a[108:111], v7 offset:4096
    ds_read_b64_tr_b16 a[144:145], v8 offset:32768
    ds_read_b64_tr_b16 a[146:147], v8 offset:36864
    ds_read_b64_tr_b16 a[148:149], v9 offset:32768
    ds_read_b64_tr_b16 a[150:151], v9 offset:36864
    ds_read_b64_tr_b16 a[152:153], v10 offset:32768
    ds_read_b64_tr_b16 a[154:155], v10 offset:36864
    ds_read_b64_tr_b16 a[156:157], v11 offset:32768
    ds_read_b64_tr_b16 a[158:159], v11 offset:36864
    ds_read_b64_tr_b16 a[160:161], v12 offset:32768
    ds_read_b64_tr_b16 a[162:163], v12 offset:36864
    ds_read_b64_tr_b16 a[164:165], v13 offset:32768
    ds_read_b64_tr_b16 a[166:167], v13 offset:36864
    ds_read_b64_tr_b16 a[168:169], v14 offset:32768
    ds_read_b64_tr_b16 a[170:171], v14 offset:36864
    ds_read_b64_tr_b16 a[172:173], v15 offset:32768
    ds_read_b64_tr_b16 a[174:175], v15 offset:36864
    s_waitcnt lgkmcnt(0)
    s_barrier
    s_add_u32 s75, s100, 8192
    s_and_b32 s75, s75, s79
    s_add_u32 m0, s74, 16384
    s_nop 0
    buffer_load_dwordx4 v16, s[80:83], s75 offen offset:0 nt lds
    buffer_load_dwordx4 v17, s[80:83], s75 offen offset:1024 nt lds
    s_add_u32 s75, s101, 8192
    s_and_b32 s75, s75, s79
    s_add_u32 s75, s75, 131072
    s_add_u32 m0, s74, 24576
    s_nop 0
    buffer_load_dwordx4 v16, s[80:83], s75 offen offset:0 nt lds
    buffer_load_dwordx4 v17, s[80:83], s75 offen offset:1024 nt lds
    s_add_u32 s75, s100, 8192
    s_and_b32 s75, s75, s79
    s_add_u32 m0, s74, 98304
    s_nop 0
    buffer_load_dwordx4 v18, s[84:87], s75 offen offset:0 nt lds
    buffer_load_dwordx4 v19, s[84:87], s75 offen offset:1024 nt lds
    s_add_u32 s75, s101, 8192
    s_and_b32 s75, s75, s79
    s_add_u32 s75, s75, 131072
    s_add_u32 m0, s74, 106496
    s_nop 0
    buffer_load_dwordx4 v18, s[84:87], s75 offen offset:0 nt lds
    buffer_load_dwordx4 v19, s[84:87], s75 offen offset:1024 nt lds
    s_waitcnt vmcnt(0)
    s_barrier
    ds_read_b128 a[112:115], v4 offset:16384
    ds_read_b128 a[116:119], v5 offset:16384
    ds_read_b128 a[120:123], v6 offset:16384
    ds_read_b128 a[124:127], v7 offset:16384
    ds_read_b128 a[128:131], v4 offset:20480
    ds_read_b128 a[132:135], v5 offset:20480
    ds_read_b128 a[136:139], v6 offset:20480
    ds_read_b128 a[140:143], v7 offset:20480
    ds_read_b64_tr_b16 a[176:177], v8 offset:32768
    ds_read_b64_tr_b16 a[178:179], v8 offset:36864
    ds_read_b64_tr_b16 a[180:181], v9 offset:32768
    ds_read_b64_tr_b16 a[182:183], v9 offset:36864
    ds_read_b64_tr_b16 a[184:185], v10 offset:32768
    ds_read_b64_tr_b16 a[186:187], v10 offset:36864
    ds_read_b64_tr_b16 a[188:189], v11 offset:32768
    ds_read_b64_tr_b16 a[190:191], v11 offset:36864
    ds_read_b64_tr_b16 a[192:193], v12 offset:32768
    ds_read_b64_tr_b16 a[194:195], v12 offset:36864
    ds_read_b64_tr_b16 a[196:197], v13 offset:32768
    ds_read_b64_tr_b16 a[198:199], v13 offset:36864
    ds_read_b64_tr_b16 a[200:201], v14 offset:32768
    ds_read_b64_tr_b16 a[202:203], v14 offset:36864
    ds_read_b64_tr_b16 a[204:205], v15 offset:32768
    ds_read_b64_tr_b16 a[206:207], v15 offset:36864
    s_waitcnt lgkmcnt(0)
    s_barrier
    s_add_u32 s75, s100, 16384
    s_and_b32 s75, s75, s79
    s_add_u32 m0, s74, 0
    s_nop 0
    buffer_load_dwordx4 v16, s[80:83], s75 offen offset:0 nt lds
    buffer_load_dwordx4 v17, s[80:83], s75 offen offset:1024 nt lds
    s_add_u32 s75, s101, 16384
    s_and_b32 s75, s75, s79
    s_add_u32 s75, s75, 131072
    s_add_u32 m0, s74, 8192
    s_nop 0
    buffer_load_dwordx4 v16, s[80:83], s75 offen offset:0 nt lds
    buffer_load_dwordx4 v17, s[80:83], s75 offen offset:1024 nt lds
    s_add_u32 s75, s100, 16384
    s_and_b32 s75, s75, s79
    s_add_u32 m0, s74, 98304
    s_nop 0
    buffer_load_dwordx4 v18, s[84:87], s75 offen offset:0 nt lds
    buffer_load_dwordx4 v19, s[84:87], s75 offen offset:1024 nt lds
    s_add_u32 s75, s101, 16384
    s_and_b32 s75, s75, s79
    s_add_u32 s75, s75, 131072
    s_add_u32 m0, s74, 106496
    s_nop 0
    buffer_load_dwordx4 v18, s[84:87], s75 offen offset:0 nt lds
    buffer_load_dwordx4 v19, s[84:87], s75 offen offset:1024 nt lds
    s_add_u32 s75, s100, 24576
    s_and_b32 s75, s75, s79
    s_add_u32 m0, s74, 16384
    s_nop 0
    buffer_load_dwordx4 v16, s[80:83], s75 offen offset:0 nt lds
    buffer_load_dwordx4 v17, s[80:83], s75 offen offset:1024 nt lds
    s_add_u32 s75, s101, 24576
    s_and_b32 s75, s75, s79
    s_add_u32 s75, s75, 131072
    s_add_u32 m0, s74, 24576
    s_nop 0
    buffer_load_dwordx4 v16, s[80:83], s75 offen offset:0 nt lds
    buffer_load_dwordx4 v17, s[80:83], s75 offen offset:1024 nt lds
    s_add_u32 s75, s100, 24576
    s_and_b32 s75, s75, s79
    s_add_u32 m0, s74, 114688
    s_nop 0
    buffer_load_dwordx4 v18, s[84:87], s75 offen offset:0 nt lds
    buffer_load_dwordx4 v19, s[84:87], s75 offen offset:1024 nt lds
    s_add_u32 s75, s101, 24576
    s_and_b32 s75, s75, s79
    s_add_u32 s75, s75, 131072
    s_add_u32 m0, s74, 122880
    s_nop 0
    buffer_load_dwordx4 v18, s[84:87], s75 offen offset:0 nt lds
    buffer_load_dwordx4 v19, s[84:87], s75 offen offset:1024 nt lds
    s_add_u32 s75, s100, 32768
    s_and_b32 s75, s75, s79
    s_add_u32 m0, s74, 32768
    s_nop 0
    buffer_load_dwordx4 v16, s[80:83], s75 offen offset:0 nt lds
    buffer_load_dwordx4 v17, s[80:83], s75 offen offset:1024 nt lds
    s_add_u32 s75, s101, 32768
    s_and_b32 s75, s75, s79
    s_add_u32 s75, s75, 131072
    s_add_u32 m0, s74, 40960
    s_nop 0
    buffer_load_dwordx4 v16, s[80:83], s75 offen offset:0 nt lds
    buffer_load_dwordx4 v17, s[80:83], s75 offen offset:1024 nt lds
    s_add_u32 s75, s100, 32768
    s_and_b32 s75, s75, s79
    s_add_u32 m0, s74, 65536
    s_nop 0
    buffer_load_dwordx4 v18, s[84:87], s75 offen offset:0 nt lds
    buffer_load_dwordx4 v19, s[84:87], s75 offen offset:1024 nt lds
    s_add_u32 s75, s101, 32768
    s_and_b32 s75, s75, s79
    s_add_u32 s75, s75, 131072
    s_add_u32 m0, s74, 73728
    s_nop 0
    buffer_load_dwordx4 v18, s[84:87], s75 offen offset:0 nt lds
    buffer_load_dwordx4 v19, s[84:87], s75 offen offset:1024 nt lds
    s_add_u32 s75, s100, 40960
    s_and_b32 s75, s75, s79
    s_add_u32 m0, s74, 49152
    s_nop 0
    buffer_load_dwordx4 v16, s[80:83], s75 offen offset:0 nt lds
    buffer_load_dwordx4 v17, s[80:83], s75 offen offset:1024 nt lds
    s_add_u32 s75, s101, 40960
    s_and_b32 s75, s75, s79
    s_add_u32 s75, s75, 131072
    s_add_u32 m0, s74, 57344
    s_nop 0
    buffer_load_dwordx4 v16, s[80:83], s75 offen offset:0 nt lds
    buffer_load_dwordx4 v17, s[80:83], s75 offen offset:1024 nt lds
    s_add_u32 s75, s100, 40960
    s_and_b32 s75, s75, s79
    s_add_u32 m0, s74, 81920
    s_nop 0
    buffer_load_dwordx4 v18, s[84:87], s75 offen offset:0 nt lds
    buffer_load_dwordx4 v19, s[84:87], s75 offen offset:1024 nt lds
    s_add_u32 s75, s101, 40960
    s_and_b32 s75, s75, s79
    s_add_u32 s75, s75, 131072
    s_add_u32 m0, s74, 90112
    s_nop 0
    buffer_load_dwordx4 v18, s[84:87], s75 offen offset:0 nt lds
    buffer_load_dwordx4 v19, s[84:87], s75 offen offset:1024 nt lds
    s_waitcnt vmcnt(0)
    s_branch ATT_MAX
K_END:
    s_endpgm
.section .rodata,"a"
.p2align 6
.amdhsa_kernel standalone__mha_block_cached__near_ridge_kernel
  .amdhsa_next_free_vgpr 512
  .amdhsa_next_free_sgpr 102
  .amdhsa_accum_offset 256
  .amdhsa_group_segment_fixed_size 0
  .amdhsa_kernarg_size 64
  .amdhsa_user_sgpr_count 2
  .amdhsa_user_sgpr_kernarg_segment_ptr 1
  .amdhsa_system_sgpr_workgroup_id_x 1
  .amdhsa_float_denorm_mode_32 3
.end_amdhsa_kernel
```
